```python
import torch

def _softmax(x, axis=-1):
    return torch.softmax(x, dim=axis)
def _gelu(x):
    return torch.nn.functional.gelu(x, approximate="tanh")
def _silu(x):
    return torch.nn.functional.silu(x)
def _sigmoid(x):
    return torch.sigmoid(x)
def _layernorm(x, axis=-1, eps=1e-5):
    m = x.mean(dim=axis, keepdim=True)
    v = x.var(dim=axis, keepdim=True, unbiased=False)
    return (x - m) / torch.sqrt(v + eps)
def _scatter_add(tgt, idx, src, axis=0):
    return tgt.clone().index_add_(axis, idx, src)
def _segment_sum(src, seg, n):
    out = torch.zeros((n,) + src.shape[1:], dtype=src.dtype)
    return out.index_add_(0, seg, src)
def _pad(x, pw):
    flat = tuple(v for pair in reversed(pw) for v in pair)
    return torch.nn.functional.pad(x, flat)

kernel_name = 'standalone__gqa_softmax__sampling'

def setup_inputs():

    _w = (lambda a: (lambda t: t.to(torch.bfloat16) if t.is_floating_point() else t)(torch.as_tensor(a)))
    B, Hq, Hkv, Sq, Sk, D = 8, 32, 16, 16, 8192, 128
    return {
        "q": _w((lambda *s: torch.randn(*s, dtype=torch.bfloat16) * 0.8)(B, Hq, Sq, D)),
        "k": _w((lambda *s: torch.randn(*s, dtype=torch.bfloat16) * 0.8)(B, Hkv, Sk, D)),
        "v": _w((lambda *s: torch.randn(*s, dtype=torch.bfloat16) * 0.05)(B, Hkv, Sk, D)),
    }

def reference(q, k, v):
    B, Hq, Sq, D = q.shape
    Hkv = k.shape[1]
    rep = Hq // Hkv
    k = (lambda x, n, axis: torch.repeat_interleave(x, n, dim=axis))(k, rep, axis=1)
    v = (lambda x, n, axis: torch.repeat_interleave(x, n, dim=axis))(v, rep, axis=1)
    scale = D ** -0.5
    scores = torch.einsum("bhqd,bhkd->bhqk", q, k) * scale
    p = _softmax(scores, axis=-1)
    return torch.einsum("bhqk,bhkd->bhqd", p, v)
```

```asm
; @launch grid=(256,1,1) block=(256,1,1) lds=86016
.amdgcn_target "amdgcn-amd-amdhsa--gfx950"
.text
.globl standalone__gqa_softmax__sampling_kernel
.p2align 8
.type standalone__gqa_softmax__sampling_kernel,@function
standalone__gqa_softmax__sampling_kernel:
s_load_dwordx8 s[4:11], s[0:1], 0
s_load_dwordx4 s[12:15], s[0:1], 32
s_cmp_ge_u32 s2, 256
s_cbranch_scc1 L_end
s_getpc_b64 s[96:97]
L_pc:
s_lshr_b32 s46, s2, 3
s_mul_i32 s46, s46, 2560
v_mul_u32_u24 v164, 10, v0
v_and_b32 v164, -4, v164
v_add_u32 v164, s46, v164
v_min_u32 v164, L_end - L_pc - 4, v164
v_mov_b32 v165, s97
v_add_co_u32 v164, vcc, s96, v164
s_nop 1
v_addc_co_u32 v165, vcc, 0, v165, vcc
global_load_dword v163, v[164:165], off
v_lshrrev_b32 v1, 6, v0
v_and_b32 v0, 63, v0
v_and_b32 v11, 15, v0
v_readfirstlane_b32 s40, v1
v_lshrrev_b32 v12, 4, v0
v_lshlrev_b32 v13, 2, v12
v_xor_b32 v13, v13, v11
v_lshlrev_b32 v14, 8, v12
v_xor_b32 v15, 0, v13
v_lshl_add_u32 v1, v15, 4, v14
v_xor_b32 v15, 1, v13
v_lshl_add_u32 v2, v15, 4, v14
v_xor_b32 v15, 2, v13
v_lshl_add_u32 v3, v15, 4, v14
v_xor_b32 v15, 3, v13
v_lshl_add_u32 v4, v15, 4, v14
s_mov_b32 s41, 0
s_bitcmp1_b32 s2, 6
s_cselect_b32 s42, 1, 0
s_or_b32 s41, s41, s42
s_bitcmp1_b32 s2, 4
s_cselect_b32 s42, 2, 0
s_or_b32 s41, s41, s42
s_bitcmp1_b32 s2, 0
s_cselect_b32 s42, 4, 0
s_or_b32 s41, s41, s42
s_bitcmp1_b32 s2, 3
s_cselect_b32 s42, 8, 0
s_or_b32 s41, s41, s42
s_bitcmp1_b32 s2, 5
s_cselect_b32 s42, 16, 0
s_or_b32 s41, s41, s42
s_bitcmp1_b32 s2, 1
s_cselect_b32 s42, 32, 0
s_or_b32 s41, s41, s42
s_bitcmp1_b32 s2, 2
s_cselect_b32 s42, 64, 0
s_or_b32 s41, s41, s42
s_bfe_u32 s42, s2, 0x10007
s_lshl_b32 s43, s42, 2
s_add_u32 s43, s43, s40
s_lshl_b32 s44, s43, 12
s_mov_b32 s45, s44
s_lshl_b32 s46, s41, 21
s_lshl_b32 s47, s40, 14
s_mov_b32 s18, 0x200000
s_mov_b32 s19, 0x20000
s_mov_b32 m0, s47
s_mov_b32 s26, 0x100000
s_mov_b32 s27, 0x20000
s_lshl_b32 s51, s41, 13
s_lshl_b32 s52, s40, 11
s_add_u32 s62, s52, s51
s_add_u32 s52, s52, 77824
s_and_b32 s54, s40, 1
s_lshl_b32 s53, s54, 5
v_xor_b32 v166, s53, v1
v_xor_b32 v167, s53, v2
s_waitcnt lgkmcnt(0)
s_add_u32 s16, s6, s46
s_addc_u32 s17, s7, 0
buffer_load_dwordx4 v1, s[16:19], s44 offen offset:0 nt lds
buffer_load_dwordx4 v2, s[16:19], s44 offen offset:1024 nt lds
buffer_load_dwordx4 v3, s[16:19], s44 offen offset:2048 nt lds
buffer_load_dwordx4 v4, s[16:19], s44 offen offset:3072 nt lds
s_mov_b32 s24, s4
s_mov_b32 s25, s5
s_mov_b32 m0, s52
s_nop 0
buffer_load_dwordx4 v166, s[24:27], s62 offen lds
buffer_load_dwordx4 v167, s[24:27], s62 offen offset:1024 lds
s_add_u32 s44, s44, 0x8000
s_add_u32 m0, s47, 4096
s_nop 0
buffer_load_dwordx4 v1, s[16:19], s44 offen offset:0 nt lds
buffer_load_dwordx4 v2, s[16:19], s44 offen offset:1024 nt lds
buffer_load_dwordx4 v3, s[16:19], s44 offen offset:2048 nt lds
buffer_load_dwordx4 v4, s[16:19], s44 offen offset:3072 nt lds
s_add_u32 s44, s44, 0x8000
s_add_u32 m0, s47, 8192
s_nop 0
buffer_load_dwordx4 v1, s[16:19], s44 offen offset:0 nt lds
buffer_load_dwordx4 v2, s[16:19], s44 offen offset:1024 nt lds
v_and_b32 v13, 3, v11
v_lshlrev_b32 v13, 2, v13
v_lshrrev_b32 v14, 2, v11
v_add_u32 v13, v13, v14
v_xor_b32 v168, v12, v13
v_lshlrev_b32 v168, 4, v168
v_lshl_add_u32 v168, v11, 8, v168
v_add_u32 v168, 77824, v168
v_xor_b32 v169, 64, v168
v_xor_b32 v170, 128, v168
v_xor_b32 v171, 192, v168
v_lshlrev_b32 v13, 8, v13
v_add_u32 v13, s47, v13
v_xor_b32 v14, v12, v11
v_xor_b32 v15, 0, v14
v_lshl_add_u32 v5, v15, 4, v13
v_xor_b32 v15, 4, v14
v_lshl_add_u32 v6, v15, 4, v13
v_xor_b32 v15, 8, v14
v_lshl_add_u32 v7, v15, 4, v13
v_xor_b32 v15, 12, v14
v_lshl_add_u32 v8, v15, 4, v13
s_mov_b32 s48, 0x3e0293ee
v_mov_b32 v12, 0xff800000
v_mov_b32 v20, 0
v_mov_b32 v21, 0
s_waitcnt vmcnt(11)
buffer_load_dwordx4 v3, s[16:19], s44 offen offset:2048 nt lds
s_waitcnt vmcnt(4)
buffer_load_dwordx4 v4, s[16:19], s44 offen offset:3072 nt lds
s_barrier
ds_read_b128 v[56:59], v168 offset:0
ds_read_b128 v[60:63], v169 offset:0
ds_read_b128 v[64:67], v170 offset:0
ds_read_b128 v[68:71], v171 offset:0
ds_read_b128 v[72:75], v168 offset:4096
ds_read_b128 v[76:79], v169 offset:4096
ds_read_b128 v[80:83], v170 offset:4096
ds_read_b128 v[84:87], v171 offset:4096
ds_read_b128 v[88:91], v5 offset:0
ds_read_b128 v[92:95], v6 offset:0
ds_read_b128 v[96:99], v7 offset:0
ds_read_b128 v[100:103], v8 offset:0
s_add_u32 s44, s44, 0x8000
s_add_u32 m0, s47, 12288
s_waitcnt vmcnt(4)
buffer_load_dwordx4 v1, s[16:19], s44 offen offset:0 nt lds
s_waitcnt lgkmcnt(0)
v_mfma_f32_16x16x32_bf16 v[120:123], v[88:91], v[56:59], 0
v_mfma_f32_16x16x32_bf16 v[128:131], v[88:91], v[72:75], 0
v_mfma_f32_16x16x32_bf16 v[120:123], v[92:95], v[60:63], v[120:123]
v_mfma_f32_16x16x32_bf16 v[128:131], v[92:95], v[76:79], v[128:131]
v_mfma_f32_16x16x32_bf16 v[120:123], v[96:99], v[64:67], v[120:123]
v_mfma_f32_16x16x32_bf16 v[128:131], v[96:99], v[80:83], v[128:131]
v_mfma_f32_16x16x32_bf16 v[120:123], v[100:103], v[68:71], v[120:123]
v_mfma_f32_16x16x32_bf16 v[128:131], v[100:103], v[84:87], v[128:131]
s_waitcnt vmcnt(4)
buffer_load_dwordx4 v2, s[16:19], s44 offen offset:1024 nt lds
s_add_u32 s20, s8, s46
s_addc_u32 s21, s9, 0
s_mov_b32 s22, 0x200000
s_mov_b32 s23, 0x20000
v_lshlrev_b32 v9, 4, v0
s_mov_b32 s28, s10
s_mov_b32 s29, s11
s_mov_b32 s30, 0x100000
s_mov_b32 s31, 0x20000
s_mov_b32 s32, s14
s_mov_b32 s33, s15
s_mov_b32 s34, 0x1000000
s_mov_b32 s35, 0x20000
s_mov_b32 s36, s12
s_mov_b32 s37, s13
s_mov_b32 s38, 256
s_mov_b32 s39, 0x20000
s_mov_b32 s49, 0x05040100
s_mov_b32 s50, 0x07060302
s_xor_b32 s64, s42, 1
s_lshl_b32 s64, s64, 7
v_xor_b32 v249, s64, v9
v_and_b32 v243, 0x370, v9
v_and_b32 v242, 8, v0
v_add3_u32 v243, v243, v242, s64
v_xor_b32 v242, 0x80, v243
s_lshl_b32 s68, s42, 7
s_add_u32 s68, s68, s62
s_xor_b32 s69, s68, 128
s_mov_b32 s88, 0
s_mov_b64 vcc, 0
s_waitcnt vmcnt(4)
buffer_load_dwordx4 v3, s[16:19], s44 offen offset:2048 nt lds
s_lshl_b32 s55, s2, 2
s_add_u32 s55, s55, s40
s_xor_b32 s56, s55, 512
s_mul_i32 s63, s55, 5120
s_mul_i32 s57, s56, 5120
s_add_u32 s58, s57, 4096
s_add_u32 s89, s63, 4096
s_mul_i32 s61, s41, 205
s_lshr_b32 s61, s61, 10
s_mul_i32 s59, s61, 5
s_sub_u32 s59, s41, s59
s_mul_i32 s59, s59, 6
s_lshl_b32 s61, s61, 2
s_and_b32 s42, s2, 7
s_lshl_b32 s42, s42, 4
s_lshr_b32 s43, s2, 4
s_add_u32 s42, s42, s43
s_add_u32 s42, s42, 128
s_lshr_b32 s43, s2, 3
s_and_b32 s43, s43, 1
s_or_b32 s43, s43, s40
s_cmp_eq_u32 s43, 0
s_cselect_b32 s42, s42, 0x1000
v_lshlrev_b32 v240, 1, v0
s_getreg_b32 s43, hwreg(HW_REG_XCC_ID, 0, 3)
s_lshl_b32 s43, s43, 2
s_lshr_b32 s43, 0x03030303, s43
s_and_b32 s43, s43, 15
v_mov_b32 v22, 0
v_lshlrev_b32 v23, 3, v0
v_and_b32 v23, 7, v0
v_lshlrev_b32 v23, 4, v23
s_lshl_b32 s92, s56, 7
s_add_u32 s92, s92, 5242880
s_lshl_b32 s93, s55, 7
s_add_u32 s93, s93, 5242880
buffer_load_dwordx4 v[172:175], v22, s[32:35], s92 offen sc1
buffer_load_dwordx4 v[176:179], v22, s[32:35], s93 offen sc1
buffer_load_ushort v180, v240, s[36:39], 0 offen offset:128
s_waitcnt vmcnt(7)
buffer_load_dwordx4 v4, s[16:19], s44 offen offset:3072 nt lds
ds_read_b128 v[104:107], v5 offset:4096
ds_read_b128 v[108:111], v6 offset:4096
ds_read_b128 v[112:115], v7 offset:4096
ds_read_b128 v[116:119], v8 offset:4096
s_add_u32 s44, s44, 0x8000
s_add_u32 m0, s47, 0
s_waitcnt vmcnt(7)
buffer_load_dwordx4 v1, s[16:19], s44 offen offset:0 nt lds
s_waitcnt lgkmcnt(0)
v_mfma_f32_16x16x32_bf16 v[124:127], v[104:107], v[56:59], 0
v_mfma_f32_16x16x32_bf16 v[132:135], v[104:107], v[72:75], 0
v_mfma_f32_16x16x32_bf16 v[124:127], v[108:111], v[60:63], v[124:127]
v_mfma_f32_16x16x32_bf16 v[132:135], v[108:111], v[76:79], v[132:135]
v_mfma_f32_16x16x32_bf16 v[124:127], v[112:115], v[64:67], v[124:127]
v_mfma_f32_16x16x32_bf16 v[132:135], v[112:115], v[80:83], v[132:135]
v_mfma_f32_16x16x32_bf16 v[124:127], v[116:119], v[68:71], v[124:127]
v_mfma_f32_16x16x32_bf16 v[132:135], v[116:119], v[84:87], v[132:135]
s_waitcnt vmcnt(7)
buffer_load_dwordx4 v2, s[16:19], s44 offen offset:1024 nt lds
v_max3_f32 v13, v120, v121, v122
v_max3_f32 v14, v128, v129, v130
s_nop 2
v_max3_f32 v13, v13, v123, v124
v_max3_f32 v14, v14, v131, v132
v_max3_f32 v13, v13, v125, v126
v_max3_f32 v14, v14, v133, v134
v_max_f32 v13, v13, v127
v_max_f32 v14, v14, v135
s_nop 1
v_permlane32_swap_b32 v13, v14
v_max_f32 v13, v13, v14
v_mov_b32 v14, v13
s_nop 1
v_permlane16_swap_b32 v13, v14
v_max_f32 v13, v13, v14
v_mul_f32 v13, s48, v13
v_max_f32 v15, v12, v13
v_sub_f32 v14, v12, v15
v_exp_f32 v24, v14
v_mov_b32 v12, v15
v_mov_b32 v11, v15
v_mov_b32 v16, v24
v_mov_b32 v18, v24
v_permlane32_swap_b32 v15, v11
s_nop 0
v_permlane32_swap_b32 v16, v18
s_waitcnt vmcnt(7)
buffer_load_dwordx4 v3, s[16:19], s44 offen offset:2048 nt lds
v_fma_f32 v120, v120, s48, -v15
v_fma_f32 v121, v121, s48, -v15
v_fma_f32 v122, v122, s48, -v15
v_fma_f32 v123, v123, s48, -v15
v_fma_f32 v124, v124, s48, -v15
v_fma_f32 v125, v125, s48, -v15
v_fma_f32 v126, v126, s48, -v15
v_fma_f32 v127, v127, s48, -v15
v_fma_f32 v128, v128, s48, -v11
v_fma_f32 v129, v129, s48, -v11
v_fma_f32 v130, v130, s48, -v11
v_fma_f32 v131, v131, s48, -v11
v_fma_f32 v132, v132, s48, -v11
v_fma_f32 v133, v133, s48, -v11
v_fma_f32 v134, v134, s48, -v11
v_fma_f32 v135, v135, s48, -v11
v_exp_f32 v120, v120
v_exp_f32 v121, v121
v_exp_f32 v122, v122
v_exp_f32 v123, v123
s_waitcnt vmcnt(7)
buffer_load_dwordx4 v4, s[16:19], s44 offen offset:3072 nt lds
v_exp_f32 v124, v124
v_exp_f32 v125, v125
v_exp_f32 v126, v126
v_exp_f32 v127, v127
v_exp_f32 v128, v128
v_exp_f32 v129, v129
v_exp_f32 v130, v130
v_exp_f32 v131, v131
ds_read_b128 v[88:91], v5 offset:8192
ds_read_b128 v[92:95], v6 offset:8192
ds_read_b128 v[96:99], v7 offset:8192
ds_read_b128 v[100:103], v8 offset:8192
s_add_u32 s44, s44, 0x8000
s_add_u32 m0, s47, 4096
s_waitcnt vmcnt(4)
buffer_load_dwordx4 v1, s[16:19], s44 offen offset:0 nt lds
s_waitcnt lgkmcnt(0)
v_mfma_f32_16x16x32_bf16 v[136:139], v[88:91], v[56:59], 0
v_mfma_f32_16x16x32_bf16 v[144:147], v[88:91], v[72:75], 0
v_exp_f32 v132, v132
v_mfma_f32_16x16x32_bf16 v[136:139], v[92:95], v[60:63], v[136:139]
v_mfma_f32_16x16x32_bf16 v[144:147], v[92:95], v[76:79], v[144:147]
v_exp_f32 v133, v133
v_mfma_f32_16x16x32_bf16 v[136:139], v[96:99], v[64:67], v[136:139]
v_mfma_f32_16x16x32_bf16 v[144:147], v[96:99], v[80:83], v[144:147]
v_exp_f32 v134, v134
v_mfma_f32_16x16x32_bf16 v[136:139], v[100:103], v[68:71], v[136:139]
v_mfma_f32_16x16x32_bf16 v[144:147], v[100:103], v[84:87], v[144:147]
v_exp_f32 v135, v135
s_waitcnt vmcnt(4)
buffer_load_dwordx4 v2, s[16:19], s44 offen offset:1024 nt lds
v_cvt_pk_bf16_f32 v152, v120, v121
v_cvt_pk_bf16_f32 v153, v122, v123
v_cvt_pk_bf16_f32 v154, v124, v125
v_cvt_pk_bf16_f32 v155, v126, v127
v_cvt_pk_bf16_f32 v156, v128, v129
v_cvt_pk_bf16_f32 v157, v130, v131
v_cvt_pk_bf16_f32 v158, v132, v133
v_cvt_pk_bf16_f32 v159, v134, v135
v_accvgpr_write_b32 a0, v152
v_accvgpr_write_b32 a1, v153
v_accvgpr_write_b32 a2, v154
v_accvgpr_write_b32 a3, v155
v_accvgpr_write_b32 a4, v156
v_accvgpr_write_b32 a5, v157
v_accvgpr_write_b32 a6, v158
v_accvgpr_write_b32 a7, v159
s_waitcnt vmcnt(4)
buffer_load_dwordx4 v3, s[16:19], s44 offen offset:2048 nt lds
v_fma_f32 v20, v20, v16, v120
v_fma_f32 v21, v21, v18, v128
v_add_f32 v20, v20, v121
v_add_f32 v21, v21, v129
v_add_f32 v20, v20, v122
v_add_f32 v21, v21, v130
v_add_f32 v20, v20, v123
v_add_f32 v21, v21, v131
v_add_f32 v20, v20, v124
v_add_f32 v21, v21, v132
v_add_f32 v20, v20, v125
v_add_f32 v21, v21, v133
v_add_f32 v20, v20, v126
v_add_f32 v21, v21, v134
v_add_f32 v20, v20, v127
v_add_f32 v21, v21, v135
s_waitcnt vmcnt(4)
buffer_load_dwordx4 v4, s[16:19], s44 offen offset:3072 nt lds
ds_read_b128 v[104:107], v5 offset:12288
ds_read_b128 v[108:111], v6 offset:12288
ds_read_b128 v[112:115], v7 offset:12288
ds_read_b128 v[116:119], v8 offset:12288
s_add_u32 s44, s44, 0x8000
s_add_u32 m0, s47, 8192
s_waitcnt vmcnt(4)
buffer_load_dwordx4 v1, s[16:19], s44 offen offset:0 nt lds
s_waitcnt lgkmcnt(0)
v_mfma_f32_16x16x32_bf16 v[140:143], v[104:107], v[56:59], 0
v_mfma_f32_16x16x32_bf16 v[148:151], v[104:107], v[72:75], 0
v_mfma_f32_16x16x32_bf16 v[140:143], v[108:111], v[60:63], v[140:143]
v_mfma_f32_16x16x32_bf16 v[148:151], v[108:111], v[76:79], v[148:151]
v_mfma_f32_16x16x32_bf16 v[140:143], v[112:115], v[64:67], v[140:143]
v_mfma_f32_16x16x32_bf16 v[148:151], v[112:115], v[80:83], v[148:151]
v_mfma_f32_16x16x32_bf16 v[140:143], v[116:119], v[68:71], v[140:143]
v_mfma_f32_16x16x32_bf16 v[148:151], v[116:119], v[84:87], v[148:151]
s_waitcnt vmcnt(4)
buffer_load_dwordx4 v2, s[16:19], s44 offen offset:1024 nt lds
v_max3_f32 v13, v136, v137, v138
v_max3_f32 v14, v144, v145, v146
s_nop 2
v_max3_f32 v13, v13, v139, v140
v_max3_f32 v14, v14, v147, v148
v_max3_f32 v13, v13, v141, v142
v_max3_f32 v14, v14, v149, v150
v_max_f32 v13, v13, v143
v_max_f32 v14, v14, v151
s_nop 1
v_permlane32_swap_b32 v13, v14
v_max_f32 v13, v13, v14
v_mov_b32 v14, v13
s_nop 1
v_permlane16_swap_b32 v13, v14
v_max_f32 v13, v13, v14
v_mul_f32 v13, s48, v13
v_max_f32 v15, v12, v13
v_sub_f32 v14, v12, v15
v_exp_f32 v25, v14
v_mov_b32 v12, v15
v_mov_b32 v11, v15
v_mov_b32 v16, v25
v_mov_b32 v18, v25
v_permlane32_swap_b32 v15, v11
s_nop 0
v_permlane32_swap_b32 v16, v18
s_waitcnt vmcnt(4)
buffer_load_dwordx4 v3, s[16:19], s44 offen offset:2048 nt lds
v_mov_b32 v241, 1
s_mov_b64 exec, 1
buffer_store_byte v241, v22, s[36:39], s42 offen
s_mov_b64 exec, -1
buffer_load_ushort v10, v240, s[36:39], 0 offen offset:128 nt
v_fma_f32 v136, v136, s48, -v15
v_fma_f32 v137, v137, s48, -v15
v_fma_f32 v138, v138, s48, -v15
v_fma_f32 v139, v139, s48, -v15
v_fma_f32 v140, v140, s48, -v15
v_fma_f32 v141, v141, s48, -v15
v_fma_f32 v142, v142, s48, -v15
v_fma_f32 v143, v143, s48, -v15
v_fma_f32 v144, v144, s48, -v11
v_fma_f32 v145, v145, s48, -v11
v_fma_f32 v146, v146, s48, -v11
v_fma_f32 v147, v147, s48, -v11
v_fma_f32 v148, v148, s48, -v11
v_fma_f32 v149, v149, s48, -v11
v_fma_f32 v150, v150, s48, -v11
v_fma_f32 v151, v151, s48, -v11
v_exp_f32 v136, v136
v_exp_f32 v137, v137
v_exp_f32 v138, v138
v_exp_f32 v139, v139
s_waitcnt vmcnt(6)
buffer_load_dwordx4 v4, s[16:19], s44 offen offset:3072 nt lds
v_exp_f32 v140, v140
v_exp_f32 v141, v141
v_exp_f32 v142, v142
v_exp_f32 v143, v143
v_exp_f32 v144, v144
v_exp_f32 v145, v145
v_exp_f32 v146, v146
v_exp_f32 v147, v147
ds_read_b128 v[88:91], v5 offset:0
ds_read_b128 v[92:95], v6 offset:0
ds_read_b128 v[96:99], v7 offset:0
ds_read_b128 v[100:103], v8 offset:0
s_add_u32 s44, s44, 0x8000
s_add_u32 m0, s47, 12288
s_waitcnt vmcnt(6)
buffer_load_dwordx4 v1, s[16:19], s44 offen offset:0 nt lds
s_waitcnt lgkmcnt(0)
v_mfma_f32_16x16x32_bf16 v[120:123], v[88:91], v[56:59], 0
v_mfma_f32_16x16x32_bf16 v[128:131], v[88:91], v[72:75], 0
v_exp_f32 v148, v148
v_mfma_f32_16x16x32_bf16 v[120:123], v[92:95], v[60:63], v[120:123]
v_mfma_f32_16x16x32_bf16 v[128:131], v[92:95], v[76:79], v[128:131]
v_exp_f32 v149, v149
v_mfma_f32_16x16x32_bf16 v[120:123], v[96:99], v[64:67], v[120:123]
v_mfma_f32_16x16x32_bf16 v[128:131], v[96:99], v[80:83], v[128:131]
v_exp_f32 v150, v150
v_mfma_f32_16x16x32_bf16 v[120:123], v[100:103], v[68:71], v[120:123]
v_mfma_f32_16x16x32_bf16 v[128:131], v[100:103], v[84:87], v[128:131]
v_exp_f32 v151, v151
s_waitcnt vmcnt(6)
buffer_load_dwordx4 v2, s[16:19], s44 offen offset:1024 nt lds
v_cvt_pk_bf16_f32 v152, v136, v137
v_cvt_pk_bf16_f32 v153, v138, v139
v_cvt_pk_bf16_f32 v154, v140, v141
v_cvt_pk_bf16_f32 v155, v142, v143
v_cvt_pk_bf16_f32 v156, v144, v145
v_cvt_pk_bf16_f32 v157, v146, v147
v_cvt_pk_bf16_f32 v158, v148, v149
v_cvt_pk_bf16_f32 v159, v150, v151
v_accvgpr_write_b32 a8, v152
v_accvgpr_write_b32 a9, v153
v_accvgpr_write_b32 a10, v154
v_accvgpr_write_b32 a11, v155
v_accvgpr_write_b32 a12, v156
v_accvgpr_write_b32 a13, v157
v_accvgpr_write_b32 a14, v158
v_accvgpr_write_b32 a15, v159
s_waitcnt vmcnt(6)
buffer_load_dwordx4 v3, s[16:19], s44 offen offset:2048 nt lds
v_readfirstlane_b32 s94, v172
v_readfirstlane_b32 s98, v174
v_readfirstlane_b32 s95, v176
v_readfirstlane_b32 s99, v178
s_nop 0
s_add_u32 s95, s95, 1
s_add_u32 s99, s99, 1
s_add_u32 s96, s94, 1
s_add_u32 s98, s98, 1
v_fma_f32 v20, v20, v16, v136
v_fma_f32 v21, v21, v18, v144
v_add_f32 v20, v20, v137
v_add_f32 v21, v21, v145
v_add_f32 v20, v20, v138
v_add_f32 v21, v21, v146
v_add_f32 v20, v20, v139
v_add_f32 v21, v21, v147
v_add_f32 v20, v20, v140
v_add_f32 v21, v21, v148
v_add_f32 v20, v20, v141
v_add_f32 v21, v21, v149
v_add_f32 v20, v20, v142
v_add_f32 v21, v21, v150
v_add_f32 v20, v20, v143
v_add_f32 v21, v21, v151
s_waitcnt vmcnt(6)
buffer_load_dwordx4 v4, s[16:19], s44 offen offset:3072 nt lds
ds_read_b128 v[104:107], v5 offset:4096
ds_read_b128 v[108:111], v6 offset:4096
ds_read_b128 v[112:115], v7 offset:4096
ds_read_b128 v[116:119], v8 offset:4096
s_add_u32 s44, s44, 0x8000
s_add_u32 m0, s47, 0
s_waitcnt vmcnt(4)
buffer_load_dwordx4 v1, s[16:19], s44 offen offset:0 nt lds
s_waitcnt lgkmcnt(0)
v_mfma_f32_16x16x32_bf16 v[124:127], v[104:107], v[56:59], 0
v_mfma_f32_16x16x32_bf16 v[132:135], v[104:107], v[72:75], 0
v_mfma_f32_16x16x32_bf16 v[124:127], v[108:111], v[60:63], v[124:127]
v_mfma_f32_16x16x32_bf16 v[132:135], v[108:111], v[76:79], v[132:135]
v_mfma_f32_16x16x32_bf16 v[124:127], v[112:115], v[64:67], v[124:127]
v_mfma_f32_16x16x32_bf16 v[132:135], v[112:115], v[80:83], v[132:135]
v_mfma_f32_16x16x32_bf16 v[124:127], v[116:119], v[68:71], v[124:127]
v_mfma_f32_16x16x32_bf16 v[132:135], v[116:119], v[84:87], v[132:135]
s_cbranch_vccnz L_sk33
s_waitcnt vmcnt(4)
L_sk33:
buffer_load_dwordx4 v2, s[16:19], s44 offen offset:1024 nt lds
v_max3_f32 v13, v120, v121, v122
v_max3_f32 v14, v128, v129, v130
s_nop 2
v_max3_f32 v13, v13, v123, v124
v_max3_f32 v14, v14, v131, v132
v_max3_f32 v13, v13, v125, v126
v_max3_f32 v14, v14, v133, v134
v_max_f32 v13, v13, v127
v_max_f32 v14, v14, v135
s_nop 1
v_permlane32_swap_b32 v13, v14
v_max_f32 v13, v13, v14
v_mov_b32 v14, v13
s_nop 1
v_permlane16_swap_b32 v13, v14
v_max_f32 v13, v13, v14
v_mul_f32 v13, s48, v13
v_max_f32 v15, v12, v13
v_sub_f32 v14, v12, v15
v_exp_f32 v26, v14
v_mov_b32 v12, v15
v_mov_b32 v11, v15
v_mov_b32 v16, v26
v_mov_b32 v18, v26
v_permlane32_swap_b32 v15, v11
s_nop 0
v_permlane32_swap_b32 v16, v18
s_waitcnt vmcnt(5)
s_bitcmp1_b32 s88, 1
s_cbranch_scc1 L_sk34
s_waitcnt vmcnt(4)
L_sk34:
buffer_load_dwordx4 v3, s[16:19], s44 offen offset:2048 nt lds
v_and_b32 v241, 0xff, v10
v_lshrrev_b32 v10, 8, v10
v_cmp_le_u32 vcc, 1, v241
v_cmp_le_u32 s[90:91], 1, v10
s_nop 0
s_bcnt1_i32_b64 s88, vcc
s_bcnt1_i32_b64 s90, s[90:91]
s_add_u32 s90, s90, s88
s_add_u32 s90, s90, s43
s_cmp_ge_u32 s90, 15
s_cselect_b32 s88, 2, 0
s_cmp_le_u32 s90, 5
s_cselect_b32 s88, 1, s88
s_cmp_ge_u32 s90, 10
s_cselect_b64 vcc, -1, 0
v_fma_f32 v120, v120, s48, -v15
v_fma_f32 v121, v121, s48, -v15
v_fma_f32 v122, v122, s48, -v15
v_fma_f32 v123, v123, s48, -v15
v_fma_f32 v124, v124, s48, -v15
v_fma_f32 v125, v125, s48, -v15
v_fma_f32 v126, v126, s48, -v15
v_fma_f32 v127, v127, s48, -v15
v_fma_f32 v128, v128, s48, -v11
v_fma_f32 v129, v129, s48, -v11
v_fma_f32 v130, v130, s48, -v11
v_fma_f32 v131, v131, s48, -v11
v_fma_f32 v132, v132, s48, -v11
v_fma_f32 v133, v133, s48, -v11
v_fma_f32 v134, v134, s48, -v11
v_fma_f32 v135, v135, s48, -v11
v_exp_f32 v120, v120
v_exp_f32 v121, v121
v_exp_f32 v122, v122
v_exp_f32 v123, v123
s_waitcnt vmcnt(5)
s_cbranch_vccnz L_sk35
s_waitcnt vmcnt(4)
L_sk35:
buffer_load_dwordx4 v4, s[16:19], s44 offen offset:3072 nt lds
v_exp_f32 v124, v124
v_exp_f32 v125, v125
v_exp_f32 v126, v126
v_exp_f32 v127, v127
v_exp_f32 v128, v128
v_exp_f32 v129, v129
v_exp_f32 v130, v130
v_exp_f32 v131, v131
ds_read_b128 v[88:91], v5 offset:8192
ds_read_b128 v[92:95], v6 offset:8192
ds_read_b128 v[96:99], v7 offset:8192
ds_read_b128 v[100:103], v8 offset:8192
s_add_u32 s44, s44, 0x8000
s_add_u32 m0, s47, 4096
s_waitcnt vmcnt(4)
buffer_load_dwordx4 v1, s[16:19], s44 offen offset:0 nt lds
s_waitcnt lgkmcnt(0)
v_mfma_f32_16x16x32_bf16 v[136:139], v[88:91], v[56:59], 0
v_mfma_f32_16x16x32_bf16 v[144:147], v[88:91], v[72:75], 0
v_exp_f32 v132, v132
v_mfma_f32_16x16x32_bf16 v[136:139], v[92:95], v[60:63], v[136:139]
v_mfma_f32_16x16x32_bf16 v[144:147], v[92:95], v[76:79], v[144:147]
v_exp_f32 v133, v133
v_mfma_f32_16x16x32_bf16 v[136:139], v[96:99], v[64:67], v[136:139]
v_mfma_f32_16x16x32_bf16 v[144:147], v[96:99], v[80:83], v[144:147]
v_exp_f32 v134, v134
v_mfma_f32_16x16x32_bf16 v[136:139], v[100:103], v[68:71], v[136:139]
v_mfma_f32_16x16x32_bf16 v[144:147], v[100:103], v[84:87], v[144:147]
v_exp_f32 v135, v135
s_cbranch_vccnz L_sk37
s_waitcnt vmcnt(4)
L_sk37:
buffer_load_dwordx4 v2, s[16:19], s44 offen offset:1024 nt lds
v_cvt_pk_bf16_f32 v152, v120, v121
v_cvt_pk_bf16_f32 v153, v122, v123
v_cvt_pk_bf16_f32 v154, v124, v125
v_cvt_pk_bf16_f32 v155, v126, v127
v_cvt_pk_bf16_f32 v156, v128, v129
v_cvt_pk_bf16_f32 v157, v130, v131
v_cvt_pk_bf16_f32 v158, v132, v133
v_cvt_pk_bf16_f32 v159, v134, v135
v_accvgpr_write_b32 a16, v152
v_accvgpr_write_b32 a17, v153
v_accvgpr_write_b32 a18, v154
v_accvgpr_write_b32 a19, v155
v_accvgpr_write_b32 a20, v156
v_accvgpr_write_b32 a21, v157
v_accvgpr_write_b32 a22, v158
v_accvgpr_write_b32 a23, v159
s_waitcnt vmcnt(4)
s_bitcmp1_b32 s88, 0
s_cbranch_scc0 L_ng38
s_waitcnt vmcnt(3)
L_ng38:
buffer_load_dwordx4 v3, s[16:19], s44 offen offset:2048 nt lds
v_fma_f32 v20, v20, v16, v120
v_fma_f32 v21, v21, v18, v128
v_add_f32 v20, v20, v121
v_add_f32 v21, v21, v129
v_add_f32 v20, v20, v122
v_add_f32 v21, v21, v130
v_add_f32 v20, v20, v123
v_add_f32 v21, v21, v131
v_add_f32 v20, v20, v124
v_add_f32 v21, v21, v132
v_add_f32 v20, v20, v125
v_add_f32 v21, v21, v133
v_add_f32 v20, v20, v126
v_add_f32 v21, v21, v134
v_add_f32 v20, v20, v127
v_add_f32 v21, v21, v135
s_cbranch_vccnz L_sk39
s_waitcnt vmcnt(4)
L_sk39:
buffer_load_dwordx4 v4, s[16:19], s44 offen offset:3072 nt lds
ds_read_b128 v[104:107], v5 offset:12288
ds_read_b128 v[108:111], v6 offset:12288
ds_read_b128 v[112:115], v7 offset:12288
ds_read_b128 v[116:119], v8 offset:12288
s_add_u32 s44, s44, 0x8000
s_add_u32 m0, s47, 8192
s_waitcnt vmcnt(4)
buffer_load_dwordx4 v1, s[16:19], s44 offen offset:0 nt lds
s_barrier
s_waitcnt lgkmcnt(0)
v_mfma_f32_16x16x32_bf16 v[140:143], v[104:107], v[56:59], 0
v_mfma_f32_16x16x32_bf16 v[148:151], v[104:107], v[72:75], 0
v_mfma_f32_16x16x32_bf16 v[140:143], v[108:111], v[60:63], v[140:143]
v_mfma_f32_16x16x32_bf16 v[148:151], v[108:111], v[76:79], v[148:151]
v_mfma_f32_16x16x32_bf16 v[140:143], v[112:115], v[64:67], v[140:143]
v_mfma_f32_16x16x32_bf16 v[148:151], v[112:115], v[80:83], v[148:151]
v_mfma_f32_16x16x32_bf16 v[140:143], v[116:119], v[68:71], v[140:143]
v_mfma_f32_16x16x32_bf16 v[148:151], v[116:119], v[84:87], v[148:151]
s_cbranch_vccnz L_sk41
s_waitcnt vmcnt(4)
L_sk41:
buffer_load_dwordx4 v2, s[16:19], s44 offen offset:1024 nt lds
v_max3_f32 v13, v136, v137, v138
v_max3_f32 v14, v144, v145, v146
s_nop 2
v_max3_f32 v13, v13, v139, v140
v_max3_f32 v14, v14, v147, v148
v_max3_f32 v13, v13, v141, v142
v_max3_f32 v14, v14, v149, v150
v_max_f32 v13, v13, v143
v_max_f32 v14, v14, v151
s_nop 1
v_permlane32_swap_b32 v13, v14
v_max_f32 v13, v13, v14
v_mov_b32 v14, v13
s_nop 1
v_permlane16_swap_b32 v13, v14
v_max_f32 v13, v13, v14
v_mul_f32 v13, s48, v13
v_max_f32 v15, v12, v13
v_sub_f32 v14, v12, v15
v_exp_f32 v27, v14
v_mov_b32 v12, v15
v_mov_b32 v11, v15
v_mov_b32 v16, v27
v_mov_b32 v18, v27
v_permlane32_swap_b32 v15, v11
s_nop 0
v_permlane32_swap_b32 v16, v18
s_waitcnt vmcnt(5)
s_bitcmp1_b32 s88, 1
s_cbranch_scc1 L_sk42
s_waitcnt vmcnt(4)
L_sk42:
buffer_load_dwordx4 v3, s[16:19], s44 offen offset:2048 nt lds
v_mov_b32 v241, 2
s_mov_b64 exec, 1
buffer_store_byte v241, v22, s[36:39], s42 offen
s_mov_b64 exec, -1
buffer_load_ushort v10, v240, s[36:39], 0 offen offset:128 nt
v_fma_f32 v136, v136, s48, -v15
v_fma_f32 v137, v137, s48, -v15
v_fma_f32 v138, v138, s48, -v15
v_fma_f32 v139, v139, s48, -v15
v_fma_f32 v140, v140, s48, -v15
v_fma_f32 v141, v141, s48, -v15
v_fma_f32 v142, v142, s48, -v15
v_fma_f32 v143, v143, s48, -v15
v_fma_f32 v144, v144, s48, -v11
v_fma_f32 v145, v145, s48, -v11
v_fma_f32 v146, v146, s48, -v11
v_fma_f32 v147, v147, s48, -v11
v_fma_f32 v148, v148, s48, -v11
v_fma_f32 v149, v149, s48, -v11
v_fma_f32 v150, v150, s48, -v11
v_fma_f32 v151, v151, s48, -v11
v_exp_f32 v136, v136
v_exp_f32 v137, v137
v_exp_f32 v138, v138
v_exp_f32 v139, v139
s_waitcnt vmcnt(7)
s_cbranch_vccnz L_sk43
s_waitcnt vmcnt(6)
L_sk43:
buffer_load_dwordx4 v4, s[16:19], s44 offen offset:3072 nt lds
v_exp_f32 v140, v140
v_exp_f32 v141, v141
v_exp_f32 v142, v142
v_exp_f32 v143, v143
v_exp_f32 v144, v144
v_exp_f32 v145, v145
v_exp_f32 v146, v146
v_exp_f32 v147, v147
ds_read_b128 v[88:91], v5 offset:0
ds_read_b128 v[92:95], v6 offset:0
ds_read_b128 v[96:99], v7 offset:0
ds_read_b128 v[100:103], v8 offset:0
s_add_u32 s44, s44, 0x8000
s_add_u32 m0, s47, 12288
s_waitcnt vmcnt(6)
buffer_load_dwordx4 v1, s[16:19], s44 offen offset:0 nt lds
s_barrier
s_waitcnt lgkmcnt(0)
v_mfma_f32_16x16x32_bf16 v[120:123], v[88:91], v[56:59], 0
v_mfma_f32_16x16x32_bf16 v[128:131], v[88:91], v[72:75], 0
v_exp_f32 v148, v148
v_mfma_f32_16x16x32_bf16 v[120:123], v[92:95], v[60:63], v[120:123]
v_mfma_f32_16x16x32_bf16 v[128:131], v[92:95], v[76:79], v[128:131]
v_exp_f32 v149, v149
v_mfma_f32_16x16x32_bf16 v[120:123], v[96:99], v[64:67], v[120:123]
v_mfma_f32_16x16x32_bf16 v[128:131], v[96:99], v[80:83], v[128:131]
v_exp_f32 v150, v150
v_mfma_f32_16x16x32_bf16 v[120:123], v[100:103], v[68:71], v[120:123]
v_mfma_f32_16x16x32_bf16 v[128:131], v[100:103], v[84:87], v[128:131]
v_exp_f32 v151, v151
s_cbranch_vccnz L_sk45
s_waitcnt vmcnt(6)
L_sk45:
buffer_load_dwordx4 v2, s[16:19], s44 offen offset:1024 nt lds
v_cvt_pk_bf16_f32 v152, v136, v137
v_cvt_pk_bf16_f32 v153, v138, v139
v_cvt_pk_bf16_f32 v154, v140, v141
v_cvt_pk_bf16_f32 v155, v142, v143
v_cvt_pk_bf16_f32 v156, v144, v145
v_cvt_pk_bf16_f32 v157, v146, v147
v_cvt_pk_bf16_f32 v158, v148, v149
v_cvt_pk_bf16_f32 v159, v150, v151
v_accvgpr_write_b32 a24, v152
v_accvgpr_write_b32 a25, v153
v_accvgpr_write_b32 a26, v154
v_accvgpr_write_b32 a27, v155
v_accvgpr_write_b32 a28, v156
v_accvgpr_write_b32 a29, v157
v_accvgpr_write_b32 a30, v158
v_accvgpr_write_b32 a31, v159
s_waitcnt vmcnt(6)
s_bitcmp1_b32 s88, 0
s_cbranch_scc0 L_ng46
s_waitcnt vmcnt(5)
L_ng46:
buffer_load_dwordx4 v3, s[16:19], s44 offen offset:2048 nt lds
v_fma_f32 v20, v20, v16, v136
v_fma_f32 v21, v21, v18, v144
v_add_f32 v20, v20, v137
v_add_f32 v21, v21, v145
v_add_f32 v20, v20, v138
v_add_f32 v21, v21, v146
v_add_f32 v20, v20, v139
v_add_f32 v21, v21, v147
v_add_f32 v20, v20, v140
v_add_f32 v21, v21, v148
v_add_f32 v20, v20, v141
v_add_f32 v21, v21, v149
v_add_f32 v20, v20, v142
v_add_f32 v21, v21, v150
v_add_f32 v20, v20, v143
v_add_f32 v21, v21, v151
s_cbranch_vccnz L_sk47
s_waitcnt vmcnt(6)
L_sk47:
buffer_load_dwordx4 v4, s[16:19], s44 offen offset:3072 nt lds
ds_read_b128 v[104:107], v5 offset:4096
ds_read_b128 v[108:111], v6 offset:4096
ds_read_b128 v[112:115], v7 offset:4096
ds_read_b128 v[116:119], v8 offset:4096
s_add_u32 s44, s44, 0x8000
s_add_u32 m0, s47, 0
s_waitcnt vmcnt(4)
buffer_load_dwordx4 v1, s[16:19], s44 offen offset:0 nt lds
s_barrier
s_waitcnt lgkmcnt(0)
v_mfma_f32_16x16x32_bf16 v[124:127], v[104:107], v[56:59], 0
v_mfma_f32_16x16x32_bf16 v[132:135], v[104:107], v[72:75], 0
v_mfma_f32_16x16x32_bf16 v[124:127], v[108:111], v[60:63], v[124:127]
v_mfma_f32_16x16x32_bf16 v[132:135], v[108:111], v[76:79], v[132:135]
v_mfma_f32_16x16x32_bf16 v[124:127], v[112:115], v[64:67], v[124:127]
v_mfma_f32_16x16x32_bf16 v[132:135], v[112:115], v[80:83], v[132:135]
v_mfma_f32_16x16x32_bf16 v[124:127], v[116:119], v[68:71], v[124:127]
v_mfma_f32_16x16x32_bf16 v[132:135], v[116:119], v[84:87], v[132:135]
s_cbranch_vccnz L_sk49
s_waitcnt vmcnt(4)
L_sk49:
buffer_load_dwordx4 v2, s[16:19], s44 offen offset:1024 nt lds
v_max3_f32 v13, v120, v121, v122
v_max3_f32 v14, v128, v129, v130
s_nop 2
v_max3_f32 v13, v13, v123, v124
v_max3_f32 v14, v14, v131, v132
v_max3_f32 v13, v13, v125, v126
v_max3_f32 v14, v14, v133, v134
v_max_f32 v13, v13, v127
v_max_f32 v14, v14, v135
s_nop 1
v_permlane32_swap_b32 v13, v14
v_max_f32 v13, v13, v14
v_mov_b32 v14, v13
s_nop 1
v_permlane16_swap_b32 v13, v14
v_max_f32 v13, v13, v14
v_mul_f32 v13, s48, v13
v_max_f32 v15, v12, v13
v_sub_f32 v14, v12, v15
v_exp_f32 v28, v14
v_mov_b32 v12, v15
v_mov_b32 v11, v15
v_mov_b32 v16, v28
v_mov_b32 v18, v28
v_permlane32_swap_b32 v15, v11
s_nop 0
v_permlane32_swap_b32 v16, v18
s_waitcnt vmcnt(5)
s_bitcmp1_b32 s88, 1
s_cbranch_scc1 L_sk50
s_waitcnt vmcnt(4)
L_sk50:
buffer_load_dwordx4 v3, s[16:19], s44 offen offset:2048 nt lds
v_and_b32 v241, 0xff, v10
v_lshrrev_b32 v10, 8, v10
v_cmp_le_u32 vcc, 2, v241
v_cmp_le_u32 s[90:91], 2, v10
s_nop 0
s_bcnt1_i32_b64 s88, vcc
s_bcnt1_i32_b64 s90, s[90:91]
s_add_u32 s90, s90, s88
s_add_u32 s90, s90, s43
s_cmp_ge_u32 s90, 15
s_cselect_b32 s88, 2, 0
s_cmp_le_u32 s90, 5
s_cselect_b32 s88, 1, s88
s_cmp_ge_u32 s90, 10
s_cselect_b64 vcc, -1, 0
v_fma_f32 v120, v120, s48, -v15
v_fma_f32 v121, v121, s48, -v15
v_fma_f32 v122, v122, s48, -v15
v_fma_f32 v123, v123, s48, -v15
v_fma_f32 v124, v124, s48, -v15
v_fma_f32 v125, v125, s48, -v15
v_fma_f32 v126, v126, s48, -v15
v_fma_f32 v127, v127, s48, -v15
v_fma_f32 v128, v128, s48, -v11
v_fma_f32 v129, v129, s48, -v11
v_fma_f32 v130, v130, s48, -v11
v_fma_f32 v131, v131, s48, -v11
v_fma_f32 v132, v132, s48, -v11
v_fma_f32 v133, v133, s48, -v11
v_fma_f32 v134, v134, s48, -v11
v_fma_f32 v135, v135, s48, -v11
v_exp_f32 v120, v120
v_exp_f32 v121, v121
v_exp_f32 v122, v122
v_exp_f32 v123, v123
s_waitcnt vmcnt(5)
s_cbranch_vccnz L_sk51
s_waitcnt vmcnt(4)
L_sk51:
buffer_load_dwordx4 v4, s[16:19], s44 offen offset:3072 nt lds
v_exp_f32 v124, v124
v_exp_f32 v125, v125
v_exp_f32 v126, v126
v_exp_f32 v127, v127
v_exp_f32 v128, v128
v_exp_f32 v129, v129
v_exp_f32 v130, v130
v_exp_f32 v131, v131
ds_read_b128 v[88:91], v5 offset:8192
ds_read_b128 v[92:95], v6 offset:8192
ds_read_b128 v[96:99], v7 offset:8192
ds_read_b128 v[100:103], v8 offset:8192
s_add_u32 s44, s44, 0x8000
s_add_u32 m0, s47, 4096
s_waitcnt vmcnt(4)
buffer_load_dwordx4 v1, s[16:19], s44 offen offset:0 nt lds
s_barrier
s_waitcnt lgkmcnt(0)
v_mfma_f32_16x16x32_bf16 v[136:139], v[88:91], v[56:59], 0
v_mfma_f32_16x16x32_bf16 v[144:147], v[88:91], v[72:75], 0
v_exp_f32 v132, v132
v_mfma_f32_16x16x32_bf16 v[136:139], v[92:95], v[60:63], v[136:139]
v_mfma_f32_16x16x32_bf16 v[144:147], v[92:95], v[76:79], v[144:147]
v_exp_f32 v133, v133
v_mfma_f32_16x16x32_bf16 v[136:139], v[96:99], v[64:67], v[136:139]
v_mfma_f32_16x16x32_bf16 v[144:147], v[96:99], v[80:83], v[144:147]
v_exp_f32 v134, v134
v_mfma_f32_16x16x32_bf16 v[136:139], v[100:103], v[68:71], v[136:139]
v_mfma_f32_16x16x32_bf16 v[144:147], v[100:103], v[84:87], v[144:147]
v_exp_f32 v135, v135
s_cbranch_vccnz L_sk53
s_waitcnt vmcnt(4)
L_sk53:
buffer_load_dwordx4 v2, s[16:19], s44 offen offset:1024 nt lds
v_cvt_pk_bf16_f32 v152, v120, v121
v_cvt_pk_bf16_f32 v153, v122, v123
v_cvt_pk_bf16_f32 v154, v124, v125
v_cvt_pk_bf16_f32 v155, v126, v127
v_cvt_pk_bf16_f32 v156, v128, v129
v_cvt_pk_bf16_f32 v157, v130, v131
v_cvt_pk_bf16_f32 v158, v132, v133
v_cvt_pk_bf16_f32 v159, v134, v135
v_accvgpr_write_b32 a32, v152
v_accvgpr_write_b32 a33, v153
v_accvgpr_write_b32 a34, v154
v_accvgpr_write_b32 a35, v155
v_accvgpr_write_b32 a36, v156
v_accvgpr_write_b32 a37, v157
v_accvgpr_write_b32 a38, v158
v_accvgpr_write_b32 a39, v159
s_waitcnt vmcnt(4)
s_bitcmp1_b32 s88, 0
s_cbranch_scc0 L_ng54
s_waitcnt vmcnt(3)
L_ng54:
buffer_load_dwordx4 v3, s[16:19], s44 offen offset:2048 nt lds
v_fma_f32 v20, v20, v16, v120
v_fma_f32 v21, v21, v18, v128
v_add_f32 v20, v20, v121
v_add_f32 v21, v21, v129
v_add_f32 v20, v20, v122
v_add_f32 v21, v21, v130
v_add_f32 v20, v20, v123
v_add_f32 v21, v21, v131
v_add_f32 v20, v20, v124
v_add_f32 v21, v21, v132
v_add_f32 v20, v20, v125
v_add_f32 v21, v21, v133
v_add_f32 v20, v20, v126
v_add_f32 v21, v21, v134
v_add_f32 v20, v20, v127
v_add_f32 v21, v21, v135
s_cbranch_vccnz L_sk55
s_waitcnt vmcnt(4)
L_sk55:
buffer_load_dwordx4 v4, s[16:19], s44 offen offset:3072 nt lds
ds_read_b128 v[104:107], v5 offset:12288
ds_read_b128 v[108:111], v6 offset:12288
ds_read_b128 v[112:115], v7 offset:12288
ds_read_b128 v[116:119], v8 offset:12288
s_add_u32 s44, s44, 0x8000
s_add_u32 m0, s47, 8192
s_waitcnt vmcnt(4)
buffer_load_dwordx4 v1, s[16:19], s44 offen offset:0 nt lds
s_barrier
s_waitcnt lgkmcnt(0)
v_mfma_f32_16x16x32_bf16 v[140:143], v[104:107], v[56:59], 0
v_mfma_f32_16x16x32_bf16 v[148:151], v[104:107], v[72:75], 0
v_mfma_f32_16x16x32_bf16 v[140:143], v[108:111], v[60:63], v[140:143]
v_mfma_f32_16x16x32_bf16 v[148:151], v[108:111], v[76:79], v[148:151]
v_mfma_f32_16x16x32_bf16 v[140:143], v[112:115], v[64:67], v[140:143]
v_mfma_f32_16x16x32_bf16 v[148:151], v[112:115], v[80:83], v[148:151]
v_mfma_f32_16x16x32_bf16 v[140:143], v[116:119], v[68:71], v[140:143]
v_mfma_f32_16x16x32_bf16 v[148:151], v[116:119], v[84:87], v[148:151]
s_cbranch_vccnz L_sk57
s_waitcnt vmcnt(4)
L_sk57:
buffer_load_dwordx4 v2, s[16:19], s44 offen offset:1024 nt lds
v_max3_f32 v13, v136, v137, v138
v_max3_f32 v14, v144, v145, v146
s_nop 2
v_max3_f32 v13, v13, v139, v140
v_max3_f32 v14, v14, v147, v148
v_max3_f32 v13, v13, v141, v142
v_max3_f32 v14, v14, v149, v150
v_max_f32 v13, v13, v143
v_max_f32 v14, v14, v151
s_nop 1
v_permlane32_swap_b32 v13, v14
v_max_f32 v13, v13, v14
v_mov_b32 v14, v13
s_nop 1
v_permlane16_swap_b32 v13, v14
v_max_f32 v13, v13, v14
v_mul_f32 v13, s48, v13
v_max_f32 v15, v12, v13
v_sub_f32 v14, v12, v15
v_exp_f32 v29, v14
v_mov_b32 v12, v15
v_mov_b32 v11, v15
v_mov_b32 v16, v29
v_mov_b32 v18, v29
v_permlane32_swap_b32 v15, v11
s_nop 0
v_permlane32_swap_b32 v16, v18
s_waitcnt vmcnt(5)
s_bitcmp1_b32 s88, 1
s_cbranch_scc1 L_sk58
s_waitcnt vmcnt(4)
L_sk58:
buffer_load_dwordx4 v3, s[16:19], s44 offen offset:2048 nt lds
v_mov_b32 v241, 3
s_mov_b64 exec, 1
buffer_store_byte v241, v22, s[36:39], s42 offen
s_mov_b64 exec, -1
buffer_load_ushort v10, v240, s[36:39], 0 offen offset:128 nt
v_fma_f32 v136, v136, s48, -v15
v_fma_f32 v137, v137, s48, -v15
v_fma_f32 v138, v138, s48, -v15
v_fma_f32 v139, v139, s48, -v15
v_fma_f32 v140, v140, s48, -v15
v_fma_f32 v141, v141, s48, -v15
v_fma_f32 v142, v142, s48, -v15
v_fma_f32 v143, v143, s48, -v15
v_fma_f32 v144, v144, s48, -v11
v_fma_f32 v145, v145, s48, -v11
v_fma_f32 v146, v146, s48, -v11
v_fma_f32 v147, v147, s48, -v11
v_fma_f32 v148, v148, s48, -v11
v_fma_f32 v149, v149, s48, -v11
v_fma_f32 v150, v150, s48, -v11
v_fma_f32 v151, v151, s48, -v11
v_exp_f32 v136, v136
v_exp_f32 v137, v137
v_exp_f32 v138, v138
v_exp_f32 v139, v139
s_waitcnt vmcnt(7)
s_cbranch_vccnz L_sk59
s_waitcnt vmcnt(6)
L_sk59:
buffer_load_dwordx4 v4, s[16:19], s44 offen offset:3072 nt lds
v_exp_f32 v140, v140
v_exp_f32 v141, v141
v_exp_f32 v142, v142
v_exp_f32 v143, v143
v_exp_f32 v144, v144
v_exp_f32 v145, v145
v_exp_f32 v146, v146
v_exp_f32 v147, v147
ds_read_b128 v[88:91], v5 offset:0
ds_read_b128 v[92:95], v6 offset:0
ds_read_b128 v[96:99], v7 offset:0
ds_read_b128 v[100:103], v8 offset:0
s_add_u32 s44, s44, 0x8000
s_add_u32 m0, s47, 12288
s_waitcnt vmcnt(6)
buffer_load_dwordx4 v1, s[16:19], s44 offen offset:0 nt lds
s_barrier
s_waitcnt lgkmcnt(0)
v_mfma_f32_16x16x32_bf16 v[120:123], v[88:91], v[56:59], 0
v_mfma_f32_16x16x32_bf16 v[128:131], v[88:91], v[72:75], 0
v_exp_f32 v148, v148
v_mfma_f32_16x16x32_bf16 v[120:123], v[92:95], v[60:63], v[120:123]
v_mfma_f32_16x16x32_bf16 v[128:131], v[92:95], v[76:79], v[128:131]
v_exp_f32 v149, v149
v_mfma_f32_16x16x32_bf16 v[120:123], v[96:99], v[64:67], v[120:123]
v_mfma_f32_16x16x32_bf16 v[128:131], v[96:99], v[80:83], v[128:131]
v_exp_f32 v150, v150
v_mfma_f32_16x16x32_bf16 v[120:123], v[100:103], v[68:71], v[120:123]
v_mfma_f32_16x16x32_bf16 v[128:131], v[100:103], v[84:87], v[128:131]
v_exp_f32 v151, v151
s_cbranch_vccnz L_sk61
s_waitcnt vmcnt(6)
L_sk61:
buffer_load_dwordx4 v2, s[16:19], s44 offen offset:1024 nt lds
v_cvt_pk_bf16_f32 v152, v136, v137
v_cvt_pk_bf16_f32 v153, v138, v139
v_cvt_pk_bf16_f32 v154, v140, v141
v_cvt_pk_bf16_f32 v155, v142, v143
v_cvt_pk_bf16_f32 v156, v144, v145
v_cvt_pk_bf16_f32 v157, v146, v147
v_cvt_pk_bf16_f32 v158, v148, v149
v_cvt_pk_bf16_f32 v159, v150, v151
v_accvgpr_write_b32 a40, v152
v_accvgpr_write_b32 a41, v153
v_accvgpr_write_b32 a42, v154
v_accvgpr_write_b32 a43, v155
v_accvgpr_write_b32 a44, v156
v_accvgpr_write_b32 a45, v157
v_accvgpr_write_b32 a46, v158
v_accvgpr_write_b32 a47, v159
s_waitcnt vmcnt(6)
s_bitcmp1_b32 s88, 0
s_cbranch_scc0 L_ng62
s_waitcnt vmcnt(5)
L_ng62:
buffer_load_dwordx4 v3, s[16:19], s44 offen offset:2048 nt lds
v_fma_f32 v20, v20, v16, v136
v_fma_f32 v21, v21, v18, v144
v_add_f32 v20, v20, v137
v_add_f32 v21, v21, v145
v_add_f32 v20, v20, v138
v_add_f32 v21, v21, v146
v_add_f32 v20, v20, v139
v_add_f32 v21, v21, v147
v_add_f32 v20, v20, v140
v_add_f32 v21, v21, v148
v_add_f32 v20, v20, v141
v_add_f32 v21, v21, v149
v_add_f32 v20, v20, v142
v_add_f32 v21, v21, v150
v_add_f32 v20, v20, v143
v_add_f32 v21, v21, v151
s_cbranch_vccnz L_sk63
s_waitcnt vmcnt(6)
L_sk63:
buffer_load_dwordx4 v4, s[16:19], s44 offen offset:3072 nt lds
ds_read_b128 v[104:107], v5 offset:4096
ds_read_b128 v[108:111], v6 offset:4096
ds_read_b128 v[112:115], v7 offset:4096
ds_read_b128 v[116:119], v8 offset:4096
s_add_u32 s44, s44, 0x8000
s_add_u32 m0, s47, 0
s_waitcnt vmcnt(4)
buffer_load_dwordx4 v1, s[16:19], s44 offen offset:0 nt lds
s_barrier
s_waitcnt lgkmcnt(0)
v_mfma_f32_16x16x32_bf16 v[124:127], v[104:107], v[56:59], 0
v_mfma_f32_16x16x32_bf16 v[132:135], v[104:107], v[72:75], 0
v_mfma_f32_16x16x32_bf16 v[124:127], v[108:111], v[60:63], v[124:127]
v_mfma_f32_16x16x32_bf16 v[132:135], v[108:111], v[76:79], v[132:135]
v_mfma_f32_16x16x32_bf16 v[124:127], v[112:115], v[64:67], v[124:127]
v_mfma_f32_16x16x32_bf16 v[132:135], v[112:115], v[80:83], v[132:135]
v_mfma_f32_16x16x32_bf16 v[124:127], v[116:119], v[68:71], v[124:127]
v_mfma_f32_16x16x32_bf16 v[132:135], v[116:119], v[84:87], v[132:135]
s_cbranch_vccnz L_sk65
s_waitcnt vmcnt(4)
L_sk65:
buffer_load_dwordx4 v2, s[16:19], s44 offen offset:1024 nt lds
v_max3_f32 v13, v120, v121, v122
v_max3_f32 v14, v128, v129, v130
s_nop 2
v_max3_f32 v13, v13, v123, v124
v_max3_f32 v14, v14, v131, v132
v_max3_f32 v13, v13, v125, v126
v_max3_f32 v14, v14, v133, v134
v_max_f32 v13, v13, v127
v_max_f32 v14, v14, v135
s_nop 1
v_permlane32_swap_b32 v13, v14
v_max_f32 v13, v13, v14
v_mov_b32 v14, v13
s_nop 1
v_permlane16_swap_b32 v13, v14
v_max_f32 v13, v13, v14
v_mul_f32 v13, s48, v13
v_max_f32 v15, v12, v13
v_sub_f32 v14, v12, v15
v_exp_f32 v30, v14
v_mov_b32 v12, v15
v_mov_b32 v11, v15
v_mov_b32 v16, v30
v_mov_b32 v18, v30
v_permlane32_swap_b32 v15, v11
s_nop 0
v_permlane32_swap_b32 v16, v18
s_waitcnt vmcnt(5)
s_bitcmp1_b32 s88, 1
s_cbranch_scc1 L_sk66
s_waitcnt vmcnt(4)
L_sk66:
buffer_load_dwordx4 v3, s[16:19], s44 offen offset:2048 nt lds
v_and_b32 v241, 0xff, v10
v_lshrrev_b32 v10, 8, v10
v_cmp_le_u32 vcc, 3, v241
v_cmp_le_u32 s[90:91], 3, v10
s_nop 0
s_bcnt1_i32_b64 s88, vcc
s_bcnt1_i32_b64 s90, s[90:91]
s_add_u32 s90, s90, s88
s_add_u32 s90, s90, s43
s_cmp_ge_u32 s90, 15
s_cselect_b32 s88, 2, 0
s_cmp_le_u32 s90, 5
s_cselect_b32 s88, 1, s88
s_cmp_ge_u32 s90, 10
s_cselect_b64 vcc, -1, 0
v_fma_f32 v120, v120, s48, -v15
v_fma_f32 v121, v121, s48, -v15
v_fma_f32 v122, v122, s48, -v15
v_fma_f32 v123, v123, s48, -v15
v_fma_f32 v124, v124, s48, -v15
v_fma_f32 v125, v125, s48, -v15
v_fma_f32 v126, v126, s48, -v15
v_fma_f32 v127, v127, s48, -v15
v_fma_f32 v128, v128, s48, -v11
v_fma_f32 v129, v129, s48, -v11
v_fma_f32 v130, v130, s48, -v11
v_fma_f32 v131, v131, s48, -v11
v_fma_f32 v132, v132, s48, -v11
v_fma_f32 v133, v133, s48, -v11
v_fma_f32 v134, v134, s48, -v11
v_fma_f32 v135, v135, s48, -v11
v_exp_f32 v120, v120
v_exp_f32 v121, v121
v_exp_f32 v122, v122
v_exp_f32 v123, v123
s_waitcnt vmcnt(5)
s_cbranch_vccnz L_sk67
s_waitcnt vmcnt(4)
L_sk67:
buffer_load_dwordx4 v4, s[16:19], s44 offen offset:3072 nt lds
v_exp_f32 v124, v124
v_exp_f32 v125, v125
v_exp_f32 v126, v126
v_exp_f32 v127, v127
v_exp_f32 v128, v128
v_exp_f32 v129, v129
v_exp_f32 v130, v130
v_exp_f32 v131, v131
ds_read_b128 v[88:91], v5 offset:8192
ds_read_b128 v[92:95], v6 offset:8192
ds_read_b128 v[96:99], v7 offset:8192
ds_read_b128 v[100:103], v8 offset:8192
s_add_u32 s44, s44, 0x8000
s_add_u32 m0, s47, 4096
s_waitcnt vmcnt(4)
buffer_load_dwordx4 v1, s[16:19], s44 offen offset:0 nt lds
s_barrier
s_waitcnt lgkmcnt(0)
v_mfma_f32_16x16x32_bf16 v[136:139], v[88:91], v[56:59], 0
v_mfma_f32_16x16x32_bf16 v[144:147], v[88:91], v[72:75], 0
v_exp_f32 v132, v132
v_mfma_f32_16x16x32_bf16 v[136:139], v[92:95], v[60:63], v[136:139]
v_mfma_f32_16x16x32_bf16 v[144:147], v[92:95], v[76:79], v[144:147]
v_exp_f32 v133, v133
v_mfma_f32_16x16x32_bf16 v[136:139], v[96:99], v[64:67], v[136:139]
v_mfma_f32_16x16x32_bf16 v[144:147], v[96:99], v[80:83], v[144:147]
v_exp_f32 v134, v134
v_mfma_f32_16x16x32_bf16 v[136:139], v[100:103], v[68:71], v[136:139]
v_mfma_f32_16x16x32_bf16 v[144:147], v[100:103], v[84:87], v[144:147]
v_exp_f32 v135, v135
s_cbranch_vccnz L_sk69
s_waitcnt vmcnt(4)
L_sk69:
buffer_load_dwordx4 v2, s[16:19], s44 offen offset:1024 nt lds
v_cvt_pk_bf16_f32 v152, v120, v121
v_cvt_pk_bf16_f32 v153, v122, v123
v_cvt_pk_bf16_f32 v154, v124, v125
v_cvt_pk_bf16_f32 v155, v126, v127
v_cvt_pk_bf16_f32 v156, v128, v129
v_cvt_pk_bf16_f32 v157, v130, v131
v_cvt_pk_bf16_f32 v158, v132, v133
v_cvt_pk_bf16_f32 v159, v134, v135
v_accvgpr_write_b32 a48, v152
v_accvgpr_write_b32 a49, v153
v_accvgpr_write_b32 a50, v154
v_accvgpr_write_b32 a51, v155
v_accvgpr_write_b32 a52, v156
v_accvgpr_write_b32 a53, v157
v_accvgpr_write_b32 a54, v158
v_accvgpr_write_b32 a55, v159
s_waitcnt vmcnt(4)
s_bitcmp1_b32 s88, 0
s_cbranch_scc0 L_ng70
s_waitcnt vmcnt(3)
L_ng70:
buffer_load_dwordx4 v3, s[16:19], s44 offen offset:2048 nt lds
v_fma_f32 v20, v20, v16, v120
v_fma_f32 v21, v21, v18, v128
v_add_f32 v20, v20, v121
v_add_f32 v21, v21, v129
v_add_f32 v20, v20, v122
v_add_f32 v21, v21, v130
v_add_f32 v20, v20, v123
v_add_f32 v21, v21, v131
v_add_f32 v20, v20, v124
v_add_f32 v21, v21, v132
v_add_f32 v20, v20, v125
v_add_f32 v21, v21, v133
v_add_f32 v20, v20, v126
v_add_f32 v21, v21, v134
v_add_f32 v20, v20, v127
v_add_f32 v21, v21, v135
s_cbranch_vccnz L_sk71
s_waitcnt vmcnt(4)
L_sk71:
buffer_load_dwordx4 v4, s[16:19], s44 offen offset:3072 nt lds
ds_read_b128 v[104:107], v5 offset:12288
ds_read_b128 v[108:111], v6 offset:12288
ds_read_b128 v[112:115], v7 offset:12288
ds_read_b128 v[116:119], v8 offset:12288
s_add_u32 s44, s44, 0x8000
s_add_u32 m0, s47, 8192
s_waitcnt vmcnt(4)
buffer_load_dwordx4 v1, s[16:19], s44 offen offset:0 nt lds
s_barrier
s_waitcnt lgkmcnt(0)
v_mfma_f32_16x16x32_bf16 v[140:143], v[104:107], v[56:59], 0
v_mfma_f32_16x16x32_bf16 v[148:151], v[104:107], v[72:75], 0
v_mfma_f32_16x16x32_bf16 v[140:143], v[108:111], v[60:63], v[140:143]
v_mfma_f32_16x16x32_bf16 v[148:151], v[108:111], v[76:79], v[148:151]
v_mfma_f32_16x16x32_bf16 v[140:143], v[112:115], v[64:67], v[140:143]
v_mfma_f32_16x16x32_bf16 v[148:151], v[112:115], v[80:83], v[148:151]
v_mfma_f32_16x16x32_bf16 v[140:143], v[116:119], v[68:71], v[140:143]
v_mfma_f32_16x16x32_bf16 v[148:151], v[116:119], v[84:87], v[148:151]
s_cbranch_vccnz L_sk73
s_waitcnt vmcnt(4)
L_sk73:
buffer_load_dwordx4 v2, s[16:19], s44 offen offset:1024 nt lds
v_max3_f32 v13, v136, v137, v138
v_max3_f32 v14, v144, v145, v146
s_nop 2
v_max3_f32 v13, v13, v139, v140
v_max3_f32 v14, v14, v147, v148
v_max3_f32 v13, v13, v141, v142
v_max3_f32 v14, v14, v149, v150
v_max_f32 v13, v13, v143
v_max_f32 v14, v14, v151
s_nop 1
v_permlane32_swap_b32 v13, v14
v_max_f32 v13, v13, v14
v_mov_b32 v14, v13
s_nop 1
v_permlane16_swap_b32 v13, v14
v_max_f32 v13, v13, v14
v_mul_f32 v13, s48, v13
v_max_f32 v15, v12, v13
v_sub_f32 v14, v12, v15
v_exp_f32 v31, v14
v_mov_b32 v12, v15
v_mov_b32 v11, v15
v_mov_b32 v16, v31
v_mov_b32 v18, v31
v_permlane32_swap_b32 v15, v11
s_nop 0
v_permlane32_swap_b32 v16, v18
s_waitcnt vmcnt(5)
s_bitcmp1_b32 s88, 1
s_cbranch_scc1 L_sk74
s_waitcnt vmcnt(4)
L_sk74:
buffer_load_dwordx4 v3, s[16:19], s44 offen offset:2048 nt lds
v_mov_b32 v241, 4
s_mov_b64 exec, 1
buffer_store_byte v241, v22, s[36:39], s42 offen
s_mov_b64 exec, -1
buffer_load_ushort v10, v240, s[36:39], 0 offen offset:128 nt
v_fma_f32 v136, v136, s48, -v15
v_fma_f32 v137, v137, s48, -v15
v_fma_f32 v138, v138, s48, -v15
v_fma_f32 v139, v139, s48, -v15
v_fma_f32 v140, v140, s48, -v15
v_fma_f32 v141, v141, s48, -v15
v_fma_f32 v142, v142, s48, -v15
v_fma_f32 v143, v143, s48, -v15
v_fma_f32 v144, v144, s48, -v11
v_fma_f32 v145, v145, s48, -v11
v_fma_f32 v146, v146, s48, -v11
v_fma_f32 v147, v147, s48, -v11
v_fma_f32 v148, v148, s48, -v11
v_fma_f32 v149, v149, s48, -v11
v_fma_f32 v150, v150, s48, -v11
v_fma_f32 v151, v151, s48, -v11
v_exp_f32 v136, v136
v_exp_f32 v137, v137
v_exp_f32 v138, v138
v_exp_f32 v139, v139
s_waitcnt vmcnt(7)
s_cbranch_vccnz L_sk75
s_waitcnt vmcnt(6)
L_sk75:
buffer_load_dwordx4 v4, s[16:19], s44 offen offset:3072 nt lds
v_exp_f32 v140, v140
v_exp_f32 v141, v141
v_exp_f32 v142, v142
v_exp_f32 v143, v143
v_exp_f32 v144, v144
v_exp_f32 v145, v145
v_exp_f32 v146, v146
v_exp_f32 v147, v147
ds_read_b128 v[88:91], v5 offset:0
ds_read_b128 v[92:95], v6 offset:0
ds_read_b128 v[96:99], v7 offset:0
ds_read_b128 v[100:103], v8 offset:0
s_add_u32 s44, s44, 0x8000
s_add_u32 m0, s47, 12288
s_waitcnt vmcnt(6)
buffer_load_dwordx4 v1, s[16:19], s44 offen offset:0 nt lds
s_barrier
s_waitcnt lgkmcnt(0)
v_mfma_f32_16x16x32_bf16 v[120:123], v[88:91], v[56:59], 0
v_mfma_f32_16x16x32_bf16 v[128:131], v[88:91], v[72:75], 0
v_exp_f32 v148, v148
v_mfma_f32_16x16x32_bf16 v[120:123], v[92:95], v[60:63], v[120:123]
v_mfma_f32_16x16x32_bf16 v[128:131], v[92:95], v[76:79], v[128:131]
v_exp_f32 v149, v149
v_mfma_f32_16x16x32_bf16 v[120:123], v[96:99], v[64:67], v[120:123]
v_mfma_f32_16x16x32_bf16 v[128:131], v[96:99], v[80:83], v[128:131]
v_exp_f32 v150, v150
v_mfma_f32_16x16x32_bf16 v[120:123], v[100:103], v[68:71], v[120:123]
v_mfma_f32_16x16x32_bf16 v[128:131], v[100:103], v[84:87], v[128:131]
v_exp_f32 v151, v151
s_cbranch_vccnz L_sk77
s_waitcnt vmcnt(6)
L_sk77:
buffer_load_dwordx4 v2, s[16:19], s44 offen offset:1024 nt lds
v_cvt_pk_bf16_f32 v152, v136, v137
v_cvt_pk_bf16_f32 v153, v138, v139
v_cvt_pk_bf16_f32 v154, v140, v141
v_cvt_pk_bf16_f32 v155, v142, v143
v_cvt_pk_bf16_f32 v156, v144, v145
v_cvt_pk_bf16_f32 v157, v146, v147
v_cvt_pk_bf16_f32 v158, v148, v149
v_cvt_pk_bf16_f32 v159, v150, v151
v_accvgpr_write_b32 a56, v152
v_accvgpr_write_b32 a57, v153
v_accvgpr_write_b32 a58, v154
v_accvgpr_write_b32 a59, v155
v_accvgpr_write_b32 a60, v156
v_accvgpr_write_b32 a61, v157
v_accvgpr_write_b32 a62, v158
v_accvgpr_write_b32 a63, v159
s_waitcnt vmcnt(6)
s_bitcmp1_b32 s88, 0
s_cbranch_scc0 L_ng78
s_waitcnt vmcnt(5)
L_ng78:
buffer_load_dwordx4 v3, s[16:19], s44 offen offset:2048 nt lds
v_fma_f32 v20, v20, v16, v136
v_fma_f32 v21, v21, v18, v144
v_add_f32 v20, v20, v137
v_add_f32 v21, v21, v145
v_add_f32 v20, v20, v138
v_add_f32 v21, v21, v146
v_add_f32 v20, v20, v139
v_add_f32 v21, v21, v147
v_add_f32 v20, v20, v140
v_add_f32 v21, v21, v148
v_add_f32 v20, v20, v141
v_add_f32 v21, v21, v149
v_add_f32 v20, v20, v142
v_add_f32 v21, v21, v150
v_add_f32 v20, v20, v143
v_add_f32 v21, v21, v151
s_cbranch_vccnz L_sk79
s_waitcnt vmcnt(6)
L_sk79:
buffer_load_dwordx4 v4, s[16:19], s44 offen offset:3072 nt lds
ds_read_b128 v[104:107], v5 offset:4096
ds_read_b128 v[108:111], v6 offset:4096
ds_read_b128 v[112:115], v7 offset:4096
ds_read_b128 v[116:119], v8 offset:4096
s_add_u32 s44, s44, 0x8000
s_add_u32 m0, s47, 0
s_waitcnt vmcnt(4)
buffer_load_dwordx4 v1, s[16:19], s44 offen offset:0 nt lds
s_barrier
s_waitcnt lgkmcnt(0)
v_mfma_f32_16x16x32_bf16 v[124:127], v[104:107], v[56:59], 0
v_mfma_f32_16x16x32_bf16 v[132:135], v[104:107], v[72:75], 0
v_mfma_f32_16x16x32_bf16 v[124:127], v[108:111], v[60:63], v[124:127]
v_mfma_f32_16x16x32_bf16 v[132:135], v[108:111], v[76:79], v[132:135]
v_mfma_f32_16x16x32_bf16 v[124:127], v[112:115], v[64:67], v[124:127]
v_mfma_f32_16x16x32_bf16 v[132:135], v[112:115], v[80:83], v[132:135]
v_mfma_f32_16x16x32_bf16 v[124:127], v[116:119], v[68:71], v[124:127]
v_mfma_f32_16x16x32_bf16 v[132:135], v[116:119], v[84:87], v[132:135]
s_cbranch_vccnz L_sk81
s_waitcnt vmcnt(4)
L_sk81:
buffer_load_dwordx4 v2, s[16:19], s44 offen offset:1024 nt lds
v_max3_f32 v13, v120, v121, v122
v_max3_f32 v14, v128, v129, v130
s_nop 2
v_max3_f32 v13, v13, v123, v124
v_max3_f32 v14, v14, v131, v132
v_max3_f32 v13, v13, v125, v126
v_max3_f32 v14, v14, v133, v134
v_max_f32 v13, v13, v127
v_max_f32 v14, v14, v135
s_nop 1
v_permlane32_swap_b32 v13, v14
v_max_f32 v13, v13, v14
v_mov_b32 v14, v13
s_nop 1
v_permlane16_swap_b32 v13, v14
v_max_f32 v13, v13, v14
v_mul_f32 v13, s48, v13
v_max_f32 v15, v12, v13
v_sub_f32 v14, v12, v15
v_exp_f32 v32, v14
v_mov_b32 v12, v15
v_mov_b32 v11, v15
v_mov_b32 v16, v32
v_mov_b32 v18, v32
v_permlane32_swap_b32 v15, v11
s_nop 0
v_permlane32_swap_b32 v16, v18
s_waitcnt vmcnt(5)
s_bitcmp1_b32 s88, 1
s_cbranch_scc1 L_sk82
s_waitcnt vmcnt(4)
L_sk82:
buffer_load_dwordx4 v3, s[16:19], s44 offen offset:2048 nt lds
v_and_b32 v241, 0xff, v10
v_lshrrev_b32 v10, 8, v10
v_cmp_le_u32 vcc, 4, v241
v_cmp_le_u32 s[90:91], 4, v10
s_nop 0
s_bcnt1_i32_b64 s88, vcc
s_bcnt1_i32_b64 s90, s[90:91]
s_add_u32 s90, s90, s88
s_add_u32 s90, s90, s43
s_cmp_ge_u32 s90, 15
s_cselect_b32 s88, 2, 0
s_cmp_le_u32 s90, 5
s_cselect_b32 s88, 1, s88
s_cmp_ge_u32 s90, 10
s_cselect_b64 vcc, -1, 0
v_fma_f32 v120, v120, s48, -v15
v_fma_f32 v121, v121, s48, -v15
v_fma_f32 v122, v122, s48, -v15
v_fma_f32 v123, v123, s48, -v15
v_fma_f32 v124, v124, s48, -v15
v_fma_f32 v125, v125, s48, -v15
v_fma_f32 v126, v126, s48, -v15
v_fma_f32 v127, v127, s48, -v15
v_fma_f32 v128, v128, s48, -v11
v_fma_f32 v129, v129, s48, -v11
v_fma_f32 v130, v130, s48, -v11
v_fma_f32 v131, v131, s48, -v11
v_fma_f32 v132, v132, s48, -v11
v_fma_f32 v133, v133, s48, -v11
v_fma_f32 v134, v134, s48, -v11
v_fma_f32 v135, v135, s48, -v11
v_exp_f32 v120, v120
v_exp_f32 v121, v121
v_exp_f32 v122, v122
v_exp_f32 v123, v123
s_waitcnt vmcnt(5)
s_cbranch_vccnz L_sk83
s_waitcnt vmcnt(4)
L_sk83:
buffer_load_dwordx4 v4, s[16:19], s44 offen offset:3072 nt lds
v_exp_f32 v124, v124
v_exp_f32 v125, v125
v_exp_f32 v126, v126
v_exp_f32 v127, v127
v_exp_f32 v128, v128
v_exp_f32 v129, v129
v_exp_f32 v130, v130
v_exp_f32 v131, v131
ds_read_b128 v[88:91], v5 offset:8192
ds_read_b128 v[92:95], v6 offset:8192
ds_read_b128 v[96:99], v7 offset:8192
ds_read_b128 v[100:103], v8 offset:8192
s_add_u32 s44, s44, 0x8000
s_add_u32 m0, s47, 4096
s_waitcnt vmcnt(4)
buffer_load_dwordx4 v1, s[16:19], s44 offen offset:0 nt lds
s_barrier
s_waitcnt lgkmcnt(0)
v_mfma_f32_16x16x32_bf16 v[136:139], v[88:91], v[56:59], 0
v_mfma_f32_16x16x32_bf16 v[144:147], v[88:91], v[72:75], 0
v_exp_f32 v132, v132
v_mfma_f32_16x16x32_bf16 v[136:139], v[92:95], v[60:63], v[136:139]
v_mfma_f32_16x16x32_bf16 v[144:147], v[92:95], v[76:79], v[144:147]
v_exp_f32 v133, v133
v_mfma_f32_16x16x32_bf16 v[136:139], v[96:99], v[64:67], v[136:139]
v_mfma_f32_16x16x32_bf16 v[144:147], v[96:99], v[80:83], v[144:147]
v_exp_f32 v134, v134
v_mfma_f32_16x16x32_bf16 v[136:139], v[100:103], v[68:71], v[136:139]
v_mfma_f32_16x16x32_bf16 v[144:147], v[100:103], v[84:87], v[144:147]
v_exp_f32 v135, v135
s_cbranch_vccnz L_sk85
s_waitcnt vmcnt(4)
L_sk85:
buffer_load_dwordx4 v2, s[16:19], s44 offen offset:1024 nt lds
v_cvt_pk_bf16_f32 v152, v120, v121
v_cvt_pk_bf16_f32 v153, v122, v123
v_cvt_pk_bf16_f32 v154, v124, v125
v_cvt_pk_bf16_f32 v155, v126, v127
v_cvt_pk_bf16_f32 v156, v128, v129
v_cvt_pk_bf16_f32 v157, v130, v131
v_cvt_pk_bf16_f32 v158, v132, v133
v_cvt_pk_bf16_f32 v159, v134, v135
v_accvgpr_write_b32 a64, v152
v_accvgpr_write_b32 a65, v153
v_accvgpr_write_b32 a66, v154
v_accvgpr_write_b32 a67, v155
v_accvgpr_write_b32 a68, v156
v_accvgpr_write_b32 a69, v157
v_accvgpr_write_b32 a70, v158
v_accvgpr_write_b32 a71, v159
s_waitcnt vmcnt(4)
s_bitcmp1_b32 s88, 0
s_cbranch_scc0 L_ng86
s_waitcnt vmcnt(3)
L_ng86:
buffer_load_dwordx4 v3, s[16:19], s44 offen offset:2048 nt lds
v_fma_f32 v20, v20, v16, v120
v_fma_f32 v21, v21, v18, v128
v_add_f32 v20, v20, v121
v_add_f32 v21, v21, v129
v_add_f32 v20, v20, v122
v_add_f32 v21, v21, v130
v_add_f32 v20, v20, v123
v_add_f32 v21, v21, v131
v_add_f32 v20, v20, v124
v_add_f32 v21, v21, v132
v_add_f32 v20, v20, v125
v_add_f32 v21, v21, v133
v_add_f32 v20, v20, v126
v_add_f32 v21, v21, v134
v_add_f32 v20, v20, v127
v_add_f32 v21, v21, v135
s_cbranch_vccnz L_sk87
s_waitcnt vmcnt(4)
L_sk87:
buffer_load_dwordx4 v4, s[16:19], s44 offen offset:3072 nt lds
ds_read_b128 v[104:107], v5 offset:12288
ds_read_b128 v[108:111], v6 offset:12288
ds_read_b128 v[112:115], v7 offset:12288
ds_read_b128 v[116:119], v8 offset:12288
s_add_u32 s44, s44, 0x8000
s_add_u32 m0, s47, 8192
s_waitcnt vmcnt(4)
buffer_load_dwordx4 v1, s[16:19], s44 offen offset:0 nt lds
s_barrier
s_waitcnt lgkmcnt(0)
v_mfma_f32_16x16x32_bf16 v[140:143], v[104:107], v[56:59], 0
v_mfma_f32_16x16x32_bf16 v[148:151], v[104:107], v[72:75], 0
v_mfma_f32_16x16x32_bf16 v[140:143], v[108:111], v[60:63], v[140:143]
v_mfma_f32_16x16x32_bf16 v[148:151], v[108:111], v[76:79], v[148:151]
v_mfma_f32_16x16x32_bf16 v[140:143], v[112:115], v[64:67], v[140:143]
v_mfma_f32_16x16x32_bf16 v[148:151], v[112:115], v[80:83], v[148:151]
v_mfma_f32_16x16x32_bf16 v[140:143], v[116:119], v[68:71], v[140:143]
v_mfma_f32_16x16x32_bf16 v[148:151], v[116:119], v[84:87], v[148:151]
s_cbranch_vccnz L_sk89
s_waitcnt vmcnt(4)
L_sk89:
buffer_load_dwordx4 v2, s[16:19], s44 offen offset:1024 nt lds
v_max3_f32 v13, v136, v137, v138
v_max3_f32 v14, v144, v145, v146
s_nop 2
v_max3_f32 v13, v13, v139, v140
v_max3_f32 v14, v14, v147, v148
v_max3_f32 v13, v13, v141, v142
v_max3_f32 v14, v14, v149, v150
v_max_f32 v13, v13, v143
v_max_f32 v14, v14, v151
s_nop 1
v_permlane32_swap_b32 v13, v14
v_max_f32 v13, v13, v14
v_mov_b32 v14, v13
s_nop 1
v_permlane16_swap_b32 v13, v14
v_max_f32 v13, v13, v14
v_mul_f32 v13, s48, v13
v_max_f32 v15, v12, v13
v_sub_f32 v14, v12, v15
v_exp_f32 v33, v14
v_mov_b32 v12, v15
v_mov_b32 v11, v15
v_mov_b32 v16, v33
v_mov_b32 v18, v33
v_permlane32_swap_b32 v15, v11
s_nop 0
v_permlane32_swap_b32 v16, v18
s_waitcnt vmcnt(5)
s_bitcmp1_b32 s88, 1
s_cbranch_scc1 L_sk90
s_waitcnt vmcnt(4)
L_sk90:
buffer_load_dwordx4 v3, s[16:19], s44 offen offset:2048 nt lds
v_mov_b32 v241, 5
s_mov_b64 exec, 1
buffer_store_byte v241, v22, s[36:39], s42 offen
s_mov_b64 exec, -1
buffer_load_ushort v10, v240, s[36:39], 0 offen offset:128 nt
v_fma_f32 v136, v136, s48, -v15
v_fma_f32 v137, v137, s48, -v15
v_fma_f32 v138, v138, s48, -v15
v_fma_f32 v139, v139, s48, -v15
v_fma_f32 v140, v140, s48, -v15
v_fma_f32 v141, v141, s48, -v15
v_fma_f32 v142, v142, s48, -v15
v_fma_f32 v143, v143, s48, -v15
v_fma_f32 v144, v144, s48, -v11
v_fma_f32 v145, v145, s48, -v11
v_fma_f32 v146, v146, s48, -v11
v_fma_f32 v147, v147, s48, -v11
v_fma_f32 v148, v148, s48, -v11
v_fma_f32 v149, v149, s48, -v11
v_fma_f32 v150, v150, s48, -v11
v_fma_f32 v151, v151, s48, -v11
v_exp_f32 v136, v136
v_exp_f32 v137, v137
v_exp_f32 v138, v138
v_exp_f32 v139, v139
s_waitcnt vmcnt(7)
s_cbranch_vccnz L_sk91
s_waitcnt vmcnt(6)
L_sk91:
buffer_load_dwordx4 v4, s[16:19], s44 offen offset:3072 nt lds
v_exp_f32 v140, v140
v_exp_f32 v141, v141
v_exp_f32 v142, v142
v_exp_f32 v143, v143
v_exp_f32 v144, v144
v_exp_f32 v145, v145
v_exp_f32 v146, v146
v_exp_f32 v147, v147
ds_read_b128 v[88:91], v5 offset:0
ds_read_b128 v[92:95], v6 offset:0
ds_read_b128 v[96:99], v7 offset:0
ds_read_b128 v[100:103], v8 offset:0
s_add_u32 s44, s44, 0x8000
s_add_u32 m0, s47, 12288
s_waitcnt vmcnt(6)
buffer_load_dwordx4 v1, s[16:19], s44 offen offset:0 nt lds
s_barrier
s_waitcnt lgkmcnt(0)
v_mfma_f32_16x16x32_bf16 v[120:123], v[88:91], v[56:59], 0
v_mfma_f32_16x16x32_bf16 v[128:131], v[88:91], v[72:75], 0
v_exp_f32 v148, v148
v_mfma_f32_16x16x32_bf16 v[120:123], v[92:95], v[60:63], v[120:123]
v_mfma_f32_16x16x32_bf16 v[128:131], v[92:95], v[76:79], v[128:131]
v_exp_f32 v149, v149
v_mfma_f32_16x16x32_bf16 v[120:123], v[96:99], v[64:67], v[120:123]
v_mfma_f32_16x16x32_bf16 v[128:131], v[96:99], v[80:83], v[128:131]
v_exp_f32 v150, v150
v_mfma_f32_16x16x32_bf16 v[120:123], v[100:103], v[68:71], v[120:123]
v_mfma_f32_16x16x32_bf16 v[128:131], v[100:103], v[84:87], v[128:131]
v_exp_f32 v151, v151
s_cbranch_vccnz L_sk93
s_waitcnt vmcnt(6)
L_sk93:
buffer_load_dwordx4 v2, s[16:19], s44 offen offset:1024 nt lds
v_cvt_pk_bf16_f32 v152, v136, v137
v_cvt_pk_bf16_f32 v153, v138, v139
v_cvt_pk_bf16_f32 v154, v140, v141
v_cvt_pk_bf16_f32 v155, v142, v143
v_cvt_pk_bf16_f32 v156, v144, v145
v_cvt_pk_bf16_f32 v157, v146, v147
v_cvt_pk_bf16_f32 v158, v148, v149
v_cvt_pk_bf16_f32 v159, v150, v151
v_accvgpr_write_b32 a72, v152
v_accvgpr_write_b32 a73, v153
v_accvgpr_write_b32 a74, v154
v_accvgpr_write_b32 a75, v155
v_accvgpr_write_b32 a76, v156
v_accvgpr_write_b32 a77, v157
v_accvgpr_write_b32 a78, v158
v_accvgpr_write_b32 a79, v159
s_waitcnt vmcnt(6)
s_bitcmp1_b32 s88, 0
s_cbranch_scc0 L_ng94
s_waitcnt vmcnt(5)
L_ng94:
buffer_load_dwordx4 v3, s[16:19], s44 offen offset:2048 nt lds
v_fma_f32 v20, v20, v16, v136
v_fma_f32 v21, v21, v18, v144
v_add_f32 v20, v20, v137
v_add_f32 v21, v21, v145
v_add_f32 v20, v20, v138
v_add_f32 v21, v21, v146
v_add_f32 v20, v20, v139
v_add_f32 v21, v21, v147
v_add_f32 v20, v20, v140
v_add_f32 v21, v21, v148
v_add_f32 v20, v20, v141
v_add_f32 v21, v21, v149
v_add_f32 v20, v20, v142
v_add_f32 v21, v21, v150
v_add_f32 v20, v20, v143
v_add_f32 v21, v21, v151
s_cbranch_vccnz L_sk95
s_waitcnt vmcnt(6)
L_sk95:
buffer_load_dwordx4 v4, s[16:19], s44 offen offset:3072 nt lds
ds_read_b128 v[104:107], v5 offset:4096
ds_read_b128 v[108:111], v6 offset:4096
ds_read_b128 v[112:115], v7 offset:4096
ds_read_b128 v[116:119], v8 offset:4096
s_add_u32 s44, s44, 0x8000
s_add_u32 m0, s47, 0
s_waitcnt vmcnt(4)
buffer_load_dwordx4 v1, s[16:19], s44 offen offset:0 nt lds
s_barrier
s_waitcnt lgkmcnt(0)
v_mfma_f32_16x16x32_bf16 v[124:127], v[104:107], v[56:59], 0
v_mfma_f32_16x16x32_bf16 v[132:135], v[104:107], v[72:75], 0
v_mfma_f32_16x16x32_bf16 v[124:127], v[108:111], v[60:63], v[124:127]
v_mfma_f32_16x16x32_bf16 v[132:135], v[108:111], v[76:79], v[132:135]
v_mfma_f32_16x16x32_bf16 v[124:127], v[112:115], v[64:67], v[124:127]
v_mfma_f32_16x16x32_bf16 v[132:135], v[112:115], v[80:83], v[132:135]
v_mfma_f32_16x16x32_bf16 v[124:127], v[116:119], v[68:71], v[124:127]
v_mfma_f32_16x16x32_bf16 v[132:135], v[116:119], v[84:87], v[132:135]
s_cbranch_vccnz L_sk97
s_waitcnt vmcnt(4)
L_sk97:
buffer_load_dwordx4 v2, s[16:19], s44 offen offset:1024 nt lds
v_max3_f32 v13, v120, v121, v122
v_max3_f32 v14, v128, v129, v130
s_nop 2
v_max3_f32 v13, v13, v123, v124
v_max3_f32 v14, v14, v131, v132
v_max3_f32 v13, v13, v125, v126
v_max3_f32 v14, v14, v133, v134
v_max_f32 v13, v13, v127
v_max_f32 v14, v14, v135
s_nop 1
v_permlane32_swap_b32 v13, v14
v_max_f32 v13, v13, v14
v_mov_b32 v14, v13
s_nop 1
v_permlane16_swap_b32 v13, v14
v_max_f32 v13, v13, v14
v_mul_f32 v13, s48, v13
v_max_f32 v15, v12, v13
v_sub_f32 v14, v12, v15
v_exp_f32 v34, v14
v_mov_b32 v12, v15
v_mov_b32 v11, v15
v_mov_b32 v16, v34
v_mov_b32 v18, v34
v_permlane32_swap_b32 v15, v11
s_nop 0
v_permlane32_swap_b32 v16, v18
s_waitcnt vmcnt(5)
s_bitcmp1_b32 s88, 1
s_cbranch_scc1 L_sk98
s_waitcnt vmcnt(4)
L_sk98:
buffer_load_dwordx4 v3, s[16:19], s44 offen offset:2048 nt lds
v_and_b32 v241, 0xff, v10
v_lshrrev_b32 v10, 8, v10
v_cmp_le_u32 vcc, 5, v241
v_cmp_le_u32 s[90:91], 5, v10
s_nop 0
s_bcnt1_i32_b64 s88, vcc
s_bcnt1_i32_b64 s90, s[90:91]
s_add_u32 s90, s90, s88
s_add_u32 s90, s90, s43
s_cmp_ge_u32 s90, 15
s_cselect_b32 s88, 2, 0
s_cmp_le_u32 s90, 5
s_cselect_b32 s88, 1, s88
s_cmp_ge_u32 s90, 10
s_cselect_b64 vcc, -1, 0
v_fma_f32 v120, v120, s48, -v15
v_fma_f32 v121, v121, s48, -v15
v_fma_f32 v122, v122, s48, -v15
v_fma_f32 v123, v123, s48, -v15
v_fma_f32 v124, v124, s48, -v15
v_fma_f32 v125, v125, s48, -v15
v_fma_f32 v126, v126, s48, -v15
v_fma_f32 v127, v127, s48, -v15
v_fma_f32 v128, v128, s48, -v11
v_fma_f32 v129, v129, s48, -v11
v_fma_f32 v130, v130, s48, -v11
v_fma_f32 v131, v131, s48, -v11
v_fma_f32 v132, v132, s48, -v11
v_fma_f32 v133, v133, s48, -v11
v_fma_f32 v134, v134, s48, -v11
v_fma_f32 v135, v135, s48, -v11
v_exp_f32 v120, v120
v_exp_f32 v121, v121
v_exp_f32 v122, v122
v_exp_f32 v123, v123
s_waitcnt vmcnt(5)
s_cbranch_vccnz L_sk99
s_waitcnt vmcnt(4)
L_sk99:
buffer_load_dwordx4 v4, s[16:19], s44 offen offset:3072 nt lds
v_exp_f32 v124, v124
v_exp_f32 v125, v125
v_exp_f32 v126, v126
v_exp_f32 v127, v127
v_exp_f32 v128, v128
v_exp_f32 v129, v129
v_exp_f32 v130, v130
v_exp_f32 v131, v131
ds_read_b128 v[88:91], v5 offset:8192
ds_read_b128 v[92:95], v6 offset:8192
ds_read_b128 v[96:99], v7 offset:8192
ds_read_b128 v[100:103], v8 offset:8192
s_add_u32 s44, s44, 0x8000
s_add_u32 m0, s47, 4096
s_waitcnt vmcnt(4)
buffer_load_dwordx4 v1, s[16:19], s44 offen offset:0 nt lds
s_barrier
s_waitcnt lgkmcnt(0)
v_mfma_f32_16x16x32_bf16 v[136:139], v[88:91], v[56:59], 0
v_mfma_f32_16x16x32_bf16 v[144:147], v[88:91], v[72:75], 0
v_exp_f32 v132, v132
v_mfma_f32_16x16x32_bf16 v[136:139], v[92:95], v[60:63], v[136:139]
v_mfma_f32_16x16x32_bf16 v[144:147], v[92:95], v[76:79], v[144:147]
v_exp_f32 v133, v133
v_mfma_f32_16x16x32_bf16 v[136:139], v[96:99], v[64:67], v[136:139]
v_mfma_f32_16x16x32_bf16 v[144:147], v[96:99], v[80:83], v[144:147]
v_exp_f32 v134, v134
v_mfma_f32_16x16x32_bf16 v[136:139], v[100:103], v[68:71], v[136:139]
v_mfma_f32_16x16x32_bf16 v[144:147], v[100:103], v[84:87], v[144:147]
v_exp_f32 v135, v135
s_cbranch_vccnz L_sk101
s_waitcnt vmcnt(4)
L_sk101:
buffer_load_dwordx4 v2, s[16:19], s44 offen offset:1024 nt lds
v_cvt_pk_bf16_f32 v152, v120, v121
v_cvt_pk_bf16_f32 v153, v122, v123
v_cvt_pk_bf16_f32 v154, v124, v125
v_cvt_pk_bf16_f32 v155, v126, v127
v_cvt_pk_bf16_f32 v156, v128, v129
v_cvt_pk_bf16_f32 v157, v130, v131
v_cvt_pk_bf16_f32 v158, v132, v133
v_cvt_pk_bf16_f32 v159, v134, v135
v_accvgpr_write_b32 a80, v152
v_accvgpr_write_b32 a81, v153
v_accvgpr_write_b32 a82, v154
v_accvgpr_write_b32 a83, v155
v_accvgpr_write_b32 a84, v156
v_accvgpr_write_b32 a85, v157
v_accvgpr_write_b32 a86, v158
v_accvgpr_write_b32 a87, v159
s_waitcnt vmcnt(4)
s_bitcmp1_b32 s88, 0
s_cbranch_scc0 L_ng102
s_waitcnt vmcnt(3)
L_ng102:
buffer_load_dwordx4 v3, s[16:19], s44 offen offset:2048 nt lds
v_fma_f32 v20, v20, v16, v120
v_fma_f32 v21, v21, v18, v128
v_add_f32 v20, v20, v121
v_add_f32 v21, v21, v129
v_add_f32 v20, v20, v122
v_add_f32 v21, v21, v130
v_add_f32 v20, v20, v123
v_add_f32 v21, v21, v131
v_add_f32 v20, v20, v124
v_add_f32 v21, v21, v132
v_add_f32 v20, v20, v125
v_add_f32 v21, v21, v133
v_add_f32 v20, v20, v126
v_add_f32 v21, v21, v134
v_add_f32 v20, v20, v127
v_add_f32 v21, v21, v135
s_cbranch_vccnz L_sk103
s_waitcnt vmcnt(4)
L_sk103:
buffer_load_dwordx4 v4, s[16:19], s44 offen offset:3072 nt lds
ds_read_b128 v[104:107], v5 offset:12288
ds_read_b128 v[108:111], v6 offset:12288
ds_read_b128 v[112:115], v7 offset:12288
ds_read_b128 v[116:119], v8 offset:12288
s_add_u32 s44, s44, 0x8000
s_add_u32 m0, s47, 8192
s_waitcnt vmcnt(4)
buffer_load_dwordx4 v1, s[16:19], s44 offen offset:0 nt lds
s_barrier
s_waitcnt lgkmcnt(0)
v_mfma_f32_16x16x32_bf16 v[140:143], v[104:107], v[56:59], 0
v_mfma_f32_16x16x32_bf16 v[148:151], v[104:107], v[72:75], 0
v_mfma_f32_16x16x32_bf16 v[140:143], v[108:111], v[60:63], v[140:143]
v_mfma_f32_16x16x32_bf16 v[148:151], v[108:111], v[76:79], v[148:151]
v_mfma_f32_16x16x32_bf16 v[140:143], v[112:115], v[64:67], v[140:143]
v_mfma_f32_16x16x32_bf16 v[148:151], v[112:115], v[80:83], v[148:151]
v_mfma_f32_16x16x32_bf16 v[140:143], v[116:119], v[68:71], v[140:143]
v_mfma_f32_16x16x32_bf16 v[148:151], v[116:119], v[84:87], v[148:151]
s_cbranch_vccnz L_sk105
s_waitcnt vmcnt(4)
L_sk105:
buffer_load_dwordx4 v2, s[16:19], s44 offen offset:1024 nt lds
v_max3_f32 v13, v136, v137, v138
v_max3_f32 v14, v144, v145, v146
s_nop 2
v_max3_f32 v13, v13, v139, v140
v_max3_f32 v14, v14, v147, v148
v_max3_f32 v13, v13, v141, v142
v_max3_f32 v14, v14, v149, v150
v_max_f32 v13, v13, v143
v_max_f32 v14, v14, v151
s_nop 1
v_permlane32_swap_b32 v13, v14
v_max_f32 v13, v13, v14
v_mov_b32 v14, v13
s_nop 1
v_permlane16_swap_b32 v13, v14
v_max_f32 v13, v13, v14
v_mul_f32 v13, s48, v13
v_max_f32 v15, v12, v13
v_sub_f32 v14, v12, v15
v_exp_f32 v35, v14
v_mov_b32 v12, v15
v_mov_b32 v11, v15
v_mov_b32 v16, v35
v_mov_b32 v18, v35
v_permlane32_swap_b32 v15, v11
s_nop 0
v_permlane32_swap_b32 v16, v18
s_waitcnt vmcnt(5)
s_bitcmp1_b32 s88, 1
s_cbranch_scc1 L_sk106
s_waitcnt vmcnt(4)
L_sk106:
buffer_load_dwordx4 v3, s[16:19], s44 offen offset:2048 nt lds
v_mov_b32 v241, 6
s_mov_b64 exec, 1
buffer_store_byte v241, v22, s[36:39], s42 offen
s_mov_b64 exec, -1
buffer_load_ushort v10, v240, s[36:39], 0 offen offset:128 nt
v_fma_f32 v136, v136, s48, -v15
v_fma_f32 v137, v137, s48, -v15
v_fma_f32 v138, v138, s48, -v15
v_fma_f32 v139, v139, s48, -v15
v_fma_f32 v140, v140, s48, -v15
v_fma_f32 v141, v141, s48, -v15
v_fma_f32 v142, v142, s48, -v15
v_fma_f32 v143, v143, s48, -v15
v_fma_f32 v144, v144, s48, -v11
v_fma_f32 v145, v145, s48, -v11
v_fma_f32 v146, v146, s48, -v11
v_fma_f32 v147, v147, s48, -v11
v_fma_f32 v148, v148, s48, -v11
v_fma_f32 v149, v149, s48, -v11
v_fma_f32 v150, v150, s48, -v11
v_fma_f32 v151, v151, s48, -v11
v_exp_f32 v136, v136
v_exp_f32 v137, v137
v_exp_f32 v138, v138
v_exp_f32 v139, v139
s_waitcnt vmcnt(7)
s_cbranch_vccnz L_sk107
s_waitcnt vmcnt(6)
L_sk107:
buffer_load_dwordx4 v4, s[16:19], s44 offen offset:3072 nt lds
v_exp_f32 v140, v140
v_exp_f32 v141, v141
v_exp_f32 v142, v142
v_exp_f32 v143, v143
v_exp_f32 v144, v144
v_exp_f32 v145, v145
v_exp_f32 v146, v146
v_exp_f32 v147, v147
ds_read_b128 v[88:91], v5 offset:0
ds_read_b128 v[92:95], v6 offset:0
ds_read_b128 v[96:99], v7 offset:0
ds_read_b128 v[100:103], v8 offset:0
s_add_u32 s44, s44, 0x8000
s_add_u32 m0, s47, 12288
s_waitcnt vmcnt(6)
buffer_load_dwordx4 v1, s[16:19], s44 offen offset:0 nt lds
s_barrier
s_waitcnt lgkmcnt(0)
v_mfma_f32_16x16x32_bf16 v[120:123], v[88:91], v[56:59], 0
v_mfma_f32_16x16x32_bf16 v[128:131], v[88:91], v[72:75], 0
v_exp_f32 v148, v148
v_mfma_f32_16x16x32_bf16 v[120:123], v[92:95], v[60:63], v[120:123]
v_mfma_f32_16x16x32_bf16 v[128:131], v[92:95], v[76:79], v[128:131]
v_exp_f32 v149, v149
v_mfma_f32_16x16x32_bf16 v[120:123], v[96:99], v[64:67], v[120:123]
v_mfma_f32_16x16x32_bf16 v[128:131], v[96:99], v[80:83], v[128:131]
v_exp_f32 v150, v150
v_mfma_f32_16x16x32_bf16 v[120:123], v[100:103], v[68:71], v[120:123]
v_mfma_f32_16x16x32_bf16 v[128:131], v[100:103], v[84:87], v[128:131]
v_exp_f32 v151, v151
s_cbranch_vccnz L_sk109
s_waitcnt vmcnt(6)
L_sk109:
buffer_load_dwordx4 v2, s[16:19], s44 offen offset:1024 nt lds
v_cvt_pk_bf16_f32 v152, v136, v137
v_cvt_pk_bf16_f32 v153, v138, v139
v_cvt_pk_bf16_f32 v154, v140, v141
v_cvt_pk_bf16_f32 v155, v142, v143
v_cvt_pk_bf16_f32 v156, v144, v145
v_cvt_pk_bf16_f32 v157, v146, v147
v_cvt_pk_bf16_f32 v158, v148, v149
v_cvt_pk_bf16_f32 v159, v150, v151
v_accvgpr_write_b32 a88, v152
v_accvgpr_write_b32 a89, v153
v_accvgpr_write_b32 a90, v154
v_accvgpr_write_b32 a91, v155
v_accvgpr_write_b32 a92, v156
v_accvgpr_write_b32 a93, v157
v_accvgpr_write_b32 a94, v158
v_accvgpr_write_b32 a95, v159
s_waitcnt vmcnt(6)
s_bitcmp1_b32 s88, 0
s_cbranch_scc0 L_ng110
s_waitcnt vmcnt(5)
L_ng110:
buffer_load_dwordx4 v3, s[16:19], s44 offen offset:2048 nt lds
v_fma_f32 v20, v20, v16, v136
v_fma_f32 v21, v21, v18, v144
v_add_f32 v20, v20, v137
v_add_f32 v21, v21, v145
v_add_f32 v20, v20, v138
v_add_f32 v21, v21, v146
v_add_f32 v20, v20, v139
v_add_f32 v21, v21, v147
v_add_f32 v20, v20, v140
v_add_f32 v21, v21, v148
v_add_f32 v20, v20, v141
v_add_f32 v21, v21, v149
v_add_f32 v20, v20, v142
v_add_f32 v21, v21, v150
v_add_f32 v20, v20, v143
v_add_f32 v21, v21, v151
s_cbranch_vccnz L_sk111
s_waitcnt vmcnt(6)
L_sk111:
buffer_load_dwordx4 v4, s[16:19], s44 offen offset:3072 nt lds
ds_read_b128 v[104:107], v5 offset:4096
ds_read_b128 v[108:111], v6 offset:4096
ds_read_b128 v[112:115], v7 offset:4096
ds_read_b128 v[116:119], v8 offset:4096
s_add_u32 s44, s44, 0x8000
s_add_u32 m0, s47, 0
s_waitcnt vmcnt(4)
buffer_load_dwordx4 v1, s[16:19], s44 offen offset:0 nt lds
s_barrier
s_waitcnt lgkmcnt(0)
v_mfma_f32_16x16x32_bf16 v[124:127], v[104:107], v[56:59], 0
v_mfma_f32_16x16x32_bf16 v[132:135], v[104:107], v[72:75], 0
v_mfma_f32_16x16x32_bf16 v[124:127], v[108:111], v[60:63], v[124:127]
v_mfma_f32_16x16x32_bf16 v[132:135], v[108:111], v[76:79], v[132:135]
v_mfma_f32_16x16x32_bf16 v[124:127], v[112:115], v[64:67], v[124:127]
v_mfma_f32_16x16x32_bf16 v[132:135], v[112:115], v[80:83], v[132:135]
v_mfma_f32_16x16x32_bf16 v[124:127], v[116:119], v[68:71], v[124:127]
v_mfma_f32_16x16x32_bf16 v[132:135], v[116:119], v[84:87], v[132:135]
s_cbranch_vccnz L_sk113
s_waitcnt vmcnt(4)
L_sk113:
buffer_load_dwordx4 v2, s[16:19], s44 offen offset:1024 nt lds
v_max3_f32 v13, v120, v121, v122
v_max3_f32 v14, v128, v129, v130
s_nop 2
v_max3_f32 v13, v13, v123, v124
v_max3_f32 v14, v14, v131, v132
v_max3_f32 v13, v13, v125, v126
v_max3_f32 v14, v14, v133, v134
v_max_f32 v13, v13, v127
v_max_f32 v14, v14, v135
s_nop 1
v_permlane32_swap_b32 v13, v14
v_max_f32 v13, v13, v14
v_mov_b32 v14, v13
s_nop 1
v_permlane16_swap_b32 v13, v14
v_max_f32 v13, v13, v14
v_mul_f32 v13, s48, v13
v_max_f32 v15, v12, v13
v_sub_f32 v14, v12, v15
v_exp_f32 v36, v14
v_mov_b32 v12, v15
v_mov_b32 v11, v15
v_mov_b32 v16, v36
v_mov_b32 v18, v36
v_permlane32_swap_b32 v15, v11
s_nop 0
v_permlane32_swap_b32 v16, v18
s_waitcnt vmcnt(5)
s_bitcmp1_b32 s88, 1
s_cbranch_scc1 L_sk114
s_waitcnt vmcnt(4)
L_sk114:
buffer_load_dwordx4 v3, s[16:19], s44 offen offset:2048 nt lds
v_and_b32 v241, 0xff, v10
v_lshrrev_b32 v10, 8, v10
v_cmp_le_u32 vcc, 6, v241
v_cmp_le_u32 s[90:91], 6, v10
s_nop 0
s_bcnt1_i32_b64 s88, vcc
s_bcnt1_i32_b64 s90, s[90:91]
s_add_u32 s90, s90, s88
s_add_u32 s90, s90, s43
s_cmp_ge_u32 s90, 15
s_cselect_b32 s88, 2, 0
s_cmp_le_u32 s90, 5
s_cselect_b32 s88, 1, s88
s_cmp_ge_u32 s90, 10
s_cselect_b64 vcc, -1, 0
v_fma_f32 v120, v120, s48, -v15
v_fma_f32 v121, v121, s48, -v15
v_fma_f32 v122, v122, s48, -v15
v_fma_f32 v123, v123, s48, -v15
v_fma_f32 v124, v124, s48, -v15
v_fma_f32 v125, v125, s48, -v15
v_fma_f32 v126, v126, s48, -v15
v_fma_f32 v127, v127, s48, -v15
v_fma_f32 v128, v128, s48, -v11
v_fma_f32 v129, v129, s48, -v11
v_fma_f32 v130, v130, s48, -v11
v_fma_f32 v131, v131, s48, -v11
v_fma_f32 v132, v132, s48, -v11
v_fma_f32 v133, v133, s48, -v11
v_fma_f32 v134, v134, s48, -v11
v_fma_f32 v135, v135, s48, -v11
v_exp_f32 v120, v120
v_exp_f32 v121, v121
v_exp_f32 v122, v122
v_exp_f32 v123, v123
s_waitcnt vmcnt(5)
s_cbranch_vccnz L_sk115
s_waitcnt vmcnt(4)
L_sk115:
buffer_load_dwordx4 v4, s[16:19], s44 offen offset:3072 nt lds
v_exp_f32 v124, v124
v_exp_f32 v125, v125
v_exp_f32 v126, v126
v_exp_f32 v127, v127
v_exp_f32 v128, v128
v_exp_f32 v129, v129
v_exp_f32 v130, v130
v_exp_f32 v131, v131
ds_read_b128 v[88:91], v5 offset:8192
ds_read_b128 v[92:95], v6 offset:8192
ds_read_b128 v[96:99], v7 offset:8192
ds_read_b128 v[100:103], v8 offset:8192
s_add_u32 s44, s44, 0x8000
s_add_u32 m0, s47, 4096
s_waitcnt vmcnt(4)
buffer_load_dwordx4 v1, s[16:19], s44 offen offset:0 nt lds
s_barrier
s_waitcnt lgkmcnt(0)
v_mfma_f32_16x16x32_bf16 v[136:139], v[88:91], v[56:59], 0
v_mfma_f32_16x16x32_bf16 v[144:147], v[88:91], v[72:75], 0
v_exp_f32 v132, v132
v_mfma_f32_16x16x32_bf16 v[136:139], v[92:95], v[60:63], v[136:139]
v_mfma_f32_16x16x32_bf16 v[144:147], v[92:95], v[76:79], v[144:147]
v_exp_f32 v133, v133
v_mfma_f32_16x16x32_bf16 v[136:139], v[96:99], v[64:67], v[136:139]
v_mfma_f32_16x16x32_bf16 v[144:147], v[96:99], v[80:83], v[144:147]
v_exp_f32 v134, v134
v_mfma_f32_16x16x32_bf16 v[136:139], v[100:103], v[68:71], v[136:139]
v_mfma_f32_16x16x32_bf16 v[144:147], v[100:103], v[84:87], v[144:147]
v_exp_f32 v135, v135
s_cbranch_vccnz L_sk117
s_waitcnt vmcnt(4)
L_sk117:
buffer_load_dwordx4 v2, s[16:19], s44 offen offset:1024 nt lds
v_cvt_pk_bf16_f32 v152, v120, v121
v_cvt_pk_bf16_f32 v153, v122, v123
v_cvt_pk_bf16_f32 v154, v124, v125
v_cvt_pk_bf16_f32 v155, v126, v127
v_cvt_pk_bf16_f32 v156, v128, v129
v_cvt_pk_bf16_f32 v157, v130, v131
v_cvt_pk_bf16_f32 v158, v132, v133
v_cvt_pk_bf16_f32 v159, v134, v135
v_accvgpr_write_b32 a96, v152
v_accvgpr_write_b32 a97, v153
v_accvgpr_write_b32 a98, v154
v_accvgpr_write_b32 a99, v155
v_accvgpr_write_b32 a100, v156
v_accvgpr_write_b32 a101, v157
v_accvgpr_write_b32 a102, v158
v_accvgpr_write_b32 a103, v159
s_waitcnt vmcnt(4)
s_bitcmp1_b32 s88, 0
s_cbranch_scc0 L_ng118
s_waitcnt vmcnt(3)
L_ng118:
buffer_load_dwordx4 v3, s[16:19], s44 offen offset:2048 nt lds
v_fma_f32 v20, v20, v16, v120
v_fma_f32 v21, v21, v18, v128
v_add_f32 v20, v20, v121
v_add_f32 v21, v21, v129
v_add_f32 v20, v20, v122
v_add_f32 v21, v21, v130
v_add_f32 v20, v20, v123
v_add_f32 v21, v21, v131
v_add_f32 v20, v20, v124
v_add_f32 v21, v21, v132
v_add_f32 v20, v20, v125
v_add_f32 v21, v21, v133
v_add_f32 v20, v20, v126
v_add_f32 v21, v21, v134
v_add_f32 v20, v20, v127
v_add_f32 v21, v21, v135
s_cbranch_vccnz L_sk119
s_waitcnt vmcnt(4)
L_sk119:
buffer_load_dwordx4 v4, s[16:19], s44 offen offset:3072 nt lds
ds_read_b128 v[104:107], v5 offset:12288
ds_read_b128 v[108:111], v6 offset:12288
ds_read_b128 v[112:115], v7 offset:12288
ds_read_b128 v[116:119], v8 offset:12288
s_add_u32 s44, s44, 0x8000
s_add_u32 m0, s47, 8192
s_waitcnt vmcnt(4)
buffer_load_dwordx4 v1, s[16:19], s44 offen offset:0 nt lds
s_barrier
s_waitcnt lgkmcnt(0)
v_mfma_f32_16x16x32_bf16 v[140:143], v[104:107], v[56:59], 0
v_mfma_f32_16x16x32_bf16 v[148:151], v[104:107], v[72:75], 0
v_mfma_f32_16x16x32_bf16 v[140:143], v[108:111], v[60:63], v[140:143]
v_mfma_f32_16x16x32_bf16 v[148:151], v[108:111], v[76:79], v[148:151]
v_mfma_f32_16x16x32_bf16 v[140:143], v[112:115], v[64:67], v[140:143]
v_mfma_f32_16x16x32_bf16 v[148:151], v[112:115], v[80:83], v[148:151]
v_mfma_f32_16x16x32_bf16 v[140:143], v[116:119], v[68:71], v[140:143]
v_mfma_f32_16x16x32_bf16 v[148:151], v[116:119], v[84:87], v[148:151]
s_cbranch_vccnz L_sk121
s_waitcnt vmcnt(4)
L_sk121:
buffer_load_dwordx4 v2, s[16:19], s44 offen offset:1024 nt lds
v_max3_f32 v13, v136, v137, v138
v_max3_f32 v14, v144, v145, v146
s_nop 2
v_max3_f32 v13, v13, v139, v140
v_max3_f32 v14, v14, v147, v148
v_max3_f32 v13, v13, v141, v142
v_max3_f32 v14, v14, v149, v150
v_max_f32 v13, v13, v143
v_max_f32 v14, v14, v151
s_nop 1
v_permlane32_swap_b32 v13, v14
v_max_f32 v13, v13, v14
v_mov_b32 v14, v13
s_nop 1
v_permlane16_swap_b32 v13, v14
v_max_f32 v13, v13, v14
v_mul_f32 v13, s48, v13
v_max_f32 v15, v12, v13
v_sub_f32 v14, v12, v15
v_exp_f32 v37, v14
v_mov_b32 v12, v15
v_mov_b32 v11, v15
v_mov_b32 v16, v37
v_mov_b32 v18, v37
v_permlane32_swap_b32 v15, v11
s_nop 0
v_permlane32_swap_b32 v16, v18
s_waitcnt vmcnt(5)
s_bitcmp1_b32 s88, 1
s_cbranch_scc1 L_sk122
s_waitcnt vmcnt(4)
L_sk122:
buffer_load_dwordx4 v3, s[16:19], s44 offen offset:2048 nt lds
v_mov_b32 v241, 7
s_mov_b64 exec, 1
buffer_store_byte v241, v22, s[36:39], s42 offen
s_mov_b64 exec, -1
buffer_load_ushort v10, v240, s[36:39], 0 offen offset:128 nt
v_fma_f32 v136, v136, s48, -v15
v_fma_f32 v137, v137, s48, -v15
v_fma_f32 v138, v138, s48, -v15
v_fma_f32 v139, v139, s48, -v15
v_fma_f32 v140, v140, s48, -v15
v_fma_f32 v141, v141, s48, -v15
v_fma_f32 v142, v142, s48, -v15
v_fma_f32 v143, v143, s48, -v15
v_fma_f32 v144, v144, s48, -v11
v_fma_f32 v145, v145, s48, -v11
v_fma_f32 v146, v146, s48, -v11
v_fma_f32 v147, v147, s48, -v11
v_fma_f32 v148, v148, s48, -v11
v_fma_f32 v149, v149, s48, -v11
v_fma_f32 v150, v150, s48, -v11
v_fma_f32 v151, v151, s48, -v11
v_exp_f32 v136, v136
v_exp_f32 v137, v137
v_exp_f32 v138, v138
v_exp_f32 v139, v139
s_waitcnt vmcnt(7)
s_cbranch_vccnz L_sk123
s_waitcnt vmcnt(6)
L_sk123:
buffer_load_dwordx4 v4, s[16:19], s44 offen offset:3072 nt lds
v_exp_f32 v140, v140
v_exp_f32 v141, v141
v_exp_f32 v142, v142
v_exp_f32 v143, v143
v_exp_f32 v144, v144
v_exp_f32 v145, v145
v_exp_f32 v146, v146
v_exp_f32 v147, v147
ds_read_b128 v[88:91], v5 offset:0
ds_read_b128 v[92:95], v6 offset:0
ds_read_b128 v[96:99], v7 offset:0
ds_read_b128 v[100:103], v8 offset:0
s_add_u32 s44, s44, 0x8000
s_add_u32 m0, s47, 12288
s_waitcnt vmcnt(6)
buffer_load_dwordx4 v1, s[16:19], s44 offen offset:0 nt lds
s_barrier
s_waitcnt lgkmcnt(0)
v_mfma_f32_16x16x32_bf16 v[120:123], v[88:91], v[56:59], 0
v_mfma_f32_16x16x32_bf16 v[128:131], v[88:91], v[72:75], 0
v_exp_f32 v148, v148
v_mfma_f32_16x16x32_bf16 v[120:123], v[92:95], v[60:63], v[120:123]
v_mfma_f32_16x16x32_bf16 v[128:131], v[92:95], v[76:79], v[128:131]
v_exp_f32 v149, v149
v_mfma_f32_16x16x32_bf16 v[120:123], v[96:99], v[64:67], v[120:123]
v_mfma_f32_16x16x32_bf16 v[128:131], v[96:99], v[80:83], v[128:131]
v_exp_f32 v150, v150
v_mfma_f32_16x16x32_bf16 v[120:123], v[100:103], v[68:71], v[120:123]
v_mfma_f32_16x16x32_bf16 v[128:131], v[100:103], v[84:87], v[128:131]
v_exp_f32 v151, v151
s_cbranch_vccnz L_sk125
s_waitcnt vmcnt(6)
L_sk125:
buffer_load_dwordx4 v2, s[16:19], s44 offen offset:1024 nt lds
v_cvt_pk_bf16_f32 v152, v136, v137
v_cvt_pk_bf16_f32 v153, v138, v139
v_cvt_pk_bf16_f32 v154, v140, v141
v_cvt_pk_bf16_f32 v155, v142, v143
v_cvt_pk_bf16_f32 v156, v144, v145
v_cvt_pk_bf16_f32 v157, v146, v147
v_cvt_pk_bf16_f32 v158, v148, v149
v_cvt_pk_bf16_f32 v159, v150, v151
v_accvgpr_write_b32 a104, v152
v_accvgpr_write_b32 a105, v153
v_accvgpr_write_b32 a106, v154
v_accvgpr_write_b32 a107, v155
v_accvgpr_write_b32 a108, v156
v_accvgpr_write_b32 a109, v157
v_accvgpr_write_b32 a110, v158
v_accvgpr_write_b32 a111, v159
s_waitcnt vmcnt(6)
s_bitcmp1_b32 s88, 0
s_cbranch_scc0 L_ng126
s_waitcnt vmcnt(5)
L_ng126:
buffer_load_dwordx4 v3, s[16:19], s44 offen offset:2048 nt lds
v_fma_f32 v20, v20, v16, v136
v_fma_f32 v21, v21, v18, v144
v_add_f32 v20, v20, v137
v_add_f32 v21, v21, v145
v_add_f32 v20, v20, v138
v_add_f32 v21, v21, v146
v_add_f32 v20, v20, v139
v_add_f32 v21, v21, v147
v_add_f32 v20, v20, v140
v_add_f32 v21, v21, v148
v_add_f32 v20, v20, v141
v_add_f32 v21, v21, v149
v_add_f32 v20, v20, v142
v_add_f32 v21, v21, v150
v_add_f32 v20, v20, v143
v_add_f32 v21, v21, v151
s_cbranch_vccnz L_sk127
s_waitcnt vmcnt(6)
L_sk127:
buffer_load_dwordx4 v4, s[16:19], s44 offen offset:3072 nt lds
ds_read_b128 v[104:107], v5 offset:4096
ds_read_b128 v[108:111], v6 offset:4096
ds_read_b128 v[112:115], v7 offset:4096
ds_read_b128 v[116:119], v8 offset:4096
s_add_u32 s44, s44, 0x8000
s_add_u32 m0, s47, 0
s_waitcnt vmcnt(4)
buffer_load_dwordx4 v1, s[16:19], s44 offen offset:0 nt lds
s_barrier
s_waitcnt lgkmcnt(0)
v_mfma_f32_16x16x32_bf16 v[124:127], v[104:107], v[56:59], 0
v_mfma_f32_16x16x32_bf16 v[132:135], v[104:107], v[72:75], 0
v_mfma_f32_16x16x32_bf16 v[124:127], v[108:111], v[60:63], v[124:127]
v_mfma_f32_16x16x32_bf16 v[132:135], v[108:111], v[76:79], v[132:135]
v_mfma_f32_16x16x32_bf16 v[124:127], v[112:115], v[64:67], v[124:127]
v_mfma_f32_16x16x32_bf16 v[132:135], v[112:115], v[80:83], v[132:135]
v_mfma_f32_16x16x32_bf16 v[124:127], v[116:119], v[68:71], v[124:127]
v_mfma_f32_16x16x32_bf16 v[132:135], v[116:119], v[84:87], v[132:135]
s_cbranch_vccnz L_sk129
s_waitcnt vmcnt(4)
L_sk129:
buffer_load_dwordx4 v2, s[16:19], s44 offen offset:1024 nt lds
v_max3_f32 v13, v120, v121, v122
v_max3_f32 v14, v128, v129, v130
s_nop 2
v_max3_f32 v13, v13, v123, v124
v_max3_f32 v14, v14, v131, v132
v_max3_f32 v13, v13, v125, v126
v_max3_f32 v14, v14, v133, v134
v_max_f32 v13, v13, v127
v_max_f32 v14, v14, v135
s_nop 1
v_permlane32_swap_b32 v13, v14
v_max_f32 v13, v13, v14
v_mov_b32 v14, v13
s_nop 1
v_permlane16_swap_b32 v13, v14
v_max_f32 v13, v13, v14
v_mul_f32 v13, s48, v13
v_max_f32 v15, v12, v13
v_sub_f32 v14, v12, v15
v_exp_f32 v38, v14
v_mov_b32 v12, v15
v_mov_b32 v11, v15
v_mov_b32 v16, v38
v_mov_b32 v18, v38
v_permlane32_swap_b32 v15, v11
s_nop 0
v_permlane32_swap_b32 v16, v18
s_waitcnt vmcnt(5)
s_bitcmp1_b32 s88, 1
s_cbranch_scc1 L_sk130
s_waitcnt vmcnt(4)
L_sk130:
buffer_load_dwordx4 v3, s[16:19], s44 offen offset:2048 nt lds
v_and_b32 v241, 0xff, v10
v_lshrrev_b32 v10, 8, v10
v_cmp_le_u32 vcc, 7, v241
v_cmp_le_u32 s[90:91], 7, v10
s_nop 0
s_bcnt1_i32_b64 s88, vcc
s_bcnt1_i32_b64 s90, s[90:91]
s_add_u32 s90, s90, s88
s_add_u32 s90, s90, s43
s_cmp_ge_u32 s90, 15
s_cselect_b32 s88, 2, 0
s_cmp_le_u32 s90, 5
s_cselect_b32 s88, 1, s88
s_cmp_ge_u32 s90, 10
s_cselect_b64 vcc, -1, 0
v_fma_f32 v120, v120, s48, -v15
v_fma_f32 v121, v121, s48, -v15
v_fma_f32 v122, v122, s48, -v15
v_fma_f32 v123, v123, s48, -v15
v_fma_f32 v124, v124, s48, -v15
v_fma_f32 v125, v125, s48, -v15
v_fma_f32 v126, v126, s48, -v15
v_fma_f32 v127, v127, s48, -v15
v_fma_f32 v128, v128, s48, -v11
v_fma_f32 v129, v129, s48, -v11
v_fma_f32 v130, v130, s48, -v11
v_fma_f32 v131, v131, s48, -v11
v_fma_f32 v132, v132, s48, -v11
v_fma_f32 v133, v133, s48, -v11
v_fma_f32 v134, v134, s48, -v11
v_fma_f32 v135, v135, s48, -v11
v_exp_f32 v120, v120
v_exp_f32 v121, v121
v_exp_f32 v122, v122
v_exp_f32 v123, v123
s_waitcnt vmcnt(5)
s_cbranch_vccnz L_sk131
s_waitcnt vmcnt(4)
L_sk131:
buffer_load_dwordx4 v4, s[16:19], s44 offen offset:3072 nt lds
v_exp_f32 v124, v124
v_exp_f32 v125, v125
v_exp_f32 v126, v126
v_exp_f32 v127, v127
v_exp_f32 v128, v128
v_exp_f32 v129, v129
v_exp_f32 v130, v130
v_exp_f32 v131, v131
ds_read_b128 v[88:91], v5 offset:8192
ds_read_b128 v[92:95], v6 offset:8192
ds_read_b128 v[96:99], v7 offset:8192
ds_read_b128 v[100:103], v8 offset:8192
s_add_u32 s44, s44, 0x8000
s_add_u32 m0, s47, 4096
s_waitcnt vmcnt(4)
buffer_load_dwordx4 v1, s[16:19], s44 offen offset:0 nt lds
s_barrier
s_waitcnt lgkmcnt(0)
v_mfma_f32_16x16x32_bf16 v[136:139], v[88:91], v[56:59], 0
v_mfma_f32_16x16x32_bf16 v[144:147], v[88:91], v[72:75], 0
v_exp_f32 v132, v132
v_mfma_f32_16x16x32_bf16 v[136:139], v[92:95], v[60:63], v[136:139]
v_mfma_f32_16x16x32_bf16 v[144:147], v[92:95], v[76:79], v[144:147]
v_exp_f32 v133, v133
v_mfma_f32_16x16x32_bf16 v[136:139], v[96:99], v[64:67], v[136:139]
v_mfma_f32_16x16x32_bf16 v[144:147], v[96:99], v[80:83], v[144:147]
v_exp_f32 v134, v134
v_mfma_f32_16x16x32_bf16 v[136:139], v[100:103], v[68:71], v[136:139]
v_mfma_f32_16x16x32_bf16 v[144:147], v[100:103], v[84:87], v[144:147]
v_exp_f32 v135, v135
s_cbranch_vccnz L_sk133
s_waitcnt vmcnt(4)
L_sk133:
buffer_load_dwordx4 v2, s[16:19], s44 offen offset:1024 nt lds
v_cvt_pk_bf16_f32 v152, v120, v121
v_cvt_pk_bf16_f32 v153, v122, v123
v_cvt_pk_bf16_f32 v154, v124, v125
v_cvt_pk_bf16_f32 v155, v126, v127
v_cvt_pk_bf16_f32 v156, v128, v129
v_cvt_pk_bf16_f32 v157, v130, v131
v_cvt_pk_bf16_f32 v158, v132, v133
v_cvt_pk_bf16_f32 v159, v134, v135
v_accvgpr_write_b32 a112, v152
v_accvgpr_write_b32 a113, v153
v_accvgpr_write_b32 a114, v154
v_accvgpr_write_b32 a115, v155
v_accvgpr_write_b32 a116, v156
v_accvgpr_write_b32 a117, v157
v_accvgpr_write_b32 a118, v158
v_accvgpr_write_b32 a119, v159
s_waitcnt vmcnt(4)
s_bitcmp1_b32 s88, 0
s_cbranch_scc0 L_ng134
s_waitcnt vmcnt(3)
L_ng134:
buffer_load_dwordx4 v3, s[16:19], s44 offen offset:2048 nt lds
v_fma_f32 v20, v20, v16, v120
v_fma_f32 v21, v21, v18, v128
v_add_f32 v20, v20, v121
v_add_f32 v21, v21, v129
v_add_f32 v20, v20, v122
v_add_f32 v21, v21, v130
v_add_f32 v20, v20, v123
v_add_f32 v21, v21, v131
v_add_f32 v20, v20, v124
v_add_f32 v21, v21, v132
v_add_f32 v20, v20, v125
v_add_f32 v21, v21, v133
v_add_f32 v20, v20, v126
v_add_f32 v21, v21, v134
v_add_f32 v20, v20, v127
v_add_f32 v21, v21, v135
s_cbranch_vccnz L_sk135
s_waitcnt vmcnt(4)
L_sk135:
buffer_load_dwordx4 v4, s[16:19], s44 offen offset:3072 nt lds
ds_read_b128 v[104:107], v5 offset:12288
ds_read_b128 v[108:111], v6 offset:12288
ds_read_b128 v[112:115], v7 offset:12288
ds_read_b128 v[116:119], v8 offset:12288
s_add_u32 s44, s44, 0x8000
s_add_u32 m0, s47, 8192
s_waitcnt vmcnt(4)
buffer_load_dwordx4 v1, s[16:19], s44 offen offset:0 nt lds
s_barrier
s_waitcnt lgkmcnt(0)
v_mfma_f32_16x16x32_bf16 v[140:143], v[104:107], v[56:59], 0
v_mfma_f32_16x16x32_bf16 v[148:151], v[104:107], v[72:75], 0
v_mfma_f32_16x16x32_bf16 v[140:143], v[108:111], v[60:63], v[140:143]
v_mfma_f32_16x16x32_bf16 v[148:151], v[108:111], v[76:79], v[148:151]
v_mfma_f32_16x16x32_bf16 v[140:143], v[112:115], v[64:67], v[140:143]
v_mfma_f32_16x16x32_bf16 v[148:151], v[112:115], v[80:83], v[148:151]
v_mfma_f32_16x16x32_bf16 v[140:143], v[116:119], v[68:71], v[140:143]
v_mfma_f32_16x16x32_bf16 v[148:151], v[116:119], v[84:87], v[148:151]
s_cbranch_vccnz L_sk137
s_waitcnt vmcnt(4)
L_sk137:
buffer_load_dwordx4 v2, s[16:19], s44 offen offset:1024 nt lds
v_max3_f32 v13, v136, v137, v138
v_max3_f32 v14, v144, v145, v146
s_nop 2
v_max3_f32 v13, v13, v139, v140
v_max3_f32 v14, v14, v147, v148
v_max3_f32 v13, v13, v141, v142
v_max3_f32 v14, v14, v149, v150
v_max_f32 v13, v13, v143
v_max_f32 v14, v14, v151
s_nop 1
v_permlane32_swap_b32 v13, v14
v_max_f32 v13, v13, v14
v_mov_b32 v14, v13
s_nop 1
v_permlane16_swap_b32 v13, v14
v_max_f32 v13, v13, v14
v_mul_f32 v13, s48, v13
v_max_f32 v15, v12, v13
v_sub_f32 v14, v12, v15
v_exp_f32 v39, v14
v_mov_b32 v12, v15
v_mov_b32 v11, v15
v_mov_b32 v16, v39
v_mov_b32 v18, v39
v_permlane32_swap_b32 v15, v11
s_nop 0
v_permlane32_swap_b32 v16, v18
s_waitcnt vmcnt(5)
s_bitcmp1_b32 s88, 1
s_cbranch_scc1 L_sk138
s_waitcnt vmcnt(4)
L_sk138:
buffer_load_dwordx4 v3, s[16:19], s44 offen offset:2048 nt lds
v_mov_b32 v241, 8
s_mov_b64 exec, 1
buffer_store_byte v241, v22, s[36:39], s42 offen
s_mov_b64 exec, -1
buffer_load_ushort v10, v240, s[36:39], 0 offen offset:128 nt
v_fma_f32 v136, v136, s48, -v15
v_fma_f32 v137, v137, s48, -v15
v_fma_f32 v138, v138, s48, -v15
v_fma_f32 v139, v139, s48, -v15
v_fma_f32 v140, v140, s48, -v15
v_fma_f32 v141, v141, s48, -v15
v_fma_f32 v142, v142, s48, -v15
v_fma_f32 v143, v143, s48, -v15
v_fma_f32 v144, v144, s48, -v11
v_fma_f32 v145, v145, s48, -v11
v_fma_f32 v146, v146, s48, -v11
v_fma_f32 v147, v147, s48, -v11
v_fma_f32 v148, v148, s48, -v11
v_fma_f32 v149, v149, s48, -v11
v_fma_f32 v150, v150, s48, -v11
v_fma_f32 v151, v151, s48, -v11
v_exp_f32 v136, v136
v_exp_f32 v137, v137
v_exp_f32 v138, v138
v_exp_f32 v139, v139
s_waitcnt vmcnt(7)
s_cbranch_vccnz L_sk139
s_waitcnt vmcnt(6)
L_sk139:
buffer_load_dwordx4 v4, s[16:19], s44 offen offset:3072 nt lds
v_exp_f32 v140, v140
v_exp_f32 v141, v141
v_exp_f32 v142, v142
v_exp_f32 v143, v143
v_exp_f32 v144, v144
v_exp_f32 v145, v145
v_exp_f32 v146, v146
v_exp_f32 v147, v147
ds_read_b128 v[88:91], v5 offset:0
ds_read_b128 v[92:95], v6 offset:0
ds_read_b128 v[96:99], v7 offset:0
ds_read_b128 v[100:103], v8 offset:0
s_add_u32 s44, s44, 0x8000
s_add_u32 m0, s47, 12288
s_waitcnt vmcnt(6)
buffer_load_dwordx4 v1, s[16:19], s44 offen offset:0 nt lds
s_barrier
s_waitcnt lgkmcnt(0)
v_mfma_f32_16x16x32_bf16 v[120:123], v[88:91], v[56:59], 0
v_mfma_f32_16x16x32_bf16 v[128:131], v[88:91], v[72:75], 0
v_exp_f32 v148, v148
v_mfma_f32_16x16x32_bf16 v[120:123], v[92:95], v[60:63], v[120:123]
v_mfma_f32_16x16x32_bf16 v[128:131], v[92:95], v[76:79], v[128:131]
v_exp_f32 v149, v149
v_mfma_f32_16x16x32_bf16 v[120:123], v[96:99], v[64:67], v[120:123]
v_mfma_f32_16x16x32_bf16 v[128:131], v[96:99], v[80:83], v[128:131]
v_exp_f32 v150, v150
v_mfma_f32_16x16x32_bf16 v[120:123], v[100:103], v[68:71], v[120:123]
v_mfma_f32_16x16x32_bf16 v[128:131], v[100:103], v[84:87], v[128:131]
v_exp_f32 v151, v151
s_cbranch_vccnz L_sk141
s_waitcnt vmcnt(6)
L_sk141:
buffer_load_dwordx4 v2, s[16:19], s44 offen offset:1024 nt lds
v_cvt_pk_bf16_f32 v152, v136, v137
v_cvt_pk_bf16_f32 v153, v138, v139
v_cvt_pk_bf16_f32 v154, v140, v141
v_cvt_pk_bf16_f32 v155, v142, v143
v_cvt_pk_bf16_f32 v156, v144, v145
v_cvt_pk_bf16_f32 v157, v146, v147
v_cvt_pk_bf16_f32 v158, v148, v149
v_cvt_pk_bf16_f32 v159, v150, v151
v_accvgpr_write_b32 a120, v152
v_accvgpr_write_b32 a121, v153
v_accvgpr_write_b32 a122, v154
v_accvgpr_write_b32 a123, v155
v_accvgpr_write_b32 a124, v156
v_accvgpr_write_b32 a125, v157
v_accvgpr_write_b32 a126, v158
v_accvgpr_write_b32 a127, v159
s_waitcnt vmcnt(6)
s_bitcmp1_b32 s88, 0
s_cbranch_scc0 L_ng142
s_waitcnt vmcnt(5)
L_ng142:
buffer_load_dwordx4 v3, s[16:19], s44 offen offset:2048 nt lds
v_fma_f32 v20, v20, v16, v136
v_fma_f32 v21, v21, v18, v144
v_add_f32 v20, v20, v137
v_add_f32 v21, v21, v145
v_add_f32 v20, v20, v138
v_add_f32 v21, v21, v146
v_add_f32 v20, v20, v139
v_add_f32 v21, v21, v147
v_add_f32 v20, v20, v140
v_add_f32 v21, v21, v148
v_add_f32 v20, v20, v141
v_add_f32 v21, v21, v149
v_add_f32 v20, v20, v142
v_add_f32 v21, v21, v150
v_add_f32 v20, v20, v143
v_add_f32 v21, v21, v151
s_cbranch_vccnz L_sk143
s_waitcnt vmcnt(6)
L_sk143:
buffer_load_dwordx4 v4, s[16:19], s44 offen offset:3072 nt lds
ds_read_b128 v[104:107], v5 offset:4096
ds_read_b128 v[108:111], v6 offset:4096
ds_read_b128 v[112:115], v7 offset:4096
ds_read_b128 v[116:119], v8 offset:4096
s_add_u32 s44, s44, 0x8000
s_add_u32 m0, s47, 0
s_waitcnt vmcnt(4)
buffer_load_dwordx4 v1, s[16:19], s44 offen offset:0 nt lds
s_barrier
s_waitcnt lgkmcnt(0)
v_mfma_f32_16x16x32_bf16 v[124:127], v[104:107], v[56:59], 0
v_mfma_f32_16x16x32_bf16 v[132:135], v[104:107], v[72:75], 0
v_mfma_f32_16x16x32_bf16 v[124:127], v[108:111], v[60:63], v[124:127]
v_mfma_f32_16x16x32_bf16 v[132:135], v[108:111], v[76:79], v[132:135]
v_mfma_f32_16x16x32_bf16 v[124:127], v[112:115], v[64:67], v[124:127]
v_mfma_f32_16x16x32_bf16 v[132:135], v[112:115], v[80:83], v[132:135]
v_mfma_f32_16x16x32_bf16 v[124:127], v[116:119], v[68:71], v[124:127]
v_mfma_f32_16x16x32_bf16 v[132:135], v[116:119], v[84:87], v[132:135]
s_cbranch_vccnz L_sk145
s_waitcnt vmcnt(4)
L_sk145:
buffer_load_dwordx4 v2, s[16:19], s44 offen offset:1024 nt lds
v_max3_f32 v13, v120, v121, v122
v_max3_f32 v14, v128, v129, v130
s_nop 2
v_max3_f32 v13, v13, v123, v124
v_max3_f32 v14, v14, v131, v132
v_max3_f32 v13, v13, v125, v126
v_max3_f32 v14, v14, v133, v134
v_max_f32 v13, v13, v127
v_max_f32 v14, v14, v135
s_nop 1
v_permlane32_swap_b32 v13, v14
v_max_f32 v13, v13, v14
v_mov_b32 v14, v13
s_nop 1
v_permlane16_swap_b32 v13, v14
v_max_f32 v13, v13, v14
v_mul_f32 v13, s48, v13
v_max_f32 v15, v12, v13
v_sub_f32 v14, v12, v15
v_exp_f32 v40, v14
v_mov_b32 v12, v15
v_mov_b32 v11, v15
v_mov_b32 v16, v40
v_mov_b32 v18, v40
v_permlane32_swap_b32 v15, v11
s_nop 0
v_permlane32_swap_b32 v16, v18
s_waitcnt vmcnt(5)
s_bitcmp1_b32 s88, 1
s_cbranch_scc1 L_sk146
s_waitcnt vmcnt(4)
L_sk146:
buffer_load_dwordx4 v3, s[16:19], s44 offen offset:2048 nt lds
v_and_b32 v241, 0xff, v10
v_lshrrev_b32 v10, 8, v10
v_cmp_le_u32 vcc, 8, v241
v_cmp_le_u32 s[90:91], 8, v10
s_nop 0
s_bcnt1_i32_b64 s88, vcc
s_bcnt1_i32_b64 s90, s[90:91]
s_add_u32 s90, s90, s88
s_add_u32 s90, s90, s43
s_cmp_ge_u32 s90, 15
s_cselect_b32 s88, 2, 0
s_cmp_le_u32 s90, 5
s_cselect_b32 s88, 1, s88
s_cmp_ge_u32 s90, 10
s_cselect_b64 vcc, -1, 0
v_fma_f32 v120, v120, s48, -v15
v_fma_f32 v121, v121, s48, -v15
v_fma_f32 v122, v122, s48, -v15
v_fma_f32 v123, v123, s48, -v15
v_fma_f32 v124, v124, s48, -v15
v_fma_f32 v125, v125, s48, -v15
v_fma_f32 v126, v126, s48, -v15
v_fma_f32 v127, v127, s48, -v15
v_fma_f32 v128, v128, s48, -v11
v_fma_f32 v129, v129, s48, -v11
v_fma_f32 v130, v130, s48, -v11
v_fma_f32 v131, v131, s48, -v11
v_fma_f32 v132, v132, s48, -v11
v_fma_f32 v133, v133, s48, -v11
v_fma_f32 v134, v134, s48, -v11
v_fma_f32 v135, v135, s48, -v11
v_exp_f32 v120, v120
v_exp_f32 v121, v121
v_exp_f32 v122, v122
v_exp_f32 v123, v123
s_waitcnt vmcnt(5)
s_cbranch_vccnz L_sk147
s_waitcnt vmcnt(4)
L_sk147:
buffer_load_dwordx4 v4, s[16:19], s44 offen offset:3072 nt lds
v_exp_f32 v124, v124
v_exp_f32 v125, v125
v_exp_f32 v126, v126
v_exp_f32 v127, v127
v_exp_f32 v128, v128
v_exp_f32 v129, v129
v_exp_f32 v130, v130
v_exp_f32 v131, v131
ds_read_b128 v[88:91], v5 offset:8192
ds_read_b128 v[92:95], v6 offset:8192
ds_read_b128 v[96:99], v7 offset:8192
ds_read_b128 v[100:103], v8 offset:8192
s_add_u32 s44, s44, 0x8000
s_add_u32 m0, s47, 4096
s_waitcnt vmcnt(4)
buffer_load_dwordx4 v1, s[16:19], s44 offen offset:0 nt lds
s_barrier
s_waitcnt lgkmcnt(0)
v_mfma_f32_16x16x32_bf16 v[136:139], v[88:91], v[56:59], 0
v_mfma_f32_16x16x32_bf16 v[144:147], v[88:91], v[72:75], 0
v_exp_f32 v132, v132
v_mfma_f32_16x16x32_bf16 v[136:139], v[92:95], v[60:63], v[136:139]
v_mfma_f32_16x16x32_bf16 v[144:147], v[92:95], v[76:79], v[144:147]
v_exp_f32 v133, v133
v_mfma_f32_16x16x32_bf16 v[136:139], v[96:99], v[64:67], v[136:139]
v_mfma_f32_16x16x32_bf16 v[144:147], v[96:99], v[80:83], v[144:147]
v_exp_f32 v134, v134
v_mfma_f32_16x16x32_bf16 v[136:139], v[100:103], v[68:71], v[136:139]
v_mfma_f32_16x16x32_bf16 v[144:147], v[100:103], v[84:87], v[144:147]
v_exp_f32 v135, v135
s_cbranch_vccnz L_sk149
s_waitcnt vmcnt(4)
L_sk149:
buffer_load_dwordx4 v2, s[16:19], s44 offen offset:1024 nt lds
v_cvt_pk_bf16_f32 v152, v120, v121
v_cvt_pk_bf16_f32 v153, v122, v123
v_cvt_pk_bf16_f32 v154, v124, v125
v_cvt_pk_bf16_f32 v155, v126, v127
v_cvt_pk_bf16_f32 v156, v128, v129
v_cvt_pk_bf16_f32 v157, v130, v131
v_cvt_pk_bf16_f32 v158, v132, v133
v_cvt_pk_bf16_f32 v159, v134, v135
v_accvgpr_write_b32 a128, v152
v_accvgpr_write_b32 a129, v153
v_accvgpr_write_b32 a130, v154
v_accvgpr_write_b32 a131, v155
v_accvgpr_write_b32 a132, v156
v_accvgpr_write_b32 a133, v157
v_accvgpr_write_b32 a134, v158
v_accvgpr_write_b32 a135, v159
s_waitcnt vmcnt(4)
s_bitcmp1_b32 s88, 0
s_cbranch_scc0 L_ng150
s_waitcnt vmcnt(3)
L_ng150:
buffer_load_dwordx4 v3, s[16:19], s44 offen offset:2048 nt lds
v_fma_f32 v20, v20, v16, v120
v_fma_f32 v21, v21, v18, v128
v_add_f32 v20, v20, v121
v_add_f32 v21, v21, v129
v_add_f32 v20, v20, v122
v_add_f32 v21, v21, v130
v_add_f32 v20, v20, v123
v_add_f32 v21, v21, v131
v_add_f32 v20, v20, v124
v_add_f32 v21, v21, v132
v_add_f32 v20, v20, v125
v_add_f32 v21, v21, v133
v_add_f32 v20, v20, v126
v_add_f32 v21, v21, v134
v_add_f32 v20, v20, v127
v_add_f32 v21, v21, v135
s_cbranch_vccnz L_sk151
s_waitcnt vmcnt(4)
L_sk151:
buffer_load_dwordx4 v4, s[16:19], s44 offen offset:3072 nt lds
ds_read_b128 v[104:107], v5 offset:12288
ds_read_b128 v[108:111], v6 offset:12288
ds_read_b128 v[112:115], v7 offset:12288
ds_read_b128 v[116:119], v8 offset:12288
s_add_u32 s44, s44, 0x8000
s_add_u32 m0, s47, 8192
s_waitcnt vmcnt(4)
buffer_load_dwordx4 v1, s[16:19], s44 offen offset:0 nt lds
s_barrier
s_waitcnt lgkmcnt(0)
v_mfma_f32_16x16x32_bf16 v[140:143], v[104:107], v[56:59], 0
v_mfma_f32_16x16x32_bf16 v[148:151], v[104:107], v[72:75], 0
v_mfma_f32_16x16x32_bf16 v[140:143], v[108:111], v[60:63], v[140:143]
v_mfma_f32_16x16x32_bf16 v[148:151], v[108:111], v[76:79], v[148:151]
v_mfma_f32_16x16x32_bf16 v[140:143], v[112:115], v[64:67], v[140:143]
v_mfma_f32_16x16x32_bf16 v[148:151], v[112:115], v[80:83], v[148:151]
v_mfma_f32_16x16x32_bf16 v[140:143], v[116:119], v[68:71], v[140:143]
v_mfma_f32_16x16x32_bf16 v[148:151], v[116:119], v[84:87], v[148:151]
s_cbranch_vccnz L_sk153
s_waitcnt vmcnt(4)
L_sk153:
buffer_load_dwordx4 v2, s[16:19], s44 offen offset:1024 nt lds
v_max3_f32 v13, v136, v137, v138
v_max3_f32 v14, v144, v145, v146
s_nop 2
v_max3_f32 v13, v13, v139, v140
v_max3_f32 v14, v14, v147, v148
v_max3_f32 v13, v13, v141, v142
v_max3_f32 v14, v14, v149, v150
v_max_f32 v13, v13, v143
v_max_f32 v14, v14, v151
s_nop 1
v_permlane32_swap_b32 v13, v14
v_max_f32 v13, v13, v14
v_mov_b32 v14, v13
s_nop 1
v_permlane16_swap_b32 v13, v14
v_max_f32 v13, v13, v14
v_mul_f32 v13, s48, v13
v_max_f32 v15, v12, v13
v_sub_f32 v14, v12, v15
v_exp_f32 v41, v14
v_mov_b32 v12, v15
v_mov_b32 v11, v15
v_mov_b32 v16, v41
v_mov_b32 v18, v41
v_permlane32_swap_b32 v15, v11
s_nop 0
v_permlane32_swap_b32 v16, v18
s_waitcnt vmcnt(5)
s_bitcmp1_b32 s88, 1
s_cbranch_scc1 L_sk154
s_waitcnt vmcnt(4)
L_sk154:
buffer_load_dwordx4 v3, s[16:19], s44 offen offset:2048 nt lds
v_mov_b32 v241, 9
s_mov_b64 exec, 1
buffer_store_byte v241, v22, s[36:39], s42 offen
s_mov_b64 exec, -1
buffer_load_ushort v10, v240, s[36:39], 0 offen offset:128 nt
v_fma_f32 v136, v136, s48, -v15
v_fma_f32 v137, v137, s48, -v15
v_fma_f32 v138, v138, s48, -v15
v_fma_f32 v139, v139, s48, -v15
v_fma_f32 v140, v140, s48, -v15
v_fma_f32 v141, v141, s48, -v15
v_fma_f32 v142, v142, s48, -v15
v_fma_f32 v143, v143, s48, -v15
v_fma_f32 v144, v144, s48, -v11
v_fma_f32 v145, v145, s48, -v11
v_fma_f32 v146, v146, s48, -v11
v_fma_f32 v147, v147, s48, -v11
v_fma_f32 v148, v148, s48, -v11
v_fma_f32 v149, v149, s48, -v11
v_fma_f32 v150, v150, s48, -v11
v_fma_f32 v151, v151, s48, -v11
v_exp_f32 v136, v136
v_exp_f32 v137, v137
v_exp_f32 v138, v138
v_exp_f32 v139, v139
s_waitcnt vmcnt(7)
s_cbranch_vccnz L_sk155
s_waitcnt vmcnt(6)
L_sk155:
buffer_load_dwordx4 v4, s[16:19], s44 offen offset:3072 nt lds
v_exp_f32 v140, v140
v_exp_f32 v141, v141
v_exp_f32 v142, v142
v_exp_f32 v143, v143
v_exp_f32 v144, v144
v_exp_f32 v145, v145
v_exp_f32 v146, v146
v_exp_f32 v147, v147
ds_read_b128 v[88:91], v5 offset:0
ds_read_b128 v[92:95], v6 offset:0
ds_read_b128 v[96:99], v7 offset:0
ds_read_b128 v[100:103], v8 offset:0
s_add_u32 s44, s44, 0x8000
s_add_u32 m0, s47, 12288
s_waitcnt vmcnt(6)
buffer_load_dwordx4 v1, s[16:19], s44 offen offset:0 nt lds
s_barrier
s_waitcnt lgkmcnt(0)
v_mfma_f32_16x16x32_bf16 v[120:123], v[88:91], v[56:59], 0
v_mfma_f32_16x16x32_bf16 v[128:131], v[88:91], v[72:75], 0
v_exp_f32 v148, v148
v_mfma_f32_16x16x32_bf16 v[120:123], v[92:95], v[60:63], v[120:123]
v_mfma_f32_16x16x32_bf16 v[128:131], v[92:95], v[76:79], v[128:131]
v_exp_f32 v149, v149
v_mfma_f32_16x16x32_bf16 v[120:123], v[96:99], v[64:67], v[120:123]
v_mfma_f32_16x16x32_bf16 v[128:131], v[96:99], v[80:83], v[128:131]
v_exp_f32 v150, v150
v_mfma_f32_16x16x32_bf16 v[120:123], v[100:103], v[68:71], v[120:123]
v_mfma_f32_16x16x32_bf16 v[128:131], v[100:103], v[84:87], v[128:131]
v_exp_f32 v151, v151
s_cbranch_vccnz L_sk157
s_waitcnt vmcnt(6)
L_sk157:
buffer_load_dwordx4 v2, s[16:19], s44 offen offset:1024 nt lds
v_cvt_pk_bf16_f32 v152, v136, v137
v_cvt_pk_bf16_f32 v153, v138, v139
v_cvt_pk_bf16_f32 v154, v140, v141
v_cvt_pk_bf16_f32 v155, v142, v143
v_cvt_pk_bf16_f32 v156, v144, v145
v_cvt_pk_bf16_f32 v157, v146, v147
v_cvt_pk_bf16_f32 v158, v148, v149
v_cvt_pk_bf16_f32 v159, v150, v151
v_accvgpr_write_b32 a136, v152
v_accvgpr_write_b32 a137, v153
v_accvgpr_write_b32 a138, v154
v_accvgpr_write_b32 a139, v155
v_accvgpr_write_b32 a140, v156
v_accvgpr_write_b32 a141, v157
v_accvgpr_write_b32 a142, v158
v_accvgpr_write_b32 a143, v159
s_waitcnt vmcnt(6)
s_bitcmp1_b32 s88, 0
s_cbranch_scc0 L_ng158
s_waitcnt vmcnt(5)
L_ng158:
buffer_load_dwordx4 v3, s[16:19], s44 offen offset:2048 nt lds
v_fma_f32 v20, v20, v16, v136
v_fma_f32 v21, v21, v18, v144
v_add_f32 v20, v20, v137
v_add_f32 v21, v21, v145
v_add_f32 v20, v20, v138
v_add_f32 v21, v21, v146
v_add_f32 v20, v20, v139
v_add_f32 v21, v21, v147
v_add_f32 v20, v20, v140
v_add_f32 v21, v21, v148
v_add_f32 v20, v20, v141
v_add_f32 v21, v21, v149
v_add_f32 v20, v20, v142
v_add_f32 v21, v21, v150
v_add_f32 v20, v20, v143
v_add_f32 v21, v21, v151
s_cbranch_vccnz L_sk159
s_waitcnt vmcnt(6)
L_sk159:
buffer_load_dwordx4 v4, s[16:19], s44 offen offset:3072 nt lds
ds_read_b128 v[104:107], v5 offset:4096
ds_read_b128 v[108:111], v6 offset:4096
ds_read_b128 v[112:115], v7 offset:4096
ds_read_b128 v[116:119], v8 offset:4096
s_add_u32 s44, s44, 0x8000
s_add_u32 m0, s47, 0
s_waitcnt vmcnt(4)
buffer_load_dwordx4 v1, s[16:19], s44 offen offset:0 nt lds
s_barrier
s_waitcnt lgkmcnt(0)
v_mfma_f32_16x16x32_bf16 v[124:127], v[104:107], v[56:59], 0
v_mfma_f32_16x16x32_bf16 v[132:135], v[104:107], v[72:75], 0
v_mfma_f32_16x16x32_bf16 v[124:127], v[108:111], v[60:63], v[124:127]
v_mfma_f32_16x16x32_bf16 v[132:135], v[108:111], v[76:79], v[132:135]
v_mfma_f32_16x16x32_bf16 v[124:127], v[112:115], v[64:67], v[124:127]
v_mfma_f32_16x16x32_bf16 v[132:135], v[112:115], v[80:83], v[132:135]
v_mfma_f32_16x16x32_bf16 v[124:127], v[116:119], v[68:71], v[124:127]
v_mfma_f32_16x16x32_bf16 v[132:135], v[116:119], v[84:87], v[132:135]
s_cbranch_vccnz L_sk161
s_waitcnt vmcnt(4)
L_sk161:
buffer_load_dwordx4 v2, s[16:19], s44 offen offset:1024 nt lds
v_max3_f32 v13, v120, v121, v122
v_max3_f32 v14, v128, v129, v130
s_nop 2
v_max3_f32 v13, v13, v123, v124
v_max3_f32 v14, v14, v131, v132
v_max3_f32 v13, v13, v125, v126
v_max3_f32 v14, v14, v133, v134
v_max_f32 v13, v13, v127
v_max_f32 v14, v14, v135
s_nop 1
v_permlane32_swap_b32 v13, v14
v_max_f32 v13, v13, v14
v_mov_b32 v14, v13
s_nop 1
v_permlane16_swap_b32 v13, v14
v_max_f32 v13, v13, v14
v_mul_f32 v13, s48, v13
v_max_f32 v15, v12, v13
v_sub_f32 v14, v12, v15
v_exp_f32 v42, v14
v_mov_b32 v12, v15
v_mov_b32 v11, v15
v_mov_b32 v16, v42
v_mov_b32 v18, v42
v_permlane32_swap_b32 v15, v11
s_nop 0
v_permlane32_swap_b32 v16, v18
s_waitcnt vmcnt(5)
s_bitcmp1_b32 s88, 1
s_cbranch_scc1 L_sk162
s_waitcnt vmcnt(4)
L_sk162:
buffer_load_dwordx4 v3, s[16:19], s44 offen offset:2048 nt lds
v_and_b32 v241, 0xff, v10
v_lshrrev_b32 v10, 8, v10
v_cmp_le_u32 vcc, 9, v241
v_cmp_le_u32 s[90:91], 9, v10
s_nop 0
s_bcnt1_i32_b64 s88, vcc
s_bcnt1_i32_b64 s90, s[90:91]
s_add_u32 s90, s90, s88
s_add_u32 s90, s90, s43
s_cmp_ge_u32 s90, 15
s_cselect_b32 s88, 2, 0
s_cmp_le_u32 s90, 5
s_cselect_b32 s88, 1, s88
s_cmp_ge_u32 s90, 10
s_cselect_b64 vcc, -1, 0
v_fma_f32 v120, v120, s48, -v15
v_fma_f32 v121, v121, s48, -v15
v_fma_f32 v122, v122, s48, -v15
v_fma_f32 v123, v123, s48, -v15
v_fma_f32 v124, v124, s48, -v15
v_fma_f32 v125, v125, s48, -v15
v_fma_f32 v126, v126, s48, -v15
v_fma_f32 v127, v127, s48, -v15
v_fma_f32 v128, v128, s48, -v11
v_fma_f32 v129, v129, s48, -v11
v_fma_f32 v130, v130, s48, -v11
v_fma_f32 v131, v131, s48, -v11
v_fma_f32 v132, v132, s48, -v11
v_fma_f32 v133, v133, s48, -v11
v_fma_f32 v134, v134, s48, -v11
v_fma_f32 v135, v135, s48, -v11
v_exp_f32 v120, v120
v_exp_f32 v121, v121
v_exp_f32 v122, v122
v_exp_f32 v123, v123
s_waitcnt vmcnt(5)
s_cbranch_vccnz L_sk163
s_waitcnt vmcnt(4)
L_sk163:
buffer_load_dwordx4 v4, s[16:19], s44 offen offset:3072 nt lds
v_exp_f32 v124, v124
v_exp_f32 v125, v125
v_exp_f32 v126, v126
v_exp_f32 v127, v127
v_exp_f32 v128, v128
v_exp_f32 v129, v129
v_exp_f32 v130, v130
v_exp_f32 v131, v131
ds_read_b128 v[88:91], v5 offset:8192
ds_read_b128 v[92:95], v6 offset:8192
ds_read_b128 v[96:99], v7 offset:8192
ds_read_b128 v[100:103], v8 offset:8192
s_add_u32 s44, s44, 0x8000
s_add_u32 m0, s47, 4096
s_waitcnt vmcnt(4)
buffer_load_dwordx4 v1, s[16:19], s44 offen offset:0 nt lds
s_barrier
s_waitcnt lgkmcnt(0)
v_mfma_f32_16x16x32_bf16 v[136:139], v[88:91], v[56:59], 0
v_mfma_f32_16x16x32_bf16 v[144:147], v[88:91], v[72:75], 0
v_exp_f32 v132, v132
v_mfma_f32_16x16x32_bf16 v[136:139], v[92:95], v[60:63], v[136:139]
v_mfma_f32_16x16x32_bf16 v[144:147], v[92:95], v[76:79], v[144:147]
v_exp_f32 v133, v133
v_mfma_f32_16x16x32_bf16 v[136:139], v[96:99], v[64:67], v[136:139]
v_mfma_f32_16x16x32_bf16 v[144:147], v[96:99], v[80:83], v[144:147]
v_exp_f32 v134, v134
v_mfma_f32_16x16x32_bf16 v[136:139], v[100:103], v[68:71], v[136:139]
v_mfma_f32_16x16x32_bf16 v[144:147], v[100:103], v[84:87], v[144:147]
v_exp_f32 v135, v135
s_cbranch_vccnz L_sk165
s_waitcnt vmcnt(4)
L_sk165:
buffer_load_dwordx4 v2, s[16:19], s44 offen offset:1024 nt lds
v_cvt_pk_bf16_f32 v152, v120, v121
v_cvt_pk_bf16_f32 v153, v122, v123
v_cvt_pk_bf16_f32 v154, v124, v125
v_cvt_pk_bf16_f32 v155, v126, v127
v_cvt_pk_bf16_f32 v156, v128, v129
v_cvt_pk_bf16_f32 v157, v130, v131
v_cvt_pk_bf16_f32 v158, v132, v133
v_cvt_pk_bf16_f32 v159, v134, v135
v_accvgpr_write_b32 a144, v152
v_accvgpr_write_b32 a145, v153
v_accvgpr_write_b32 a146, v154
v_accvgpr_write_b32 a147, v155
v_accvgpr_write_b32 a148, v156
v_accvgpr_write_b32 a149, v157
v_accvgpr_write_b32 a150, v158
v_accvgpr_write_b32 a151, v159
s_waitcnt vmcnt(4)
s_bitcmp1_b32 s88, 0
s_cbranch_scc0 L_ng166
s_waitcnt vmcnt(3)
L_ng166:
buffer_load_dwordx4 v3, s[16:19], s44 offen offset:2048 nt lds
v_fma_f32 v20, v20, v16, v120
v_fma_f32 v21, v21, v18, v128
v_add_f32 v20, v20, v121
v_add_f32 v21, v21, v129
v_add_f32 v20, v20, v122
v_add_f32 v21, v21, v130
v_add_f32 v20, v20, v123
v_add_f32 v21, v21, v131
v_add_f32 v20, v20, v124
v_add_f32 v21, v21, v132
v_add_f32 v20, v20, v125
v_add_f32 v21, v21, v133
v_add_f32 v20, v20, v126
v_add_f32 v21, v21, v134
v_add_f32 v20, v20, v127
v_add_f32 v21, v21, v135
s_cbranch_vccnz L_sk167
s_waitcnt vmcnt(4)
L_sk167:
buffer_load_dwordx4 v4, s[16:19], s44 offen offset:3072 nt lds
ds_read_b128 v[104:107], v5 offset:12288
ds_read_b128 v[108:111], v6 offset:12288
ds_read_b128 v[112:115], v7 offset:12288
ds_read_b128 v[116:119], v8 offset:12288
s_add_u32 s44, s44, 0x8000
s_add_u32 m0, s47, 8192
s_waitcnt vmcnt(4)
buffer_load_dwordx4 v1, s[16:19], s44 offen offset:0 nt lds
s_barrier
s_waitcnt lgkmcnt(0)
v_mfma_f32_16x16x32_bf16 v[140:143], v[104:107], v[56:59], 0
v_mfma_f32_16x16x32_bf16 v[148:151], v[104:107], v[72:75], 0
v_mfma_f32_16x16x32_bf16 v[140:143], v[108:111], v[60:63], v[140:143]
v_mfma_f32_16x16x32_bf16 v[148:151], v[108:111], v[76:79], v[148:151]
v_mfma_f32_16x16x32_bf16 v[140:143], v[112:115], v[64:67], v[140:143]
v_mfma_f32_16x16x32_bf16 v[148:151], v[112:115], v[80:83], v[148:151]
v_mfma_f32_16x16x32_bf16 v[140:143], v[116:119], v[68:71], v[140:143]
v_mfma_f32_16x16x32_bf16 v[148:151], v[116:119], v[84:87], v[148:151]
s_cbranch_vccnz L_sk169
s_waitcnt vmcnt(4)
L_sk169:
buffer_load_dwordx4 v2, s[16:19], s44 offen offset:1024 nt lds
v_max3_f32 v13, v136, v137, v138
v_max3_f32 v14, v144, v145, v146
s_nop 2
v_max3_f32 v13, v13, v139, v140
v_max3_f32 v14, v14, v147, v148
v_max3_f32 v13, v13, v141, v142
v_max3_f32 v14, v14, v149, v150
v_max_f32 v13, v13, v143
v_max_f32 v14, v14, v151
s_nop 1
v_permlane32_swap_b32 v13, v14
v_max_f32 v13, v13, v14
v_mov_b32 v14, v13
s_nop 1
v_permlane16_swap_b32 v13, v14
v_max_f32 v13, v13, v14
v_mul_f32 v13, s48, v13
v_max_f32 v15, v12, v13
v_sub_f32 v14, v12, v15
v_exp_f32 v43, v14
v_mov_b32 v12, v15
v_mov_b32 v11, v15
v_mov_b32 v16, v43
v_mov_b32 v18, v43
v_permlane32_swap_b32 v15, v11
s_nop 0
v_permlane32_swap_b32 v16, v18
s_waitcnt vmcnt(5)
s_bitcmp1_b32 s88, 1
s_cbranch_scc1 L_sk170
s_waitcnt vmcnt(4)
L_sk170:
buffer_load_dwordx4 v3, s[16:19], s44 offen offset:2048 nt lds
v_mov_b32 v241, 10
s_mov_b64 exec, 1
buffer_store_byte v241, v22, s[36:39], s42 offen
s_mov_b64 exec, -1
buffer_load_ushort v10, v240, s[36:39], 0 offen offset:128 nt
v_fma_f32 v136, v136, s48, -v15
v_fma_f32 v137, v137, s48, -v15
v_fma_f32 v138, v138, s48, -v15
v_fma_f32 v139, v139, s48, -v15
v_fma_f32 v140, v140, s48, -v15
v_fma_f32 v141, v141, s48, -v15
v_fma_f32 v142, v142, s48, -v15
v_fma_f32 v143, v143, s48, -v15
v_fma_f32 v144, v144, s48, -v11
v_fma_f32 v145, v145, s48, -v11
v_fma_f32 v146, v146, s48, -v11
v_fma_f32 v147, v147, s48, -v11
v_fma_f32 v148, v148, s48, -v11
v_fma_f32 v149, v149, s48, -v11
v_fma_f32 v150, v150, s48, -v11
v_fma_f32 v151, v151, s48, -v11
v_exp_f32 v136, v136
v_exp_f32 v137, v137
v_exp_f32 v138, v138
v_exp_f32 v139, v139
s_waitcnt vmcnt(7)
s_cbranch_vccnz L_sk171
s_waitcnt vmcnt(6)
L_sk171:
buffer_load_dwordx4 v4, s[16:19], s44 offen offset:3072 nt lds
v_exp_f32 v140, v140
v_exp_f32 v141, v141
v_exp_f32 v142, v142
v_exp_f32 v143, v143
v_exp_f32 v144, v144
v_exp_f32 v145, v145
v_exp_f32 v146, v146
v_exp_f32 v147, v147
ds_read_b128 v[88:91], v5 offset:0
ds_read_b128 v[92:95], v6 offset:0
ds_read_b128 v[96:99], v7 offset:0
ds_read_b128 v[100:103], v8 offset:0
s_add_u32 s44, s44, 0x8000
s_add_u32 m0, s47, 12288
s_waitcnt vmcnt(6)
buffer_load_dwordx4 v1, s[16:19], s44 offen offset:0 nt lds
s_barrier
s_waitcnt lgkmcnt(0)
v_mfma_f32_16x16x32_bf16 v[120:123], v[88:91], v[56:59], 0
v_mfma_f32_16x16x32_bf16 v[128:131], v[88:91], v[72:75], 0
v_exp_f32 v148, v148
v_mfma_f32_16x16x32_bf16 v[120:123], v[92:95], v[60:63], v[120:123]
v_mfma_f32_16x16x32_bf16 v[128:131], v[92:95], v[76:79], v[128:131]
v_exp_f32 v149, v149
v_mfma_f32_16x16x32_bf16 v[120:123], v[96:99], v[64:67], v[120:123]
v_mfma_f32_16x16x32_bf16 v[128:131], v[96:99], v[80:83], v[128:131]
v_exp_f32 v150, v150
v_mfma_f32_16x16x32_bf16 v[120:123], v[100:103], v[68:71], v[120:123]
v_mfma_f32_16x16x32_bf16 v[128:131], v[100:103], v[84:87], v[128:131]
v_exp_f32 v151, v151
s_cbranch_vccnz L_sk173
s_waitcnt vmcnt(6)
L_sk173:
buffer_load_dwordx4 v2, s[16:19], s44 offen offset:1024 nt lds
v_cvt_pk_bf16_f32 v152, v136, v137
v_cvt_pk_bf16_f32 v153, v138, v139
v_cvt_pk_bf16_f32 v154, v140, v141
v_cvt_pk_bf16_f32 v155, v142, v143
v_cvt_pk_bf16_f32 v156, v144, v145
v_cvt_pk_bf16_f32 v157, v146, v147
v_cvt_pk_bf16_f32 v158, v148, v149
v_cvt_pk_bf16_f32 v159, v150, v151
v_accvgpr_write_b32 a152, v152
v_accvgpr_write_b32 a153, v153
v_accvgpr_write_b32 a154, v154
v_accvgpr_write_b32 a155, v155
v_accvgpr_write_b32 a156, v156
v_accvgpr_write_b32 a157, v157
v_accvgpr_write_b32 a158, v158
v_accvgpr_write_b32 a159, v159
s_waitcnt vmcnt(6)
s_bitcmp1_b32 s88, 0
s_cbranch_scc0 L_ng174
s_waitcnt vmcnt(5)
L_ng174:
buffer_load_dwordx4 v3, s[16:19], s44 offen offset:2048 nt lds
v_fma_f32 v20, v20, v16, v136
v_fma_f32 v21, v21, v18, v144
v_add_f32 v20, v20, v137
v_add_f32 v21, v21, v145
v_add_f32 v20, v20, v138
v_add_f32 v21, v21, v146
v_add_f32 v20, v20, v139
v_add_f32 v21, v21, v147
v_add_f32 v20, v20, v140
v_add_f32 v21, v21, v148
v_add_f32 v20, v20, v141
v_add_f32 v21, v21, v149
v_add_f32 v20, v20, v142
v_add_f32 v21, v21, v150
v_add_f32 v20, v20, v143
v_add_f32 v21, v21, v151
s_cbranch_vccnz L_sk175
s_waitcnt vmcnt(6)
L_sk175:
buffer_load_dwordx4 v4, s[16:19], s44 offen offset:3072 nt lds
ds_read_b128 v[104:107], v5 offset:4096
ds_read_b128 v[108:111], v6 offset:4096
ds_read_b128 v[112:115], v7 offset:4096
ds_read_b128 v[116:119], v8 offset:4096
s_add_u32 s44, s44, 0x8000
s_add_u32 m0, s47, 0
s_waitcnt vmcnt(4)
buffer_load_dwordx4 v1, s[16:19], s44 offen offset:0 nt lds
s_barrier
s_waitcnt lgkmcnt(0)
v_mfma_f32_16x16x32_bf16 v[124:127], v[104:107], v[56:59], 0
v_mfma_f32_16x16x32_bf16 v[132:135], v[104:107], v[72:75], 0
v_mfma_f32_16x16x32_bf16 v[124:127], v[108:111], v[60:63], v[124:127]
v_mfma_f32_16x16x32_bf16 v[132:135], v[108:111], v[76:79], v[132:135]
v_mfma_f32_16x16x32_bf16 v[124:127], v[112:115], v[64:67], v[124:127]
v_mfma_f32_16x16x32_bf16 v[132:135], v[112:115], v[80:83], v[132:135]
v_mfma_f32_16x16x32_bf16 v[124:127], v[116:119], v[68:71], v[124:127]
v_mfma_f32_16x16x32_bf16 v[132:135], v[116:119], v[84:87], v[132:135]
s_cbranch_vccnz L_sk177
s_waitcnt vmcnt(4)
L_sk177:
buffer_load_dwordx4 v2, s[16:19], s44 offen offset:1024 nt lds
v_max3_f32 v13, v120, v121, v122
v_max3_f32 v14, v128, v129, v130
s_nop 2
v_max3_f32 v13, v13, v123, v124
v_max3_f32 v14, v14, v131, v132
v_max3_f32 v13, v13, v125, v126
v_max3_f32 v14, v14, v133, v134
v_max_f32 v13, v13, v127
v_max_f32 v14, v14, v135
s_nop 1
v_permlane32_swap_b32 v13, v14
v_max_f32 v13, v13, v14
v_mov_b32 v14, v13
s_nop 1
v_permlane16_swap_b32 v13, v14
v_max_f32 v13, v13, v14
v_mul_f32 v13, s48, v13
v_max_f32 v15, v12, v13
v_sub_f32 v14, v12, v15
v_exp_f32 v44, v14
v_mov_b32 v12, v15
v_mov_b32 v11, v15
v_mov_b32 v16, v44
v_mov_b32 v18, v44
v_permlane32_swap_b32 v15, v11
s_nop 0
v_permlane32_swap_b32 v16, v18
s_waitcnt vmcnt(5)
s_bitcmp1_b32 s88, 1
s_cbranch_scc1 L_sk178
s_waitcnt vmcnt(4)
L_sk178:
buffer_load_dwordx4 v3, s[16:19], s44 offen offset:2048 nt lds
v_and_b32 v241, 0xff, v10
v_lshrrev_b32 v10, 8, v10
v_cmp_le_u32 vcc, 10, v241
v_cmp_le_u32 s[90:91], 10, v10
s_nop 0
s_bcnt1_i32_b64 s88, vcc
s_bcnt1_i32_b64 s90, s[90:91]
s_add_u32 s90, s90, s88
s_add_u32 s90, s90, s43
s_cmp_ge_u32 s90, 15
s_cselect_b32 s88, 2, 0
s_cmp_le_u32 s90, 5
s_cselect_b32 s88, 1, s88
s_cmp_ge_u32 s90, 10
s_cselect_b64 vcc, -1, 0
v_fma_f32 v120, v120, s48, -v15
v_fma_f32 v121, v121, s48, -v15
v_fma_f32 v122, v122, s48, -v15
v_fma_f32 v123, v123, s48, -v15
v_fma_f32 v124, v124, s48, -v15
v_fma_f32 v125, v125, s48, -v15
v_fma_f32 v126, v126, s48, -v15
v_fma_f32 v127, v127, s48, -v15
v_fma_f32 v128, v128, s48, -v11
v_fma_f32 v129, v129, s48, -v11
v_fma_f32 v130, v130, s48, -v11
v_fma_f32 v131, v131, s48, -v11
v_fma_f32 v132, v132, s48, -v11
v_fma_f32 v133, v133, s48, -v11
v_fma_f32 v134, v134, s48, -v11
v_fma_f32 v135, v135, s48, -v11
v_exp_f32 v120, v120
v_exp_f32 v121, v121
v_exp_f32 v122, v122
v_exp_f32 v123, v123
s_waitcnt vmcnt(5)
s_cbranch_vccnz L_sk179
s_waitcnt vmcnt(4)
L_sk179:
buffer_load_dwordx4 v4, s[16:19], s44 offen offset:3072 nt lds
v_exp_f32 v124, v124
v_exp_f32 v125, v125
v_exp_f32 v126, v126
v_exp_f32 v127, v127
v_exp_f32 v128, v128
v_exp_f32 v129, v129
v_exp_f32 v130, v130
v_exp_f32 v131, v131
ds_read_b128 v[88:91], v5 offset:8192
ds_read_b128 v[92:95], v6 offset:8192
ds_read_b128 v[96:99], v7 offset:8192
ds_read_b128 v[100:103], v8 offset:8192
s_add_u32 s44, s44, 0x8000
s_add_u32 m0, s47, 4096
s_waitcnt vmcnt(4)
buffer_load_dwordx4 v1, s[16:19], s44 offen offset:0 nt lds
s_barrier
s_waitcnt lgkmcnt(0)
v_mfma_f32_16x16x32_bf16 v[136:139], v[88:91], v[56:59], 0
v_mfma_f32_16x16x32_bf16 v[144:147], v[88:91], v[72:75], 0
v_exp_f32 v132, v132
v_mfma_f32_16x16x32_bf16 v[136:139], v[92:95], v[60:63], v[136:139]
v_mfma_f32_16x16x32_bf16 v[144:147], v[92:95], v[76:79], v[144:147]
v_exp_f32 v133, v133
v_mfma_f32_16x16x32_bf16 v[136:139], v[96:99], v[64:67], v[136:139]
v_mfma_f32_16x16x32_bf16 v[144:147], v[96:99], v[80:83], v[144:147]
v_exp_f32 v134, v134
v_mfma_f32_16x16x32_bf16 v[136:139], v[100:103], v[68:71], v[136:139]
v_mfma_f32_16x16x32_bf16 v[144:147], v[100:103], v[84:87], v[144:147]
v_exp_f32 v135, v135
s_cbranch_vccnz L_sk181
s_waitcnt vmcnt(4)
L_sk181:
buffer_load_dwordx4 v2, s[16:19], s44 offen offset:1024 nt lds
v_cvt_pk_bf16_f32 v152, v120, v121
v_cvt_pk_bf16_f32 v153, v122, v123
v_cvt_pk_bf16_f32 v154, v124, v125
v_cvt_pk_bf16_f32 v155, v126, v127
v_cvt_pk_bf16_f32 v156, v128, v129
v_cvt_pk_bf16_f32 v157, v130, v131
v_cvt_pk_bf16_f32 v158, v132, v133
v_cvt_pk_bf16_f32 v159, v134, v135
v_accvgpr_write_b32 a160, v152
v_accvgpr_write_b32 a161, v153
v_accvgpr_write_b32 a162, v154
v_accvgpr_write_b32 a163, v155
v_accvgpr_write_b32 a164, v156
v_accvgpr_write_b32 a165, v157
v_accvgpr_write_b32 a166, v158
v_accvgpr_write_b32 a167, v159
s_waitcnt vmcnt(4)
s_bitcmp1_b32 s88, 0
s_cbranch_scc0 L_ng182
s_waitcnt vmcnt(3)
L_ng182:
buffer_load_dwordx4 v3, s[16:19], s44 offen offset:2048 nt lds
v_fma_f32 v20, v20, v16, v120
v_fma_f32 v21, v21, v18, v128
v_add_f32 v20, v20, v121
v_add_f32 v21, v21, v129
v_add_f32 v20, v20, v122
v_add_f32 v21, v21, v130
v_add_f32 v20, v20, v123
v_add_f32 v21, v21, v131
v_add_f32 v20, v20, v124
v_add_f32 v21, v21, v132
v_add_f32 v20, v20, v125
v_add_f32 v21, v21, v133
v_add_f32 v20, v20, v126
v_add_f32 v21, v21, v134
v_add_f32 v20, v20, v127
v_add_f32 v21, v21, v135
s_cbranch_vccnz L_sk183
s_waitcnt vmcnt(4)
L_sk183:
buffer_load_dwordx4 v4, s[16:19], s44 offen offset:3072 nt lds
ds_read_b128 v[104:107], v5 offset:12288
ds_read_b128 v[108:111], v6 offset:12288
ds_read_b128 v[112:115], v7 offset:12288
ds_read_b128 v[116:119], v8 offset:12288
s_add_u32 s44, s44, 0x8000
s_add_u32 m0, s47, 8192
s_waitcnt vmcnt(4)
buffer_load_dwordx4 v1, s[16:19], s44 offen offset:0 nt lds
s_barrier
s_waitcnt lgkmcnt(0)
v_mfma_f32_16x16x32_bf16 v[140:143], v[104:107], v[56:59], 0
v_mfma_f32_16x16x32_bf16 v[148:151], v[104:107], v[72:75], 0
v_mfma_f32_16x16x32_bf16 v[140:143], v[108:111], v[60:63], v[140:143]
v_mfma_f32_16x16x32_bf16 v[148:151], v[108:111], v[76:79], v[148:151]
v_mfma_f32_16x16x32_bf16 v[140:143], v[112:115], v[64:67], v[140:143]
v_mfma_f32_16x16x32_bf16 v[148:151], v[112:115], v[80:83], v[148:151]
v_mfma_f32_16x16x32_bf16 v[140:143], v[116:119], v[68:71], v[140:143]
v_mfma_f32_16x16x32_bf16 v[148:151], v[116:119], v[84:87], v[148:151]
s_cbranch_vccnz L_sk185
s_waitcnt vmcnt(4)
L_sk185:
buffer_load_dwordx4 v2, s[16:19], s44 offen offset:1024 nt lds
v_max3_f32 v13, v136, v137, v138
v_max3_f32 v14, v144, v145, v146
s_nop 2
v_max3_f32 v13, v13, v139, v140
v_max3_f32 v14, v14, v147, v148
v_max3_f32 v13, v13, v141, v142
v_max3_f32 v14, v14, v149, v150
v_max_f32 v13, v13, v143
v_max_f32 v14, v14, v151
s_nop 1
v_permlane32_swap_b32 v13, v14
v_max_f32 v13, v13, v14
v_mov_b32 v14, v13
s_nop 1
v_permlane16_swap_b32 v13, v14
v_max_f32 v13, v13, v14
v_mul_f32 v13, s48, v13
v_max_f32 v15, v12, v13
v_sub_f32 v14, v12, v15
v_exp_f32 v45, v14
v_mov_b32 v12, v15
v_mov_b32 v11, v15
v_mov_b32 v16, v45
v_mov_b32 v18, v45
v_permlane32_swap_b32 v15, v11
s_nop 0
v_permlane32_swap_b32 v16, v18
s_waitcnt vmcnt(5)
s_bitcmp1_b32 s88, 1
s_cbranch_scc1 L_sk186
s_waitcnt vmcnt(4)
L_sk186:
buffer_load_dwordx4 v3, s[16:19], s44 offen offset:2048 nt lds
v_mov_b32 v241, 11
s_mov_b64 exec, 1
buffer_store_byte v241, v22, s[36:39], s42 offen
s_mov_b64 exec, -1
buffer_load_ushort v10, v240, s[36:39], 0 offen offset:128 nt
v_fma_f32 v136, v136, s48, -v15
v_fma_f32 v137, v137, s48, -v15
v_fma_f32 v138, v138, s48, -v15
v_fma_f32 v139, v139, s48, -v15
v_fma_f32 v140, v140, s48, -v15
v_fma_f32 v141, v141, s48, -v15
v_fma_f32 v142, v142, s48, -v15
v_fma_f32 v143, v143, s48, -v15
v_fma_f32 v144, v144, s48, -v11
v_fma_f32 v145, v145, s48, -v11
v_fma_f32 v146, v146, s48, -v11
v_fma_f32 v147, v147, s48, -v11
v_fma_f32 v148, v148, s48, -v11
v_fma_f32 v149, v149, s48, -v11
v_fma_f32 v150, v150, s48, -v11
v_fma_f32 v151, v151, s48, -v11
v_exp_f32 v136, v136
v_exp_f32 v137, v137
v_exp_f32 v138, v138
v_exp_f32 v139, v139
s_waitcnt vmcnt(7)
s_cbranch_vccnz L_sk187
s_waitcnt vmcnt(6)
L_sk187:
buffer_load_dwordx4 v4, s[16:19], s44 offen offset:3072 nt lds
v_exp_f32 v140, v140
v_exp_f32 v141, v141
v_exp_f32 v142, v142
v_exp_f32 v143, v143
v_exp_f32 v144, v144
v_exp_f32 v145, v145
v_exp_f32 v146, v146
v_exp_f32 v147, v147
ds_read_b128 v[88:91], v5 offset:0
ds_read_b128 v[92:95], v6 offset:0
ds_read_b128 v[96:99], v7 offset:0
ds_read_b128 v[100:103], v8 offset:0
s_add_u32 s44, s44, 0x8000
s_add_u32 m0, s47, 12288
s_waitcnt vmcnt(6)
buffer_load_dwordx4 v1, s[16:19], s44 offen offset:0 nt lds
s_barrier
s_waitcnt lgkmcnt(0)
v_mfma_f32_16x16x32_bf16 v[120:123], v[88:91], v[56:59], 0
v_mfma_f32_16x16x32_bf16 v[128:131], v[88:91], v[72:75], 0
v_exp_f32 v148, v148
v_mfma_f32_16x16x32_bf16 v[120:123], v[92:95], v[60:63], v[120:123]
v_mfma_f32_16x16x32_bf16 v[128:131], v[92:95], v[76:79], v[128:131]
v_exp_f32 v149, v149
v_mfma_f32_16x16x32_bf16 v[120:123], v[96:99], v[64:67], v[120:123]
v_mfma_f32_16x16x32_bf16 v[128:131], v[96:99], v[80:83], v[128:131]
v_exp_f32 v150, v150
v_mfma_f32_16x16x32_bf16 v[120:123], v[100:103], v[68:71], v[120:123]
v_mfma_f32_16x16x32_bf16 v[128:131], v[100:103], v[84:87], v[128:131]
v_exp_f32 v151, v151
s_cbranch_vccnz L_sk189
s_waitcnt vmcnt(6)
L_sk189:
buffer_load_dwordx4 v2, s[16:19], s44 offen offset:1024 nt lds
v_cvt_pk_bf16_f32 v152, v136, v137
v_cvt_pk_bf16_f32 v153, v138, v139
v_cvt_pk_bf16_f32 v154, v140, v141
v_cvt_pk_bf16_f32 v155, v142, v143
v_cvt_pk_bf16_f32 v156, v144, v145
v_cvt_pk_bf16_f32 v157, v146, v147
v_cvt_pk_bf16_f32 v158, v148, v149
v_cvt_pk_bf16_f32 v159, v150, v151
v_accvgpr_write_b32 a168, v152
v_accvgpr_write_b32 a169, v153
v_accvgpr_write_b32 a170, v154
v_accvgpr_write_b32 a171, v155
v_accvgpr_write_b32 a172, v156
v_accvgpr_write_b32 a173, v157
v_accvgpr_write_b32 a174, v158
v_accvgpr_write_b32 a175, v159
s_waitcnt vmcnt(6)
s_bitcmp1_b32 s88, 0
s_cbranch_scc0 L_ng190
s_waitcnt vmcnt(5)
L_ng190:
buffer_load_dwordx4 v3, s[16:19], s44 offen offset:2048 nt lds
v_fma_f32 v20, v20, v16, v136
v_fma_f32 v21, v21, v18, v144
v_add_f32 v20, v20, v137
v_add_f32 v21, v21, v145
v_add_f32 v20, v20, v138
v_add_f32 v21, v21, v146
v_add_f32 v20, v20, v139
v_add_f32 v21, v21, v147
v_add_f32 v20, v20, v140
v_add_f32 v21, v21, v148
v_add_f32 v20, v20, v141
v_add_f32 v21, v21, v149
v_add_f32 v20, v20, v142
v_add_f32 v21, v21, v150
v_add_f32 v20, v20, v143
v_add_f32 v21, v21, v151
s_cbranch_vccnz L_sk191
s_waitcnt vmcnt(6)
L_sk191:
buffer_load_dwordx4 v4, s[16:19], s44 offen offset:3072 nt lds
ds_read_b128 v[104:107], v5 offset:4096
ds_read_b128 v[108:111], v6 offset:4096
ds_read_b128 v[112:115], v7 offset:4096
ds_read_b128 v[116:119], v8 offset:4096
s_add_u32 s44, s44, 0x8000
s_add_u32 m0, s47, 0
s_waitcnt vmcnt(4)
buffer_load_dwordx4 v1, s[16:19], s44 offen offset:0 nt lds
s_barrier
s_waitcnt lgkmcnt(0)
v_mfma_f32_16x16x32_bf16 v[124:127], v[104:107], v[56:59], 0
v_mfma_f32_16x16x32_bf16 v[132:135], v[104:107], v[72:75], 0
v_mfma_f32_16x16x32_bf16 v[124:127], v[108:111], v[60:63], v[124:127]
v_mfma_f32_16x16x32_bf16 v[132:135], v[108:111], v[76:79], v[132:135]
v_mfma_f32_16x16x32_bf16 v[124:127], v[112:115], v[64:67], v[124:127]
v_mfma_f32_16x16x32_bf16 v[132:135], v[112:115], v[80:83], v[132:135]
v_mfma_f32_16x16x32_bf16 v[124:127], v[116:119], v[68:71], v[124:127]
v_mfma_f32_16x16x32_bf16 v[132:135], v[116:119], v[84:87], v[132:135]
s_cbranch_vccnz L_sk193
s_waitcnt vmcnt(4)
L_sk193:
buffer_load_dwordx4 v2, s[16:19], s44 offen offset:1024 nt lds
v_max3_f32 v13, v120, v121, v122
v_max3_f32 v14, v128, v129, v130
s_nop 2
v_max3_f32 v13, v13, v123, v124
v_max3_f32 v14, v14, v131, v132
v_max3_f32 v13, v13, v125, v126
v_max3_f32 v14, v14, v133, v134
v_max_f32 v13, v13, v127
v_max_f32 v14, v14, v135
s_nop 1
v_permlane32_swap_b32 v13, v14
v_max_f32 v13, v13, v14
v_mov_b32 v14, v13
s_nop 1
v_permlane16_swap_b32 v13, v14
v_max_f32 v13, v13, v14
v_mul_f32 v13, s48, v13
v_max_f32 v15, v12, v13
v_sub_f32 v14, v12, v15
v_exp_f32 v46, v14
v_mov_b32 v12, v15
v_mov_b32 v11, v15
v_mov_b32 v16, v46
v_mov_b32 v18, v46
v_permlane32_swap_b32 v15, v11
s_nop 0
v_permlane32_swap_b32 v16, v18
s_waitcnt vmcnt(5)
s_bitcmp1_b32 s88, 1
s_cbranch_scc1 L_sk194
s_waitcnt vmcnt(4)
L_sk194:
buffer_load_dwordx4 v3, s[16:19], s44 offen offset:2048 nt lds
v_and_b32 v241, 0xff, v10
v_lshrrev_b32 v10, 8, v10
v_cmp_le_u32 vcc, 11, v241
v_cmp_le_u32 s[90:91], 11, v10
s_nop 0
s_bcnt1_i32_b64 s88, vcc
s_bcnt1_i32_b64 s90, s[90:91]
s_add_u32 s90, s90, s88
s_add_u32 s90, s90, s43
s_cmp_ge_u32 s90, 15
s_cselect_b32 s88, 2, 0
s_cmp_le_u32 s90, 5
s_cselect_b32 s88, 1, s88
s_cmp_ge_u32 s90, 10
s_cselect_b64 vcc, -1, 0
v_fma_f32 v120, v120, s48, -v15
v_fma_f32 v121, v121, s48, -v15
v_fma_f32 v122, v122, s48, -v15
v_fma_f32 v123, v123, s48, -v15
v_fma_f32 v124, v124, s48, -v15
v_fma_f32 v125, v125, s48, -v15
v_fma_f32 v126, v126, s48, -v15
v_fma_f32 v127, v127, s48, -v15
v_fma_f32 v128, v128, s48, -v11
v_fma_f32 v129, v129, s48, -v11
v_fma_f32 v130, v130, s48, -v11
v_fma_f32 v131, v131, s48, -v11
v_fma_f32 v132, v132, s48, -v11
v_fma_f32 v133, v133, s48, -v11
v_fma_f32 v134, v134, s48, -v11
v_fma_f32 v135, v135, s48, -v11
v_exp_f32 v120, v120
v_exp_f32 v121, v121
v_exp_f32 v122, v122
v_exp_f32 v123, v123
s_waitcnt vmcnt(5)
s_cbranch_vccnz L_sk195
s_waitcnt vmcnt(4)
L_sk195:
buffer_load_dwordx4 v4, s[16:19], s44 offen offset:3072 nt lds
v_exp_f32 v124, v124
v_exp_f32 v125, v125
v_exp_f32 v126, v126
v_exp_f32 v127, v127
v_exp_f32 v128, v128
v_exp_f32 v129, v129
v_exp_f32 v130, v130
v_exp_f32 v131, v131
ds_read_b128 v[88:91], v5 offset:8192
ds_read_b128 v[92:95], v6 offset:8192
ds_read_b128 v[96:99], v7 offset:8192
ds_read_b128 v[100:103], v8 offset:8192
s_add_u32 s44, s44, 0x8000
s_add_u32 m0, s47, 4096
s_waitcnt vmcnt(4)
buffer_load_dwordx4 v1, s[16:19], s44 offen offset:0 nt lds
s_barrier
s_waitcnt lgkmcnt(0)
v_mfma_f32_16x16x32_bf16 v[136:139], v[88:91], v[56:59], 0
v_mfma_f32_16x16x32_bf16 v[144:147], v[88:91], v[72:75], 0
v_exp_f32 v132, v132
v_mfma_f32_16x16x32_bf16 v[136:139], v[92:95], v[60:63], v[136:139]
v_mfma_f32_16x16x32_bf16 v[144:147], v[92:95], v[76:79], v[144:147]
v_exp_f32 v133, v133
v_mfma_f32_16x16x32_bf16 v[136:139], v[96:99], v[64:67], v[136:139]
v_mfma_f32_16x16x32_bf16 v[144:147], v[96:99], v[80:83], v[144:147]
v_exp_f32 v134, v134
v_mfma_f32_16x16x32_bf16 v[136:139], v[100:103], v[68:71], v[136:139]
v_mfma_f32_16x16x32_bf16 v[144:147], v[100:103], v[84:87], v[144:147]
v_exp_f32 v135, v135
s_cbranch_vccnz L_sk197
s_waitcnt vmcnt(4)
L_sk197:
buffer_load_dwordx4 v2, s[16:19], s44 offen offset:1024 nt lds
v_cvt_pk_bf16_f32 v152, v120, v121
v_cvt_pk_bf16_f32 v153, v122, v123
v_cvt_pk_bf16_f32 v154, v124, v125
v_cvt_pk_bf16_f32 v155, v126, v127
v_cvt_pk_bf16_f32 v156, v128, v129
v_cvt_pk_bf16_f32 v157, v130, v131
v_cvt_pk_bf16_f32 v158, v132, v133
v_cvt_pk_bf16_f32 v159, v134, v135
v_accvgpr_write_b32 a176, v152
v_accvgpr_write_b32 a177, v153
v_accvgpr_write_b32 a178, v154
v_accvgpr_write_b32 a179, v155
v_accvgpr_write_b32 a180, v156
v_accvgpr_write_b32 a181, v157
v_accvgpr_write_b32 a182, v158
v_accvgpr_write_b32 a183, v159
s_waitcnt vmcnt(4)
s_bitcmp1_b32 s88, 0
s_cbranch_scc0 L_ng198
s_waitcnt vmcnt(3)
L_ng198:
buffer_load_dwordx4 v3, s[16:19], s44 offen offset:2048 nt lds
v_fma_f32 v20, v20, v16, v120
v_fma_f32 v21, v21, v18, v128
v_add_f32 v20, v20, v121
v_add_f32 v21, v21, v129
v_add_f32 v20, v20, v122
v_add_f32 v21, v21, v130
v_add_f32 v20, v20, v123
v_add_f32 v21, v21, v131
v_add_f32 v20, v20, v124
v_add_f32 v21, v21, v132
v_add_f32 v20, v20, v125
v_add_f32 v21, v21, v133
v_add_f32 v20, v20, v126
v_add_f32 v21, v21, v134
v_add_f32 v20, v20, v127
v_add_f32 v21, v21, v135
s_cbranch_vccnz L_sk199
s_waitcnt vmcnt(4)
L_sk199:
buffer_load_dwordx4 v4, s[16:19], s44 offen offset:3072 nt lds
ds_read_b128 v[104:107], v5 offset:12288
ds_read_b128 v[108:111], v6 offset:12288
ds_read_b128 v[112:115], v7 offset:12288
ds_read_b128 v[116:119], v8 offset:12288
s_add_u32 s44, s44, 0x8000
s_add_u32 m0, s47, 8192
s_waitcnt vmcnt(4)
buffer_load_dwordx4 v1, s[16:19], s44 offen offset:0 nt lds
s_barrier
s_waitcnt lgkmcnt(0)
v_mfma_f32_16x16x32_bf16 v[140:143], v[104:107], v[56:59], 0
v_mfma_f32_16x16x32_bf16 v[148:151], v[104:107], v[72:75], 0
v_mfma_f32_16x16x32_bf16 v[140:143], v[108:111], v[60:63], v[140:143]
v_mfma_f32_16x16x32_bf16 v[148:151], v[108:111], v[76:79], v[148:151]
v_mfma_f32_16x16x32_bf16 v[140:143], v[112:115], v[64:67], v[140:143]
v_mfma_f32_16x16x32_bf16 v[148:151], v[112:115], v[80:83], v[148:151]
v_mfma_f32_16x16x32_bf16 v[140:143], v[116:119], v[68:71], v[140:143]
v_mfma_f32_16x16x32_bf16 v[148:151], v[116:119], v[84:87], v[148:151]
s_cbranch_vccnz L_sk201
s_waitcnt vmcnt(4)
L_sk201:
buffer_load_dwordx4 v2, s[16:19], s44 offen offset:1024 nt lds
v_max3_f32 v13, v136, v137, v138
v_max3_f32 v14, v144, v145, v146
s_nop 2
v_max3_f32 v13, v13, v139, v140
v_max3_f32 v14, v14, v147, v148
v_max3_f32 v13, v13, v141, v142
v_max3_f32 v14, v14, v149, v150
v_max_f32 v13, v13, v143
v_max_f32 v14, v14, v151
s_nop 1
v_permlane32_swap_b32 v13, v14
v_max_f32 v13, v13, v14
v_mov_b32 v14, v13
s_nop 1
v_permlane16_swap_b32 v13, v14
v_max_f32 v13, v13, v14
v_mul_f32 v13, s48, v13
v_max_f32 v15, v12, v13
v_sub_f32 v14, v12, v15
v_exp_f32 v47, v14
v_mov_b32 v12, v15
v_mov_b32 v11, v15
v_mov_b32 v16, v47
v_mov_b32 v18, v47
v_permlane32_swap_b32 v15, v11
s_nop 0
v_permlane32_swap_b32 v16, v18
s_waitcnt vmcnt(5)
s_bitcmp1_b32 s88, 1
s_cbranch_scc1 L_sk202
s_waitcnt vmcnt(4)
L_sk202:
buffer_load_dwordx4 v3, s[16:19], s44 offen offset:2048 nt lds
v_mov_b32 v241, 12
s_mov_b64 exec, 1
buffer_store_byte v241, v22, s[36:39], s42 offen
s_mov_b64 exec, -1
buffer_load_ushort v10, v240, s[36:39], 0 offen offset:128 nt
v_fma_f32 v136, v136, s48, -v15
v_fma_f32 v137, v137, s48, -v15
v_fma_f32 v138, v138, s48, -v15
v_fma_f32 v139, v139, s48, -v15
v_fma_f32 v140, v140, s48, -v15
v_fma_f32 v141, v141, s48, -v15
v_fma_f32 v142, v142, s48, -v15
v_fma_f32 v143, v143, s48, -v15
v_fma_f32 v144, v144, s48, -v11
v_fma_f32 v145, v145, s48, -v11
v_fma_f32 v146, v146, s48, -v11
v_fma_f32 v147, v147, s48, -v11
v_fma_f32 v148, v148, s48, -v11
v_fma_f32 v149, v149, s48, -v11
v_fma_f32 v150, v150, s48, -v11
v_fma_f32 v151, v151, s48, -v11
v_exp_f32 v136, v136
v_exp_f32 v137, v137
v_exp_f32 v138, v138
v_exp_f32 v139, v139
s_waitcnt vmcnt(7)
s_cbranch_vccnz L_sk203
s_waitcnt vmcnt(6)
L_sk203:
buffer_load_dwordx4 v4, s[16:19], s44 offen offset:3072 nt lds
v_exp_f32 v140, v140
v_exp_f32 v141, v141
v_exp_f32 v142, v142
v_exp_f32 v143, v143
v_exp_f32 v144, v144
v_exp_f32 v145, v145
v_exp_f32 v146, v146
v_exp_f32 v147, v147
ds_read_b128 v[88:91], v5 offset:0
ds_read_b128 v[92:95], v6 offset:0
ds_read_b128 v[96:99], v7 offset:0
ds_read_b128 v[100:103], v8 offset:0
s_add_u32 s44, s44, 0x8000
s_add_u32 m0, s47, 12288
s_waitcnt vmcnt(6)
buffer_load_dwordx4 v1, s[16:19], s44 offen offset:0 nt lds
s_barrier
s_waitcnt lgkmcnt(0)
v_mfma_f32_16x16x32_bf16 v[120:123], v[88:91], v[56:59], 0
v_mfma_f32_16x16x32_bf16 v[128:131], v[88:91], v[72:75], 0
v_exp_f32 v148, v148
v_mfma_f32_16x16x32_bf16 v[120:123], v[92:95], v[60:63], v[120:123]
v_mfma_f32_16x16x32_bf16 v[128:131], v[92:95], v[76:79], v[128:131]
v_exp_f32 v149, v149
v_mfma_f32_16x16x32_bf16 v[120:123], v[96:99], v[64:67], v[120:123]
v_mfma_f32_16x16x32_bf16 v[128:131], v[96:99], v[80:83], v[128:131]
v_exp_f32 v150, v150
v_mfma_f32_16x16x32_bf16 v[120:123], v[100:103], v[68:71], v[120:123]
v_mfma_f32_16x16x32_bf16 v[128:131], v[100:103], v[84:87], v[128:131]
v_exp_f32 v151, v151
s_cbranch_vccnz L_sk205
s_waitcnt vmcnt(6)
L_sk205:
buffer_load_dwordx4 v2, s[16:19], s44 offen offset:1024 nt lds
v_cvt_pk_bf16_f32 v152, v136, v137
v_cvt_pk_bf16_f32 v153, v138, v139
v_cvt_pk_bf16_f32 v154, v140, v141
v_cvt_pk_bf16_f32 v155, v142, v143
v_cvt_pk_bf16_f32 v156, v144, v145
v_cvt_pk_bf16_f32 v157, v146, v147
v_cvt_pk_bf16_f32 v158, v148, v149
v_cvt_pk_bf16_f32 v159, v150, v151
v_accvgpr_write_b32 a184, v152
v_accvgpr_write_b32 a185, v153
v_accvgpr_write_b32 a186, v154
v_accvgpr_write_b32 a187, v155
v_accvgpr_write_b32 a188, v156
v_accvgpr_write_b32 a189, v157
v_accvgpr_write_b32 a190, v158
v_accvgpr_write_b32 a191, v159
s_waitcnt vmcnt(6)
s_bitcmp1_b32 s88, 0
s_cbranch_scc0 L_ng206
s_waitcnt vmcnt(5)
L_ng206:
buffer_load_dwordx4 v3, s[16:19], s44 offen offset:2048 nt lds
v_fma_f32 v20, v20, v16, v136
v_fma_f32 v21, v21, v18, v144
v_add_f32 v20, v20, v137
v_add_f32 v21, v21, v145
v_add_f32 v20, v20, v138
v_add_f32 v21, v21, v146
v_add_f32 v20, v20, v139
v_add_f32 v21, v21, v147
v_add_f32 v20, v20, v140
v_add_f32 v21, v21, v148
v_add_f32 v20, v20, v141
v_add_f32 v21, v21, v149
v_add_f32 v20, v20, v142
v_add_f32 v21, v21, v150
v_add_f32 v20, v20, v143
v_add_f32 v21, v21, v151
s_cbranch_vccnz L_sk207
s_waitcnt vmcnt(6)
L_sk207:
buffer_load_dwordx4 v4, s[16:19], s44 offen offset:3072 nt lds
ds_read_b128 v[104:107], v5 offset:4096
ds_read_b128 v[108:111], v6 offset:4096
ds_read_b128 v[112:115], v7 offset:4096
ds_read_b128 v[116:119], v8 offset:4096
s_add_u32 s44, s44, 0x8000
s_add_u32 m0, s47, 0
s_waitcnt vmcnt(4)
buffer_load_dwordx4 v1, s[16:19], s44 offen offset:0 nt lds
s_barrier
s_waitcnt lgkmcnt(0)
v_mfma_f32_16x16x32_bf16 v[124:127], v[104:107], v[56:59], 0
v_mfma_f32_16x16x32_bf16 v[132:135], v[104:107], v[72:75], 0
v_mfma_f32_16x16x32_bf16 v[124:127], v[108:111], v[60:63], v[124:127]
v_mfma_f32_16x16x32_bf16 v[132:135], v[108:111], v[76:79], v[132:135]
v_mfma_f32_16x16x32_bf16 v[124:127], v[112:115], v[64:67], v[124:127]
v_mfma_f32_16x16x32_bf16 v[132:135], v[112:115], v[80:83], v[132:135]
v_mfma_f32_16x16x32_bf16 v[124:127], v[116:119], v[68:71], v[124:127]
v_mfma_f32_16x16x32_bf16 v[132:135], v[116:119], v[84:87], v[132:135]
s_cbranch_vccnz L_sk209
s_waitcnt vmcnt(4)
L_sk209:
buffer_load_dwordx4 v2, s[16:19], s44 offen offset:1024 nt lds
v_max3_f32 v13, v120, v121, v122
v_max3_f32 v14, v128, v129, v130
s_nop 2
v_max3_f32 v13, v13, v123, v124
v_max3_f32 v14, v14, v131, v132
v_max3_f32 v13, v13, v125, v126
v_max3_f32 v14, v14, v133, v134
v_max_f32 v13, v13, v127
v_max_f32 v14, v14, v135
s_nop 1
v_permlane32_swap_b32 v13, v14
v_max_f32 v13, v13, v14
v_mov_b32 v14, v13
s_nop 1
v_permlane16_swap_b32 v13, v14
v_max_f32 v13, v13, v14
v_mul_f32 v13, s48, v13
v_max_f32 v15, v12, v13
v_sub_f32 v14, v12, v15
v_exp_f32 v48, v14
v_mov_b32 v12, v15
v_mov_b32 v11, v15
v_mov_b32 v16, v48
v_mov_b32 v18, v48
v_permlane32_swap_b32 v15, v11
s_nop 0
v_permlane32_swap_b32 v16, v18
s_waitcnt vmcnt(5)
s_bitcmp1_b32 s88, 1
s_cbranch_scc1 L_sk210
s_waitcnt vmcnt(4)
L_sk210:
buffer_load_dwordx4 v3, s[16:19], s44 offen offset:2048 nt lds
v_and_b32 v241, 0xff, v10
v_lshrrev_b32 v10, 8, v10
v_cmp_le_u32 vcc, 12, v241
v_cmp_le_u32 s[90:91], 12, v10
s_nop 0
s_bcnt1_i32_b64 s88, vcc
s_bcnt1_i32_b64 s90, s[90:91]
s_add_u32 s90, s90, s88
s_add_u32 s90, s90, s43
s_cmp_ge_u32 s90, 15
s_cselect_b32 s88, 2, 0
s_cmp_le_u32 s90, 5
s_cselect_b32 s88, 1, s88
s_cmp_ge_u32 s90, 10
s_cselect_b64 vcc, -1, 0
v_fma_f32 v120, v120, s48, -v15
v_fma_f32 v121, v121, s48, -v15
v_fma_f32 v122, v122, s48, -v15
v_fma_f32 v123, v123, s48, -v15
v_fma_f32 v124, v124, s48, -v15
v_fma_f32 v125, v125, s48, -v15
v_fma_f32 v126, v126, s48, -v15
v_fma_f32 v127, v127, s48, -v15
v_fma_f32 v128, v128, s48, -v11
v_fma_f32 v129, v129, s48, -v11
v_fma_f32 v130, v130, s48, -v11
v_fma_f32 v131, v131, s48, -v11
v_fma_f32 v132, v132, s48, -v11
v_fma_f32 v133, v133, s48, -v11
v_fma_f32 v134, v134, s48, -v11
v_fma_f32 v135, v135, s48, -v11
v_exp_f32 v120, v120
v_exp_f32 v121, v121
v_exp_f32 v122, v122
v_exp_f32 v123, v123
s_waitcnt vmcnt(5)
s_cbranch_vccnz L_sk211
s_waitcnt vmcnt(4)
L_sk211:
buffer_load_dwordx4 v4, s[16:19], s44 offen offset:3072 nt lds
v_exp_f32 v124, v124
v_exp_f32 v125, v125
v_exp_f32 v126, v126
v_exp_f32 v127, v127
v_exp_f32 v128, v128
v_exp_f32 v129, v129
v_exp_f32 v130, v130
v_exp_f32 v131, v131
ds_read_b128 v[88:91], v5 offset:8192
ds_read_b128 v[92:95], v6 offset:8192
ds_read_b128 v[96:99], v7 offset:8192
ds_read_b128 v[100:103], v8 offset:8192
s_add_u32 s44, s44, 0x8000
s_add_u32 m0, s47, 4096
s_waitcnt vmcnt(4)
buffer_load_dwordx4 v1, s[16:19], s44 offen offset:0 nt lds
s_barrier
s_waitcnt lgkmcnt(0)
v_mfma_f32_16x16x32_bf16 v[136:139], v[88:91], v[56:59], 0
v_mfma_f32_16x16x32_bf16 v[144:147], v[88:91], v[72:75], 0
v_exp_f32 v132, v132
v_mfma_f32_16x16x32_bf16 v[136:139], v[92:95], v[60:63], v[136:139]
v_mfma_f32_16x16x32_bf16 v[144:147], v[92:95], v[76:79], v[144:147]
v_exp_f32 v133, v133
v_mfma_f32_16x16x32_bf16 v[136:139], v[96:99], v[64:67], v[136:139]
v_mfma_f32_16x16x32_bf16 v[144:147], v[96:99], v[80:83], v[144:147]
v_exp_f32 v134, v134
v_mfma_f32_16x16x32_bf16 v[136:139], v[100:103], v[68:71], v[136:139]
v_mfma_f32_16x16x32_bf16 v[144:147], v[100:103], v[84:87], v[144:147]
v_exp_f32 v135, v135
s_cbranch_vccnz L_sk213
s_waitcnt vmcnt(4)
L_sk213:
buffer_load_dwordx4 v2, s[16:19], s44 offen offset:1024 nt lds
v_cvt_pk_bf16_f32 v152, v120, v121
v_cvt_pk_bf16_f32 v153, v122, v123
v_cvt_pk_bf16_f32 v154, v124, v125
v_cvt_pk_bf16_f32 v155, v126, v127
v_cvt_pk_bf16_f32 v156, v128, v129
v_cvt_pk_bf16_f32 v157, v130, v131
v_cvt_pk_bf16_f32 v158, v132, v133
v_cvt_pk_bf16_f32 v159, v134, v135
v_accvgpr_write_b32 a192, v152
v_accvgpr_write_b32 a193, v153
v_accvgpr_write_b32 a194, v154
v_accvgpr_write_b32 a195, v155
v_accvgpr_write_b32 a196, v156
v_accvgpr_write_b32 a197, v157
v_accvgpr_write_b32 a198, v158
v_accvgpr_write_b32 a199, v159
s_waitcnt vmcnt(4)
s_bitcmp1_b32 s88, 0
s_cbranch_scc0 L_ng214
s_waitcnt vmcnt(3)
L_ng214:
buffer_load_dwordx4 v3, s[16:19], s44 offen offset:2048 nt lds
v_fma_f32 v20, v20, v16, v120
v_fma_f32 v21, v21, v18, v128
v_add_f32 v20, v20, v121
v_add_f32 v21, v21, v129
v_add_f32 v20, v20, v122
v_add_f32 v21, v21, v130
v_add_f32 v20, v20, v123
v_add_f32 v21, v21, v131
v_add_f32 v20, v20, v124
v_add_f32 v21, v21, v132
v_add_f32 v20, v20, v125
v_add_f32 v21, v21, v133
v_add_f32 v20, v20, v126
v_add_f32 v21, v21, v134
v_add_f32 v20, v20, v127
v_add_f32 v21, v21, v135
s_cbranch_vccnz L_sk215
s_waitcnt vmcnt(4)
L_sk215:
buffer_load_dwordx4 v4, s[16:19], s44 offen offset:3072 nt lds
ds_read_b128 v[104:107], v5 offset:12288
ds_read_b128 v[108:111], v6 offset:12288
ds_read_b128 v[112:115], v7 offset:12288
ds_read_b128 v[116:119], v8 offset:12288
s_add_u32 s44, s44, 0x8000
s_add_u32 m0, s47, 8192
s_waitcnt vmcnt(4)
buffer_load_dwordx4 v1, s[16:19], s44 offen offset:0 nt lds
s_barrier
s_waitcnt lgkmcnt(0)
v_mfma_f32_16x16x32_bf16 v[140:143], v[104:107], v[56:59], 0
v_mfma_f32_16x16x32_bf16 v[148:151], v[104:107], v[72:75], 0
v_mfma_f32_16x16x32_bf16 v[140:143], v[108:111], v[60:63], v[140:143]
v_mfma_f32_16x16x32_bf16 v[148:151], v[108:111], v[76:79], v[148:151]
v_mfma_f32_16x16x32_bf16 v[140:143], v[112:115], v[64:67], v[140:143]
v_mfma_f32_16x16x32_bf16 v[148:151], v[112:115], v[80:83], v[148:151]
v_mfma_f32_16x16x32_bf16 v[140:143], v[116:119], v[68:71], v[140:143]
v_mfma_f32_16x16x32_bf16 v[148:151], v[116:119], v[84:87], v[148:151]
s_cbranch_vccnz L_sk217
s_waitcnt vmcnt(4)
L_sk217:
buffer_load_dwordx4 v2, s[16:19], s44 offen offset:1024 nt lds
v_max3_f32 v13, v136, v137, v138
v_max3_f32 v14, v144, v145, v146
s_nop 2
v_max3_f32 v13, v13, v139, v140
v_max3_f32 v14, v14, v147, v148
v_max3_f32 v13, v13, v141, v142
v_max3_f32 v14, v14, v149, v150
v_max_f32 v13, v13, v143
v_max_f32 v14, v14, v151
s_nop 1
v_permlane32_swap_b32 v13, v14
v_max_f32 v13, v13, v14
v_mov_b32 v14, v13
s_nop 1
v_permlane16_swap_b32 v13, v14
v_max_f32 v13, v13, v14
v_mul_f32 v13, s48, v13
v_max_f32 v15, v12, v13
v_sub_f32 v14, v12, v15
v_exp_f32 v49, v14
v_mov_b32 v12, v15
v_mov_b32 v11, v15
v_mov_b32 v16, v49
v_mov_b32 v18, v49
v_permlane32_swap_b32 v15, v11
s_nop 0
v_permlane32_swap_b32 v16, v18
s_waitcnt vmcnt(5)
s_bitcmp1_b32 s88, 1
s_cbranch_scc1 L_sk218
s_waitcnt vmcnt(4)
L_sk218:
buffer_load_dwordx4 v3, s[16:19], s44 offen offset:2048 nt lds
v_mov_b32 v241, 13
s_mov_b64 exec, 1
buffer_store_byte v241, v22, s[36:39], s42 offen
s_mov_b64 exec, -1
buffer_load_ushort v10, v240, s[36:39], 0 offen offset:128 nt
v_fma_f32 v136, v136, s48, -v15
v_fma_f32 v137, v137, s48, -v15
v_fma_f32 v138, v138, s48, -v15
v_fma_f32 v139, v139, s48, -v15
v_fma_f32 v140, v140, s48, -v15
v_fma_f32 v141, v141, s48, -v15
v_fma_f32 v142, v142, s48, -v15
v_fma_f32 v143, v143, s48, -v15
v_fma_f32 v144, v144, s48, -v11
v_fma_f32 v145, v145, s48, -v11
v_fma_f32 v146, v146, s48, -v11
v_fma_f32 v147, v147, s48, -v11
v_fma_f32 v148, v148, s48, -v11
v_fma_f32 v149, v149, s48, -v11
v_fma_f32 v150, v150, s48, -v11
v_fma_f32 v151, v151, s48, -v11
v_exp_f32 v136, v136
v_exp_f32 v137, v137
v_exp_f32 v138, v138
v_exp_f32 v139, v139
s_waitcnt vmcnt(7)
s_cbranch_vccnz L_sk219
s_waitcnt vmcnt(6)
L_sk219:
buffer_load_dwordx4 v4, s[16:19], s44 offen offset:3072 nt lds
v_exp_f32 v140, v140
v_exp_f32 v141, v141
v_exp_f32 v142, v142
v_exp_f32 v143, v143
v_exp_f32 v144, v144
v_exp_f32 v145, v145
v_exp_f32 v146, v146
v_exp_f32 v147, v147
ds_read_b128 v[88:91], v5 offset:0
ds_read_b128 v[92:95], v6 offset:0
ds_read_b128 v[96:99], v7 offset:0
ds_read_b128 v[100:103], v8 offset:0
s_add_u32 s44, s44, 0x8000
s_add_u32 m0, s47, 12288
s_waitcnt vmcnt(6)
buffer_load_dwordx4 v1, s[16:19], s44 offen offset:0 nt lds
s_barrier
s_waitcnt lgkmcnt(0)
v_mfma_f32_16x16x32_bf16 v[120:123], v[88:91], v[56:59], 0
v_mfma_f32_16x16x32_bf16 v[128:131], v[88:91], v[72:75], 0
v_exp_f32 v148, v148
v_mfma_f32_16x16x32_bf16 v[120:123], v[92:95], v[60:63], v[120:123]
v_mfma_f32_16x16x32_bf16 v[128:131], v[92:95], v[76:79], v[128:131]
v_exp_f32 v149, v149
v_mfma_f32_16x16x32_bf16 v[120:123], v[96:99], v[64:67], v[120:123]
v_mfma_f32_16x16x32_bf16 v[128:131], v[96:99], v[80:83], v[128:131]
v_exp_f32 v150, v150
v_mfma_f32_16x16x32_bf16 v[120:123], v[100:103], v[68:71], v[120:123]
v_mfma_f32_16x16x32_bf16 v[128:131], v[100:103], v[84:87], v[128:131]
v_exp_f32 v151, v151
s_cbranch_vccnz L_sk221
s_waitcnt vmcnt(6)
L_sk221:
buffer_load_dwordx4 v2, s[16:19], s44 offen offset:1024 nt lds
v_cvt_pk_bf16_f32 v152, v136, v137
v_cvt_pk_bf16_f32 v153, v138, v139
v_cvt_pk_bf16_f32 v154, v140, v141
v_cvt_pk_bf16_f32 v155, v142, v143
v_cvt_pk_bf16_f32 v156, v144, v145
v_cvt_pk_bf16_f32 v157, v146, v147
v_cvt_pk_bf16_f32 v158, v148, v149
v_cvt_pk_bf16_f32 v159, v150, v151
v_accvgpr_write_b32 a200, v152
v_accvgpr_write_b32 a201, v153
v_accvgpr_write_b32 a202, v154
v_accvgpr_write_b32 a203, v155
v_accvgpr_write_b32 a204, v156
v_accvgpr_write_b32 a205, v157
v_accvgpr_write_b32 a206, v158
v_accvgpr_write_b32 a207, v159
s_waitcnt vmcnt(6)
s_bitcmp1_b32 s88, 0
s_cbranch_scc0 L_ng222
s_waitcnt vmcnt(5)
L_ng222:
buffer_load_dwordx4 v3, s[16:19], s44 offen offset:2048 nt lds
v_fma_f32 v20, v20, v16, v136
v_fma_f32 v21, v21, v18, v144
v_add_f32 v20, v20, v137
v_add_f32 v21, v21, v145
v_add_f32 v20, v20, v138
v_add_f32 v21, v21, v146
v_add_f32 v20, v20, v139
v_add_f32 v21, v21, v147
v_add_f32 v20, v20, v140
v_add_f32 v21, v21, v148
v_add_f32 v20, v20, v141
v_add_f32 v21, v21, v149
v_add_f32 v20, v20, v142
v_add_f32 v21, v21, v150
v_add_f32 v20, v20, v143
v_add_f32 v21, v21, v151
s_cbranch_vccnz L_sk223
s_waitcnt vmcnt(6)
L_sk223:
buffer_load_dwordx4 v4, s[16:19], s44 offen offset:3072 nt lds
ds_read_b128 v[104:107], v5 offset:4096
ds_read_b128 v[108:111], v6 offset:4096
ds_read_b128 v[112:115], v7 offset:4096
ds_read_b128 v[116:119], v8 offset:4096
s_add_u32 s44, s44, 0x8000
s_add_u32 m0, s47, 0
s_waitcnt vmcnt(4)
buffer_load_dwordx4 v1, s[16:19], s44 offen offset:0 nt lds
s_barrier
s_waitcnt lgkmcnt(0)
v_mfma_f32_16x16x32_bf16 v[124:127], v[104:107], v[56:59], 0
v_mfma_f32_16x16x32_bf16 v[132:135], v[104:107], v[72:75], 0
v_mfma_f32_16x16x32_bf16 v[124:127], v[108:111], v[60:63], v[124:127]
v_mfma_f32_16x16x32_bf16 v[132:135], v[108:111], v[76:79], v[132:135]
v_mfma_f32_16x16x32_bf16 v[124:127], v[112:115], v[64:67], v[124:127]
v_mfma_f32_16x16x32_bf16 v[132:135], v[112:115], v[80:83], v[132:135]
v_mfma_f32_16x16x32_bf16 v[124:127], v[116:119], v[68:71], v[124:127]
v_mfma_f32_16x16x32_bf16 v[132:135], v[116:119], v[84:87], v[132:135]
s_cbranch_vccnz L_sk225
s_waitcnt vmcnt(4)
L_sk225:
buffer_load_dwordx4 v2, s[16:19], s44 offen offset:1024 nt lds
v_max3_f32 v13, v120, v121, v122
v_max3_f32 v14, v128, v129, v130
s_nop 2
v_max3_f32 v13, v13, v123, v124
v_max3_f32 v14, v14, v131, v132
v_max3_f32 v13, v13, v125, v126
v_max3_f32 v14, v14, v133, v134
v_max_f32 v13, v13, v127
v_max_f32 v14, v14, v135
s_nop 1
v_permlane32_swap_b32 v13, v14
v_max_f32 v13, v13, v14
v_mov_b32 v14, v13
s_nop 1
v_permlane16_swap_b32 v13, v14
v_max_f32 v13, v13, v14
v_mul_f32 v13, s48, v13
v_max_f32 v15, v12, v13
v_sub_f32 v14, v12, v15
v_exp_f32 v50, v14
v_mov_b32 v12, v15
v_mov_b32 v11, v15
v_mov_b32 v16, v50
v_mov_b32 v18, v50
v_permlane32_swap_b32 v15, v11
s_nop 0
v_permlane32_swap_b32 v16, v18
s_waitcnt vmcnt(5)
s_bitcmp1_b32 s88, 1
s_cbranch_scc1 L_sk226
s_waitcnt vmcnt(4)
L_sk226:
buffer_load_dwordx4 v3, s[16:19], s44 offen offset:2048 nt lds
v_and_b32 v241, 0xff, v10
v_lshrrev_b32 v10, 8, v10
v_cmp_le_u32 vcc, 13, v241
v_cmp_le_u32 s[90:91], 13, v10
s_nop 0
s_bcnt1_i32_b64 s88, vcc
s_bcnt1_i32_b64 s90, s[90:91]
s_add_u32 s90, s90, s88
s_add_u32 s90, s90, s43
s_cmp_ge_u32 s90, 15
s_cselect_b32 s88, 2, 0
s_cmp_le_u32 s90, 5
s_cselect_b32 s88, 1, s88
s_cmp_ge_u32 s90, 10
s_cselect_b64 vcc, -1, 0
v_fma_f32 v120, v120, s48, -v15
v_fma_f32 v121, v121, s48, -v15
v_fma_f32 v122, v122, s48, -v15
v_fma_f32 v123, v123, s48, -v15
v_fma_f32 v124, v124, s48, -v15
v_fma_f32 v125, v125, s48, -v15
v_fma_f32 v126, v126, s48, -v15
v_fma_f32 v127, v127, s48, -v15
v_fma_f32 v128, v128, s48, -v11
v_fma_f32 v129, v129, s48, -v11
v_fma_f32 v130, v130, s48, -v11
v_fma_f32 v131, v131, s48, -v11
v_fma_f32 v132, v132, s48, -v11
v_fma_f32 v133, v133, s48, -v11
v_fma_f32 v134, v134, s48, -v11
v_fma_f32 v135, v135, s48, -v11
v_exp_f32 v120, v120
v_exp_f32 v121, v121
v_exp_f32 v122, v122
v_exp_f32 v123, v123
s_waitcnt vmcnt(5)
s_cbranch_vccnz L_sk227
s_waitcnt vmcnt(4)
L_sk227:
buffer_load_dwordx4 v4, s[16:19], s44 offen offset:3072 nt lds
v_exp_f32 v124, v124
v_exp_f32 v125, v125
v_exp_f32 v126, v126
v_exp_f32 v127, v127
v_exp_f32 v128, v128
v_exp_f32 v129, v129
v_exp_f32 v130, v130
v_exp_f32 v131, v131
ds_read_b128 v[88:91], v5 offset:8192
ds_read_b128 v[92:95], v6 offset:8192
ds_read_b128 v[96:99], v7 offset:8192
ds_read_b128 v[100:103], v8 offset:8192
s_add_u32 s44, s44, 0x8000
s_add_u32 m0, s47, 4096
s_waitcnt vmcnt(4)
buffer_load_dwordx4 v1, s[16:19], s44 offen offset:0 nt lds
s_barrier
s_waitcnt lgkmcnt(0)
v_mfma_f32_16x16x32_bf16 v[136:139], v[88:91], v[56:59], 0
v_mfma_f32_16x16x32_bf16 v[144:147], v[88:91], v[72:75], 0
v_exp_f32 v132, v132
v_mfma_f32_16x16x32_bf16 v[136:139], v[92:95], v[60:63], v[136:139]
v_mfma_f32_16x16x32_bf16 v[144:147], v[92:95], v[76:79], v[144:147]
v_exp_f32 v133, v133
v_mfma_f32_16x16x32_bf16 v[136:139], v[96:99], v[64:67], v[136:139]
v_mfma_f32_16x16x32_bf16 v[144:147], v[96:99], v[80:83], v[144:147]
v_exp_f32 v134, v134
v_mfma_f32_16x16x32_bf16 v[136:139], v[100:103], v[68:71], v[136:139]
v_mfma_f32_16x16x32_bf16 v[144:147], v[100:103], v[84:87], v[144:147]
v_exp_f32 v135, v135
s_cbranch_vccnz L_sk229
s_waitcnt vmcnt(4)
L_sk229:
buffer_load_dwordx4 v2, s[16:19], s44 offen offset:1024 nt lds
v_cvt_pk_bf16_f32 v152, v120, v121
v_cvt_pk_bf16_f32 v153, v122, v123
v_cvt_pk_bf16_f32 v154, v124, v125
v_cvt_pk_bf16_f32 v155, v126, v127
v_cvt_pk_bf16_f32 v156, v128, v129
v_cvt_pk_bf16_f32 v157, v130, v131
v_cvt_pk_bf16_f32 v158, v132, v133
v_cvt_pk_bf16_f32 v159, v134, v135
v_accvgpr_write_b32 a208, v152
v_accvgpr_write_b32 a209, v153
v_accvgpr_write_b32 a210, v154
v_accvgpr_write_b32 a211, v155
v_accvgpr_write_b32 a212, v156
v_accvgpr_write_b32 a213, v157
v_accvgpr_write_b32 a214, v158
v_accvgpr_write_b32 a215, v159
s_waitcnt vmcnt(4)
s_bitcmp1_b32 s88, 0
s_cbranch_scc0 L_ng230
s_waitcnt vmcnt(3)
L_ng230:
buffer_load_dwordx4 v3, s[16:19], s44 offen offset:2048 nt lds
v_fma_f32 v20, v20, v16, v120
v_fma_f32 v21, v21, v18, v128
v_add_f32 v20, v20, v121
v_add_f32 v21, v21, v129
v_add_f32 v20, v20, v122
v_add_f32 v21, v21, v130
v_add_f32 v20, v20, v123
v_add_f32 v21, v21, v131
v_add_f32 v20, v20, v124
v_add_f32 v21, v21, v132
v_add_f32 v20, v20, v125
v_add_f32 v21, v21, v133
v_add_f32 v20, v20, v126
v_add_f32 v21, v21, v134
v_add_f32 v20, v20, v127
v_add_f32 v21, v21, v135
s_cbranch_vccnz L_sk231
s_waitcnt vmcnt(4)
L_sk231:
buffer_load_dwordx4 v4, s[16:19], s44 offen offset:3072 nt lds
ds_read_b128 v[104:107], v5 offset:12288
ds_read_b128 v[108:111], v6 offset:12288
ds_read_b128 v[112:115], v7 offset:12288
ds_read_b128 v[116:119], v8 offset:12288
s_add_u32 s44, s44, 0x8000
s_add_u32 m0, s47, 8192
s_waitcnt vmcnt(4)
buffer_load_dwordx4 v1, s[16:19], s44 offen offset:0 nt lds
s_barrier
s_waitcnt lgkmcnt(0)
v_mfma_f32_16x16x32_bf16 v[140:143], v[104:107], v[56:59], 0
v_mfma_f32_16x16x32_bf16 v[148:151], v[104:107], v[72:75], 0
v_mfma_f32_16x16x32_bf16 v[140:143], v[108:111], v[60:63], v[140:143]
v_mfma_f32_16x16x32_bf16 v[148:151], v[108:111], v[76:79], v[148:151]
v_mfma_f32_16x16x32_bf16 v[140:143], v[112:115], v[64:67], v[140:143]
v_mfma_f32_16x16x32_bf16 v[148:151], v[112:115], v[80:83], v[148:151]
v_mfma_f32_16x16x32_bf16 v[140:143], v[116:119], v[68:71], v[140:143]
v_mfma_f32_16x16x32_bf16 v[148:151], v[116:119], v[84:87], v[148:151]
s_cbranch_vccnz L_sk233
s_waitcnt vmcnt(4)
L_sk233:
buffer_load_dwordx4 v2, s[16:19], s44 offen offset:1024 nt lds
v_max3_f32 v13, v136, v137, v138
v_max3_f32 v14, v144, v145, v146
s_nop 2
v_max3_f32 v13, v13, v139, v140
v_max3_f32 v14, v14, v147, v148
v_max3_f32 v13, v13, v141, v142
v_max3_f32 v14, v14, v149, v150
v_max_f32 v13, v13, v143
v_max_f32 v14, v14, v151
s_nop 1
v_permlane32_swap_b32 v13, v14
v_max_f32 v13, v13, v14
v_mov_b32 v14, v13
s_nop 1
v_permlane16_swap_b32 v13, v14
v_max_f32 v13, v13, v14
v_mul_f32 v13, s48, v13
v_max_f32 v15, v12, v13
v_sub_f32 v14, v12, v15
v_exp_f32 v51, v14
v_mov_b32 v12, v15
v_mov_b32 v11, v15
v_mov_b32 v16, v51
v_mov_b32 v18, v51
v_permlane32_swap_b32 v15, v11
s_nop 0
v_permlane32_swap_b32 v16, v18
s_waitcnt vmcnt(5)
s_bitcmp1_b32 s88, 1
s_cbranch_scc1 L_sk234
s_waitcnt vmcnt(4)
L_sk234:
buffer_load_dwordx4 v3, s[16:19], s44 offen offset:2048 nt lds
v_mov_b32 v241, 14
s_mov_b64 exec, 1
buffer_store_byte v241, v22, s[36:39], s42 offen
s_mov_b64 exec, -1
buffer_load_ushort v10, v240, s[36:39], 0 offen offset:128 nt
v_fma_f32 v136, v136, s48, -v15
v_fma_f32 v137, v137, s48, -v15
v_fma_f32 v138, v138, s48, -v15
v_fma_f32 v139, v139, s48, -v15
v_fma_f32 v140, v140, s48, -v15
v_fma_f32 v141, v141, s48, -v15
v_fma_f32 v142, v142, s48, -v15
v_fma_f32 v143, v143, s48, -v15
v_fma_f32 v144, v144, s48, -v11
v_fma_f32 v145, v145, s48, -v11
v_fma_f32 v146, v146, s48, -v11
v_fma_f32 v147, v147, s48, -v11
v_fma_f32 v148, v148, s48, -v11
v_fma_f32 v149, v149, s48, -v11
v_fma_f32 v150, v150, s48, -v11
v_fma_f32 v151, v151, s48, -v11
v_exp_f32 v136, v136
v_exp_f32 v137, v137
v_exp_f32 v138, v138
v_exp_f32 v139, v139
s_waitcnt vmcnt(7)
s_cbranch_vccnz L_sk235
s_waitcnt vmcnt(6)
L_sk235:
buffer_load_dwordx4 v4, s[16:19], s44 offen offset:3072 nt lds
v_exp_f32 v140, v140
v_exp_f32 v141, v141
v_exp_f32 v142, v142
v_exp_f32 v143, v143
v_exp_f32 v144, v144
v_exp_f32 v145, v145
v_exp_f32 v146, v146
v_exp_f32 v147, v147
ds_read_b128 v[88:91], v5 offset:0
ds_read_b128 v[92:95], v6 offset:0
ds_read_b128 v[96:99], v7 offset:0
ds_read_b128 v[100:103], v8 offset:0
s_add_u32 s44, s44, 0x8000
s_add_u32 m0, s47, 12288
s_waitcnt vmcnt(6)
buffer_load_dwordx4 v1, s[16:19], s44 offen offset:0 nt lds
s_barrier
s_waitcnt lgkmcnt(0)
v_mfma_f32_16x16x32_bf16 v[120:123], v[88:91], v[56:59], 0
v_mfma_f32_16x16x32_bf16 v[128:131], v[88:91], v[72:75], 0
v_exp_f32 v148, v148
v_mfma_f32_16x16x32_bf16 v[120:123], v[92:95], v[60:63], v[120:123]
v_mfma_f32_16x16x32_bf16 v[128:131], v[92:95], v[76:79], v[128:131]
v_exp_f32 v149, v149
v_mfma_f32_16x16x32_bf16 v[120:123], v[96:99], v[64:67], v[120:123]
v_mfma_f32_16x16x32_bf16 v[128:131], v[96:99], v[80:83], v[128:131]
v_exp_f32 v150, v150
v_mfma_f32_16x16x32_bf16 v[120:123], v[100:103], v[68:71], v[120:123]
v_mfma_f32_16x16x32_bf16 v[128:131], v[100:103], v[84:87], v[128:131]
v_exp_f32 v151, v151
s_cbranch_vccnz L_sk237
s_waitcnt vmcnt(6)
L_sk237:
buffer_load_dwordx4 v2, s[16:19], s44 offen offset:1024 nt lds
v_cvt_pk_bf16_f32 v152, v136, v137
v_cvt_pk_bf16_f32 v153, v138, v139
v_cvt_pk_bf16_f32 v154, v140, v141
v_cvt_pk_bf16_f32 v155, v142, v143
v_cvt_pk_bf16_f32 v156, v144, v145
v_cvt_pk_bf16_f32 v157, v146, v147
v_cvt_pk_bf16_f32 v158, v148, v149
v_cvt_pk_bf16_f32 v159, v150, v151
v_accvgpr_write_b32 a216, v152
v_accvgpr_write_b32 a217, v153
v_accvgpr_write_b32 a218, v154
v_accvgpr_write_b32 a219, v155
v_accvgpr_write_b32 a220, v156
v_accvgpr_write_b32 a221, v157
v_accvgpr_write_b32 a222, v158
v_accvgpr_write_b32 a223, v159
s_waitcnt vmcnt(6)
s_bitcmp1_b32 s88, 0
s_cbranch_scc0 L_ng238
s_waitcnt vmcnt(5)
L_ng238:
buffer_load_dwordx4 v3, s[16:19], s44 offen offset:2048 nt lds
v_fma_f32 v20, v20, v16, v136
v_fma_f32 v21, v21, v18, v144
v_add_f32 v20, v20, v137
v_add_f32 v21, v21, v145
v_add_f32 v20, v20, v138
v_add_f32 v21, v21, v146
v_add_f32 v20, v20, v139
v_add_f32 v21, v21, v147
v_add_f32 v20, v20, v140
v_add_f32 v21, v21, v148
v_add_f32 v20, v20, v141
v_add_f32 v21, v21, v149
v_add_f32 v20, v20, v142
v_add_f32 v21, v21, v150
v_add_f32 v20, v20, v143
v_add_f32 v21, v21, v151
s_cbranch_vccnz L_sk239
s_waitcnt vmcnt(6)
L_sk239:
buffer_load_dwordx4 v4, s[16:19], s44 offen offset:3072 nt lds
ds_read_b128 v[104:107], v5 offset:4096
ds_read_b128 v[108:111], v6 offset:4096
ds_read_b128 v[112:115], v7 offset:4096
ds_read_b128 v[116:119], v8 offset:4096
s_add_u32 s44, s44, 0x8000
s_add_u32 m0, s47, 0
s_waitcnt vmcnt(4)
buffer_load_dwordx4 v1, s[16:19], s44 offen offset:0 nt lds
s_barrier
s_waitcnt lgkmcnt(0)
v_mfma_f32_16x16x32_bf16 v[124:127], v[104:107], v[56:59], 0
v_mfma_f32_16x16x32_bf16 v[132:135], v[104:107], v[72:75], 0
v_mfma_f32_16x16x32_bf16 v[124:127], v[108:111], v[60:63], v[124:127]
v_mfma_f32_16x16x32_bf16 v[132:135], v[108:111], v[76:79], v[132:135]
v_mfma_f32_16x16x32_bf16 v[124:127], v[112:115], v[64:67], v[124:127]
v_mfma_f32_16x16x32_bf16 v[132:135], v[112:115], v[80:83], v[132:135]
v_mfma_f32_16x16x32_bf16 v[124:127], v[116:119], v[68:71], v[124:127]
v_mfma_f32_16x16x32_bf16 v[132:135], v[116:119], v[84:87], v[132:135]
s_cbranch_vccnz L_sk241
s_waitcnt vmcnt(4)
L_sk241:
buffer_load_dwordx4 v2, s[16:19], s44 offen offset:1024 nt lds
v_max3_f32 v13, v120, v121, v122
v_max3_f32 v14, v128, v129, v130
s_nop 2
v_max3_f32 v13, v13, v123, v124
v_max3_f32 v14, v14, v131, v132
v_max3_f32 v13, v13, v125, v126
v_max3_f32 v14, v14, v133, v134
v_max_f32 v13, v13, v127
v_max_f32 v14, v14, v135
s_nop 1
v_permlane32_swap_b32 v13, v14
v_max_f32 v13, v13, v14
v_mov_b32 v14, v13
s_nop 1
v_permlane16_swap_b32 v13, v14
v_max_f32 v13, v13, v14
v_mul_f32 v13, s48, v13
v_max_f32 v15, v12, v13
v_sub_f32 v14, v12, v15
v_exp_f32 v52, v14
v_mov_b32 v12, v15
v_mov_b32 v11, v15
v_mov_b32 v16, v52
v_mov_b32 v18, v52
v_permlane32_swap_b32 v15, v11
s_nop 0
v_permlane32_swap_b32 v16, v18
s_waitcnt vmcnt(5)
s_bitcmp1_b32 s88, 1
s_cbranch_scc1 L_sk242
s_waitcnt vmcnt(4)
L_sk242:
buffer_load_dwordx4 v3, s[16:19], s44 offen offset:2048 nt lds
v_and_b32 v241, 0xff, v10
v_lshrrev_b32 v10, 8, v10
v_cmp_le_u32 vcc, 14, v241
v_cmp_le_u32 s[90:91], 14, v10
s_nop 0
s_bcnt1_i32_b64 s88, vcc
s_bcnt1_i32_b64 s90, s[90:91]
s_add_u32 s90, s90, s88
s_add_u32 s90, s90, s43
s_cmp_ge_u32 s90, 15
s_cselect_b32 s88, 2, 0
s_cmp_le_u32 s90, 5
s_cselect_b32 s88, 1, s88
s_cmp_ge_u32 s90, 10
s_cselect_b64 vcc, -1, 0
v_fma_f32 v120, v120, s48, -v15
v_fma_f32 v121, v121, s48, -v15
v_fma_f32 v122, v122, s48, -v15
v_fma_f32 v123, v123, s48, -v15
v_fma_f32 v124, v124, s48, -v15
v_fma_f32 v125, v125, s48, -v15
v_fma_f32 v126, v126, s48, -v15
v_fma_f32 v127, v127, s48, -v15
v_fma_f32 v128, v128, s48, -v11
v_fma_f32 v129, v129, s48, -v11
v_fma_f32 v130, v130, s48, -v11
v_fma_f32 v131, v131, s48, -v11
v_fma_f32 v132, v132, s48, -v11
v_fma_f32 v133, v133, s48, -v11
v_fma_f32 v134, v134, s48, -v11
v_fma_f32 v135, v135, s48, -v11
v_exp_f32 v120, v120
v_exp_f32 v121, v121
v_exp_f32 v122, v122
v_exp_f32 v123, v123
s_waitcnt vmcnt(5)
s_cbranch_vccnz L_sk243
s_waitcnt vmcnt(4)
L_sk243:
buffer_load_dwordx4 v4, s[16:19], s44 offen offset:3072 nt lds
v_exp_f32 v124, v124
v_exp_f32 v125, v125
v_exp_f32 v126, v126
v_exp_f32 v127, v127
v_exp_f32 v128, v128
v_exp_f32 v129, v129
v_exp_f32 v130, v130
v_exp_f32 v131, v131
ds_read_b128 v[88:91], v5 offset:8192
ds_read_b128 v[92:95], v6 offset:8192
ds_read_b128 v[96:99], v7 offset:8192
ds_read_b128 v[100:103], v8 offset:8192
s_add_u32 s44, s44, 0x8000
s_add_u32 m0, s47, 4096
s_waitcnt vmcnt(4)
buffer_load_dwordx4 v1, s[16:19], s44 offen offset:0 nt lds
s_barrier
s_waitcnt lgkmcnt(0)
v_mfma_f32_16x16x32_bf16 v[136:139], v[88:91], v[56:59], 0
v_mfma_f32_16x16x32_bf16 v[144:147], v[88:91], v[72:75], 0
v_exp_f32 v132, v132
v_mfma_f32_16x16x32_bf16 v[136:139], v[92:95], v[60:63], v[136:139]
v_mfma_f32_16x16x32_bf16 v[144:147], v[92:95], v[76:79], v[144:147]
v_exp_f32 v133, v133
v_mfma_f32_16x16x32_bf16 v[136:139], v[96:99], v[64:67], v[136:139]
v_mfma_f32_16x16x32_bf16 v[144:147], v[96:99], v[80:83], v[144:147]
v_exp_f32 v134, v134
v_mfma_f32_16x16x32_bf16 v[136:139], v[100:103], v[68:71], v[136:139]
v_mfma_f32_16x16x32_bf16 v[144:147], v[100:103], v[84:87], v[144:147]
v_exp_f32 v135, v135
s_cbranch_vccnz L_sk245
s_waitcnt vmcnt(4)
L_sk245:
buffer_load_dwordx4 v2, s[16:19], s44 offen offset:1024 nt lds
v_cvt_pk_bf16_f32 v152, v120, v121
v_cvt_pk_bf16_f32 v153, v122, v123
v_cvt_pk_bf16_f32 v154, v124, v125
v_cvt_pk_bf16_f32 v155, v126, v127
v_cvt_pk_bf16_f32 v156, v128, v129
v_cvt_pk_bf16_f32 v157, v130, v131
v_cvt_pk_bf16_f32 v158, v132, v133
v_cvt_pk_bf16_f32 v159, v134, v135
v_accvgpr_write_b32 a224, v152
v_accvgpr_write_b32 a225, v153
v_accvgpr_write_b32 a226, v154
v_accvgpr_write_b32 a227, v155
v_accvgpr_write_b32 a228, v156
v_accvgpr_write_b32 a229, v157
v_accvgpr_write_b32 a230, v158
v_accvgpr_write_b32 a231, v159
s_waitcnt vmcnt(4)
s_bitcmp1_b32 s88, 0
s_cbranch_scc0 L_ng246
s_waitcnt vmcnt(3)
L_ng246:
buffer_load_dwordx4 v3, s[16:19], s44 offen offset:2048 nt lds
v_fma_f32 v20, v20, v16, v120
v_fma_f32 v21, v21, v18, v128
v_add_f32 v20, v20, v121
v_add_f32 v21, v21, v129
v_add_f32 v20, v20, v122
v_add_f32 v21, v21, v130
v_add_f32 v20, v20, v123
v_add_f32 v21, v21, v131
v_add_f32 v20, v20, v124
v_add_f32 v21, v21, v132
v_add_f32 v20, v20, v125
v_add_f32 v21, v21, v133
v_add_f32 v20, v20, v126
v_add_f32 v21, v21, v134
v_add_f32 v20, v20, v127
v_add_f32 v21, v21, v135
s_cbranch_vccnz L_sk247
s_waitcnt vmcnt(4)
L_sk247:
buffer_load_dwordx4 v4, s[16:19], s44 offen offset:3072 nt lds
ds_read_b128 v[104:107], v5 offset:12288
ds_read_b128 v[108:111], v6 offset:12288
ds_read_b128 v[112:115], v7 offset:12288
ds_read_b128 v[116:119], v8 offset:12288
s_add_u32 s44, s44, 0x8000
s_add_u32 m0, s47, 8192
s_waitcnt vmcnt(4)
buffer_load_dwordx4 v1, s[16:19], s44 offen offset:0 nt lds
s_barrier
s_waitcnt lgkmcnt(0)
v_mfma_f32_16x16x32_bf16 v[140:143], v[104:107], v[56:59], 0
v_mfma_f32_16x16x32_bf16 v[148:151], v[104:107], v[72:75], 0
v_mfma_f32_16x16x32_bf16 v[140:143], v[108:111], v[60:63], v[140:143]
v_mfma_f32_16x16x32_bf16 v[148:151], v[108:111], v[76:79], v[148:151]
v_mfma_f32_16x16x32_bf16 v[140:143], v[112:115], v[64:67], v[140:143]
v_mfma_f32_16x16x32_bf16 v[148:151], v[112:115], v[80:83], v[148:151]
v_mfma_f32_16x16x32_bf16 v[140:143], v[116:119], v[68:71], v[140:143]
v_mfma_f32_16x16x32_bf16 v[148:151], v[116:119], v[84:87], v[148:151]
s_cbranch_vccnz L_sk249
s_waitcnt vmcnt(4)
L_sk249:
buffer_load_dwordx4 v2, s[16:19], s44 offen offset:1024 nt lds
v_max3_f32 v13, v136, v137, v138
v_max3_f32 v14, v144, v145, v146
s_nop 2
v_max3_f32 v13, v13, v139, v140
v_max3_f32 v14, v14, v147, v148
v_max3_f32 v13, v13, v141, v142
v_max3_f32 v14, v14, v149, v150
v_max_f32 v13, v13, v143
v_max_f32 v14, v14, v151
s_nop 1
v_permlane32_swap_b32 v13, v14
v_max_f32 v13, v13, v14
v_mov_b32 v14, v13
s_nop 1
v_permlane16_swap_b32 v13, v14
v_max_f32 v13, v13, v14
v_mul_f32 v13, s48, v13
v_max_f32 v15, v12, v13
v_sub_f32 v14, v12, v15
v_exp_f32 v53, v14
v_mov_b32 v12, v15
v_mov_b32 v11, v15
v_mov_b32 v16, v53
v_mov_b32 v18, v53
v_permlane32_swap_b32 v15, v11
s_nop 0
v_permlane32_swap_b32 v16, v18
s_waitcnt vmcnt(5)
s_bitcmp1_b32 s88, 1
s_cbranch_scc1 L_sk250
s_waitcnt vmcnt(4)
L_sk250:
buffer_load_dwordx4 v3, s[16:19], s44 offen offset:2048 nt lds
v_mov_b32 v241, 15
s_mov_b64 exec, 1
buffer_store_byte v241, v22, s[36:39], s42 offen
s_mov_b64 exec, -1
buffer_load_ushort v10, v240, s[36:39], 0 offen offset:128 nt
v_fma_f32 v136, v136, s48, -v15
v_fma_f32 v137, v137, s48, -v15
v_fma_f32 v138, v138, s48, -v15
v_fma_f32 v139, v139, s48, -v15
v_fma_f32 v140, v140, s48, -v15
v_fma_f32 v141, v141, s48, -v15
v_fma_f32 v142, v142, s48, -v15
v_fma_f32 v143, v143, s48, -v15
v_fma_f32 v144, v144, s48, -v11
v_fma_f32 v145, v145, s48, -v11
v_fma_f32 v146, v146, s48, -v11
v_fma_f32 v147, v147, s48, -v11
v_fma_f32 v148, v148, s48, -v11
v_fma_f32 v149, v149, s48, -v11
v_fma_f32 v150, v150, s48, -v11
v_fma_f32 v151, v151, s48, -v11
v_exp_f32 v136, v136
v_exp_f32 v137, v137
v_exp_f32 v138, v138
v_exp_f32 v139, v139
s_waitcnt vmcnt(7)
s_cbranch_vccnz L_sk251
s_waitcnt vmcnt(6)
L_sk251:
buffer_load_dwordx4 v4, s[16:19], s44 offen offset:3072 nt lds
v_exp_f32 v140, v140
v_exp_f32 v141, v141
v_exp_f32 v142, v142
v_exp_f32 v143, v143
v_exp_f32 v144, v144
v_exp_f32 v145, v145
v_exp_f32 v146, v146
v_exp_f32 v147, v147
ds_read_b128 v[88:91], v5 offset:0
ds_read_b128 v[92:95], v6 offset:0
ds_read_b128 v[96:99], v7 offset:0
ds_read_b128 v[100:103], v8 offset:0
s_add_u32 s44, s44, 0x8000
s_add_u32 m0, s47, 12288
s_waitcnt vmcnt(6)
buffer_load_dwordx4 v1, s[16:19], s44 offen offset:0 nt lds
s_barrier
s_waitcnt lgkmcnt(0)
v_mfma_f32_16x16x32_bf16 v[120:123], v[88:91], v[56:59], 0
v_mfma_f32_16x16x32_bf16 v[128:131], v[88:91], v[72:75], 0
v_exp_f32 v148, v148
v_mfma_f32_16x16x32_bf16 v[120:123], v[92:95], v[60:63], v[120:123]
v_mfma_f32_16x16x32_bf16 v[128:131], v[92:95], v[76:79], v[128:131]
v_exp_f32 v149, v149
v_mfma_f32_16x16x32_bf16 v[120:123], v[96:99], v[64:67], v[120:123]
v_mfma_f32_16x16x32_bf16 v[128:131], v[96:99], v[80:83], v[128:131]
v_exp_f32 v150, v150
v_mfma_f32_16x16x32_bf16 v[120:123], v[100:103], v[68:71], v[120:123]
v_mfma_f32_16x16x32_bf16 v[128:131], v[100:103], v[84:87], v[128:131]
v_exp_f32 v151, v151
s_cbranch_vccnz L_sk253
s_waitcnt vmcnt(6)
L_sk253:
buffer_load_dwordx4 v2, s[16:19], s44 offen offset:1024 nt lds
v_cvt_pk_bf16_f32 v152, v136, v137
v_cvt_pk_bf16_f32 v153, v138, v139
v_cvt_pk_bf16_f32 v154, v140, v141
v_cvt_pk_bf16_f32 v155, v142, v143
v_cvt_pk_bf16_f32 v156, v144, v145
v_cvt_pk_bf16_f32 v157, v146, v147
v_cvt_pk_bf16_f32 v158, v148, v149
v_cvt_pk_bf16_f32 v159, v150, v151
v_accvgpr_write_b32 a232, v152
v_accvgpr_write_b32 a233, v153
v_accvgpr_write_b32 a234, v154
v_accvgpr_write_b32 a235, v155
v_accvgpr_write_b32 a236, v156
v_accvgpr_write_b32 a237, v157
v_accvgpr_write_b32 a238, v158
v_accvgpr_write_b32 a239, v159
s_waitcnt vmcnt(6)
s_bitcmp1_b32 s88, 0
s_cbranch_scc0 L_ng254
s_waitcnt vmcnt(5)
L_ng254:
buffer_load_dwordx4 v3, s[16:19], s44 offen offset:2048 nt lds
v_fma_f32 v20, v20, v16, v136
v_fma_f32 v21, v21, v18, v144
v_add_f32 v20, v20, v137
v_add_f32 v21, v21, v145
v_add_f32 v20, v20, v138
v_add_f32 v21, v21, v146
v_add_f32 v20, v20, v139
v_add_f32 v21, v21, v147
v_add_f32 v20, v20, v140
v_add_f32 v21, v21, v148
v_add_f32 v20, v20, v141
v_add_f32 v21, v21, v149
v_add_f32 v20, v20, v142
v_add_f32 v21, v21, v150
v_add_f32 v20, v20, v143
v_add_f32 v21, v21, v151
s_cbranch_vccnz L_sk255
s_waitcnt vmcnt(6)
L_sk255:
buffer_load_dwordx4 v4, s[16:19], s44 offen offset:3072 nt lds
ds_read_b128 v[104:107], v5 offset:4096
ds_read_b128 v[108:111], v6 offset:4096
ds_read_b128 v[112:115], v7 offset:4096
ds_read_b128 v[116:119], v8 offset:4096
s_waitcnt vmcnt(4)
buffer_load_dwordx4 v[160:163], v249, s[20:23], s45 offen offset:0 nt
s_barrier
s_waitcnt lgkmcnt(0)
v_mfma_f32_16x16x32_bf16 v[124:127], v[104:107], v[56:59], 0
v_mfma_f32_16x16x32_bf16 v[132:135], v[104:107], v[72:75], 0
v_mfma_f32_16x16x32_bf16 v[124:127], v[108:111], v[60:63], v[124:127]
v_mfma_f32_16x16x32_bf16 v[132:135], v[108:111], v[76:79], v[132:135]
v_mfma_f32_16x16x32_bf16 v[124:127], v[112:115], v[64:67], v[124:127]
v_mfma_f32_16x16x32_bf16 v[132:135], v[112:115], v[80:83], v[132:135]
v_mfma_f32_16x16x32_bf16 v[124:127], v[116:119], v[68:71], v[124:127]
v_mfma_f32_16x16x32_bf16 v[132:135], v[116:119], v[84:87], v[132:135]
s_cbranch_vccnz L_sk257
s_waitcnt vmcnt(4)
L_sk257:
buffer_load_dwordx4 v[164:167], v249, s[20:23], s45 offen offset:1024 nt
v_max3_f32 v13, v120, v121, v122
v_max3_f32 v14, v128, v129, v130
s_nop 2
v_max3_f32 v13, v13, v123, v124
v_max3_f32 v14, v14, v131, v132
v_max3_f32 v13, v13, v125, v126
v_max3_f32 v14, v14, v133, v134
v_max_f32 v13, v13, v127
v_max_f32 v14, v14, v135
s_nop 1
v_permlane32_swap_b32 v13, v14
v_max_f32 v13, v13, v14
v_mov_b32 v14, v13
s_nop 1
v_permlane16_swap_b32 v13, v14
v_max_f32 v13, v13, v14
v_mul_f32 v13, s48, v13
v_max_f32 v15, v12, v13
v_sub_f32 v14, v12, v15
v_exp_f32 v54, v14
v_mov_b32 v12, v15
v_mov_b32 v11, v15
v_mov_b32 v16, v54
v_mov_b32 v18, v54
v_permlane32_swap_b32 v15, v11
s_nop 0
v_permlane32_swap_b32 v16, v18
s_waitcnt vmcnt(5)
s_bitcmp1_b32 s88, 1
s_cbranch_scc1 L_sk258
s_waitcnt vmcnt(4)
L_sk258:
buffer_load_dwordx4 v[168:171], v249, s[20:23], s45 offen offset:2048 nt
v_and_b32 v241, 0xff, v10
v_lshrrev_b32 v10, 8, v10
v_cmp_le_u32 vcc, 15, v241
v_cmp_le_u32 s[90:91], 15, v10
s_nop 0
s_bcnt1_i32_b64 s88, vcc
s_bcnt1_i32_b64 s90, s[90:91]
s_add_u32 s90, s90, s88
s_add_u32 s90, s90, s43
s_cmp_ge_u32 s90, 15
s_cselect_b32 s88, 2, 0
s_cmp_le_u32 s90, 5
s_cselect_b32 s88, 1, s88
s_cmp_ge_u32 s90, 10
s_cselect_b64 vcc, -1, 0
v_fma_f32 v120, v120, s48, -v15
v_fma_f32 v121, v121, s48, -v15
v_fma_f32 v122, v122, s48, -v15
v_fma_f32 v123, v123, s48, -v15
v_fma_f32 v124, v124, s48, -v15
v_fma_f32 v125, v125, s48, -v15
v_fma_f32 v126, v126, s48, -v15
v_fma_f32 v127, v127, s48, -v15
v_fma_f32 v128, v128, s48, -v11
v_fma_f32 v129, v129, s48, -v11
v_fma_f32 v130, v130, s48, -v11
v_fma_f32 v131, v131, s48, -v11
v_fma_f32 v132, v132, s48, -v11
v_fma_f32 v133, v133, s48, -v11
v_fma_f32 v134, v134, s48, -v11
v_fma_f32 v135, v135, s48, -v11
v_exp_f32 v120, v120
v_exp_f32 v121, v121
v_exp_f32 v122, v122
v_exp_f32 v123, v123
s_waitcnt vmcnt(5)
s_cbranch_vccnz L_sk259
s_waitcnt vmcnt(4)
L_sk259:
buffer_load_dwordx4 v[172:175], v249, s[20:23], s45 offen offset:3072 nt
v_exp_f32 v124, v124
v_exp_f32 v125, v125
v_exp_f32 v126, v126
v_exp_f32 v127, v127
v_exp_f32 v128, v128
v_exp_f32 v129, v129
v_exp_f32 v130, v130
v_exp_f32 v131, v131
ds_read_b128 v[88:91], v5 offset:8192
ds_read_b128 v[92:95], v6 offset:8192
ds_read_b128 v[96:99], v7 offset:8192
ds_read_b128 v[100:103], v8 offset:8192
s_add_u32 s45, s45, 32768
s_waitcnt vmcnt(4)
buffer_load_dwordx4 v[176:179], v249, s[20:23], s45 offen offset:0 nt
s_barrier
s_waitcnt lgkmcnt(0)
v_mfma_f32_16x16x32_bf16 v[136:139], v[88:91], v[56:59], 0
v_mfma_f32_16x16x32_bf16 v[144:147], v[88:91], v[72:75], 0
v_exp_f32 v132, v132
v_mfma_f32_16x16x32_bf16 v[136:139], v[92:95], v[60:63], v[136:139]
v_mfma_f32_16x16x32_bf16 v[144:147], v[92:95], v[76:79], v[144:147]
v_exp_f32 v133, v133
v_mfma_f32_16x16x32_bf16 v[136:139], v[96:99], v[64:67], v[136:139]
v_mfma_f32_16x16x32_bf16 v[144:147], v[96:99], v[80:83], v[144:147]
v_exp_f32 v134, v134
v_mfma_f32_16x16x32_bf16 v[136:139], v[100:103], v[68:71], v[136:139]
v_mfma_f32_16x16x32_bf16 v[144:147], v[100:103], v[84:87], v[144:147]
v_exp_f32 v135, v135
s_cbranch_vccnz L_sk261
s_waitcnt vmcnt(4)
L_sk261:
buffer_load_dwordx4 v[180:183], v249, s[20:23], s45 offen offset:1024 nt
v_cvt_pk_bf16_f32 v152, v120, v121
v_cvt_pk_bf16_f32 v153, v122, v123
v_cvt_pk_bf16_f32 v154, v124, v125
v_cvt_pk_bf16_f32 v155, v126, v127
v_cvt_pk_bf16_f32 v156, v128, v129
v_cvt_pk_bf16_f32 v157, v130, v131
v_cvt_pk_bf16_f32 v158, v132, v133
v_cvt_pk_bf16_f32 v159, v134, v135
v_accvgpr_write_b32 a240, v152
v_accvgpr_write_b32 a241, v153
v_accvgpr_write_b32 a242, v154
v_accvgpr_write_b32 a243, v155
v_accvgpr_write_b32 a244, v156
v_accvgpr_write_b32 a245, v157
v_accvgpr_write_b32 a246, v158
v_accvgpr_write_b32 a247, v159
s_waitcnt vmcnt(4)
s_bitcmp1_b32 s88, 0
s_cbranch_scc0 L_ng262
s_waitcnt vmcnt(3)
L_ng262:
buffer_load_dwordx4 v[184:187], v249, s[20:23], s45 offen offset:2048 nt
v_fma_f32 v20, v20, v16, v120
v_fma_f32 v21, v21, v18, v128
v_add_f32 v20, v20, v121
v_add_f32 v21, v21, v129
v_add_f32 v20, v20, v122
v_add_f32 v21, v21, v130
v_add_f32 v20, v20, v123
v_add_f32 v21, v21, v131
v_add_f32 v20, v20, v124
v_add_f32 v21, v21, v132
v_add_f32 v20, v20, v125
v_add_f32 v21, v21, v133
v_add_f32 v20, v20, v126
v_add_f32 v21, v21, v134
v_add_f32 v20, v20, v127
v_add_f32 v21, v21, v135
s_cbranch_vccnz L_sk263
s_waitcnt vmcnt(4)
L_sk263:
buffer_load_dwordx4 v[188:191], v249, s[20:23], s45 offen offset:3072 nt
ds_read_b128 v[104:107], v5 offset:12288
ds_read_b128 v[108:111], v6 offset:12288
ds_read_b128 v[112:115], v7 offset:12288
ds_read_b128 v[116:119], v8 offset:12288
s_add_u32 s45, s45, 32768
s_waitcnt vmcnt(4)
buffer_load_dwordx4 v[192:195], v249, s[20:23], s45 offen offset:0 nt
s_barrier
s_waitcnt lgkmcnt(0)
v_mfma_f32_16x16x32_bf16 v[140:143], v[104:107], v[56:59], 0
v_mfma_f32_16x16x32_bf16 v[148:151], v[104:107], v[72:75], 0
v_mfma_f32_16x16x32_bf16 v[140:143], v[108:111], v[60:63], v[140:143]
v_mfma_f32_16x16x32_bf16 v[148:151], v[108:111], v[76:79], v[148:151]
v_mfma_f32_16x16x32_bf16 v[140:143], v[112:115], v[64:67], v[140:143]
v_mfma_f32_16x16x32_bf16 v[148:151], v[112:115], v[80:83], v[148:151]
v_mfma_f32_16x16x32_bf16 v[140:143], v[116:119], v[68:71], v[140:143]
v_mfma_f32_16x16x32_bf16 v[148:151], v[116:119], v[84:87], v[148:151]
s_cbranch_vccnz L_sk265
s_waitcnt vmcnt(4)
L_sk265:
buffer_load_dwordx4 v[196:199], v249, s[20:23], s45 offen offset:1024 nt
v_max3_f32 v13, v136, v137, v138
v_max3_f32 v14, v144, v145, v146
s_nop 2
v_max3_f32 v13, v13, v139, v140
v_max3_f32 v14, v14, v147, v148
v_max3_f32 v13, v13, v141, v142
v_max3_f32 v14, v14, v149, v150
v_max_f32 v13, v13, v143
v_max_f32 v14, v14, v151
s_nop 1
v_permlane32_swap_b32 v13, v14
v_max_f32 v13, v13, v14
v_mov_b32 v14, v13
s_nop 1
v_permlane16_swap_b32 v13, v14
v_max_f32 v13, v13, v14
v_mul_f32 v13, s48, v13
v_max_f32 v15, v12, v13
v_sub_f32 v14, v12, v15
v_exp_f32 v55, v14
v_mov_b32 v12, v15
v_mov_b32 v11, v15
v_mov_b32 v16, v55
v_mov_b32 v18, v55
v_permlane32_swap_b32 v15, v11
s_nop 0
v_permlane32_swap_b32 v16, v18
s_waitcnt vmcnt(5)
s_bitcmp1_b32 s88, 1
s_cbranch_scc1 L_sk266
s_waitcnt vmcnt(4)
L_sk266:
buffer_load_dwordx4 v[200:203], v249, s[20:23], s45 offen offset:2048 nt
v_mov_b32 v241, 16
s_mov_b64 exec, 1
buffer_store_byte v241, v22, s[36:39], s42 offen
s_mov_b64 exec, -1
buffer_load_ushort v10, v240, s[36:39], 0 offen offset:128 nt
v_fma_f32 v136, v136, s48, -v15
v_fma_f32 v137, v137, s48, -v15
v_fma_f32 v138, v138, s48, -v15
v_fma_f32 v139, v139, s48, -v15
v_fma_f32 v140, v140, s48, -v15
v_fma_f32 v141, v141, s48, -v15
v_fma_f32 v142, v142, s48, -v15
v_fma_f32 v143, v143, s48, -v15
v_fma_f32 v144, v144, s48, -v11
v_fma_f32 v145, v145, s48, -v11
v_fma_f32 v146, v146, s48, -v11
v_fma_f32 v147, v147, s48, -v11
v_fma_f32 v148, v148, s48, -v11
v_fma_f32 v149, v149, s48, -v11
v_fma_f32 v150, v150, s48, -v11
v_fma_f32 v151, v151, s48, -v11
v_exp_f32 v136, v136
v_exp_f32 v137, v137
v_exp_f32 v138, v138
v_exp_f32 v139, v139
s_waitcnt vmcnt(7)
s_cbranch_vccnz L_sk267
s_waitcnt vmcnt(6)
L_sk267:
buffer_load_dwordx4 v[204:207], v249, s[20:23], s45 offen offset:3072 nt
v_exp_f32 v140, v140
v_exp_f32 v141, v141
v_exp_f32 v142, v142
v_exp_f32 v143, v143
v_exp_f32 v144, v144
v_exp_f32 v145, v145
v_exp_f32 v146, v146
v_exp_f32 v147, v147
v_perm_b32 v56, v164, v160, s49
v_perm_b32 v57, v172, v168, s49
v_perm_b32 v60, v164, v160, s50
v_perm_b32 v61, v172, v168, s50
s_add_u32 s45, s45, 32768
s_waitcnt vmcnt(6)
buffer_load_dwordx4 v[208:211], v249, s[20:23], s45 offen offset:0 nt
s_barrier
v_exp_f32 v148, v148
v_exp_f32 v149, v149
v_exp_f32 v150, v150
v_exp_f32 v151, v151
v_perm_b32 v64, v165, v161, s49
v_perm_b32 v65, v173, v169, s49
v_perm_b32 v68, v165, v161, s50
v_perm_b32 v69, v173, v169, s50
s_cbranch_vccnz L_sk269
s_waitcnt vmcnt(6)
L_sk269:
buffer_load_dwordx4 v[212:215], v249, s[20:23], s45 offen offset:1024 nt
v_cvt_pk_bf16_f32 v152, v136, v137
v_cvt_pk_bf16_f32 v153, v138, v139
v_cvt_pk_bf16_f32 v154, v140, v141
v_cvt_pk_bf16_f32 v155, v142, v143
v_cvt_pk_bf16_f32 v156, v144, v145
v_cvt_pk_bf16_f32 v157, v146, v147
v_cvt_pk_bf16_f32 v158, v148, v149
v_cvt_pk_bf16_f32 v159, v150, v151
v_accvgpr_write_b32 a248, v152
v_accvgpr_write_b32 a249, v153
v_accvgpr_write_b32 a250, v154
v_accvgpr_write_b32 a251, v155
v_accvgpr_write_b32 a252, v156
v_accvgpr_write_b32 a253, v157
v_accvgpr_write_b32 a254, v158
v_accvgpr_write_b32 a255, v159
v_perm_b32 v72, v166, v162, s49
v_perm_b32 v73, v174, v170, s49
v_perm_b32 v76, v166, v162, s50
v_perm_b32 v77, v174, v170, s50
s_waitcnt vmcnt(6)
s_bitcmp1_b32 s88, 0
s_cbranch_scc0 L_ng270
s_waitcnt vmcnt(5)
L_ng270:
buffer_load_dwordx4 v[216:219], v249, s[20:23], s45 offen offset:2048 nt
v_fma_f32 v20, v20, v16, v136
v_fma_f32 v21, v21, v18, v144
v_add_f32 v20, v20, v137
v_add_f32 v21, v21, v145
v_add_f32 v20, v20, v138
v_add_f32 v21, v21, v146
v_add_f32 v20, v20, v139
v_add_f32 v21, v21, v147
v_add_f32 v20, v20, v140
v_add_f32 v21, v21, v148
v_add_f32 v20, v20, v141
v_add_f32 v21, v21, v149
v_add_f32 v20, v20, v142
v_add_f32 v21, v21, v150
v_add_f32 v20, v20, v143
v_add_f32 v21, v21, v151
v_perm_b32 v80, v167, v163, s49
v_perm_b32 v81, v175, v171, s49
v_perm_b32 v84, v167, v163, s50
v_perm_b32 v85, v175, v171, s50
s_cbranch_vccnz L_sk271
s_waitcnt vmcnt(6)
L_sk271:
buffer_load_dwordx4 v[220:223], v249, s[20:23], s45 offen offset:3072 nt
v_perm_b32 v58, v180, v176, s49
v_perm_b32 v59, v188, v184, s49
v_perm_b32 v62, v180, v176, s50
v_perm_b32 v63, v188, v184, s50
v_mfma_f32_16x16x32_bf16 v[88:91], v[56:59], a[0:3], 0
v_mfma_f32_16x16x32_bf16 v[120:123], v[56:59], a[4:7], 0
v_mfma_f32_16x16x32_bf16 v[92:95], v[60:63], a[0:3], 0
v_mfma_f32_16x16x32_bf16 v[124:127], v[60:63], a[4:7], 0
s_add_u32 s45, s45, 32768
s_waitcnt vmcnt(4)
buffer_load_dwordx4 v[224:227], v249, s[20:23], s45 offen offset:0 nt
s_barrier
v_perm_b32 v66, v181, v177, s49
v_perm_b32 v67, v189, v185, s49
v_perm_b32 v70, v181, v177, s50
v_perm_b32 v71, v189, v185, s50
v_mfma_f32_16x16x32_bf16 v[96:99], v[64:67], a[0:3], 0
v_mfma_f32_16x16x32_bf16 v[128:131], v[64:67], a[4:7], 0
v_mfma_f32_16x16x32_bf16 v[100:103], v[68:71], a[0:3], 0
v_mfma_f32_16x16x32_bf16 v[132:135], v[68:71], a[4:7], 0
s_cbranch_vccnz L_sk273
s_waitcnt vmcnt(4)
L_sk273:
buffer_load_dwordx4 v[228:231], v249, s[20:23], s45 offen offset:1024 nt
v_perm_b32 v74, v182, v178, s49
v_perm_b32 v75, v190, v186, s49
v_perm_b32 v78, v182, v178, s50
v_perm_b32 v79, v190, v186, s50
v_mfma_f32_16x16x32_bf16 v[104:107], v[72:75], a[0:3], 0
v_mfma_f32_16x16x32_bf16 v[136:139], v[72:75], a[4:7], 0
v_mfma_f32_16x16x32_bf16 v[108:111], v[76:79], a[0:3], 0
v_mfma_f32_16x16x32_bf16 v[140:143], v[76:79], a[4:7], 0
s_waitcnt vmcnt(5)
s_bitcmp1_b32 s88, 1
s_cbranch_scc1 L_sk274
s_waitcnt vmcnt(4)
L_sk274:
buffer_load_dwordx4 v[232:235], v249, s[20:23], s45 offen offset:2048 nt
v_and_b32 v241, 0xff, v10
v_lshrrev_b32 v10, 8, v10
v_cmp_le_u32 vcc, 16, v241
v_cmp_le_u32 s[90:91], 16, v10
s_nop 0
s_bcnt1_i32_b64 s88, vcc
s_bcnt1_i32_b64 s90, s[90:91]
s_add_u32 s90, s90, s88
s_add_u32 s90, s90, s43
s_cmp_ge_u32 s90, 15
s_cselect_b32 s88, 2, 0
s_cmp_le_u32 s90, 5
s_cselect_b32 s88, 1, s88
s_cmp_ge_u32 s90, 10
s_cselect_b64 vcc, -1, 0
v_perm_b32 v82, v183, v179, s49
v_perm_b32 v83, v191, v187, s49
v_perm_b32 v86, v183, v179, s50
v_perm_b32 v87, v191, v187, s50
v_mfma_f32_16x16x32_bf16 v[112:115], v[80:83], a[0:3], 0
v_mfma_f32_16x16x32_bf16 v[144:147], v[80:83], a[4:7], 0
v_mfma_f32_16x16x32_bf16 v[116:119], v[84:87], a[0:3], 0
v_mfma_f32_16x16x32_bf16 v[148:151], v[84:87], a[4:7], 0
s_waitcnt vmcnt(5)
s_cbranch_vccnz L_sk275
s_waitcnt vmcnt(4)
L_sk275:
buffer_load_dwordx4 v[236:239], v249, s[20:23], s45 offen offset:3072 nt
v_mov_b32 v16, v25
v_mov_b32 v18, v25
s_nop 1
v_permlane32_swap_b32 v16, v18
v_pk_mul_f32 v[88:89], v[88:89], v[16:17] op_sel_hi:[1,0]
v_pk_mul_f32 v[90:91], v[90:91], v[16:17] op_sel_hi:[1,0]
v_pk_mul_f32 v[120:121], v[120:121], v[18:19] op_sel_hi:[1,0]
v_pk_mul_f32 v[122:123], v[122:123], v[18:19] op_sel_hi:[1,0]
v_pk_mul_f32 v[92:93], v[92:93], v[16:17] op_sel_hi:[1,0]
v_pk_mul_f32 v[94:95], v[94:95], v[16:17] op_sel_hi:[1,0]
v_pk_mul_f32 v[124:125], v[124:125], v[18:19] op_sel_hi:[1,0]
v_pk_mul_f32 v[126:127], v[126:127], v[18:19] op_sel_hi:[1,0]
v_perm_b32 v56, v196, v192, s49
v_perm_b32 v57, v204, v200, s49
v_perm_b32 v60, v196, v192, s50
v_perm_b32 v61, v204, v200, s50
s_add_u32 s45, s45, 32768
s_waitcnt vmcnt(4)
buffer_load_dwordx4 v[160:163], v249, s[20:23], s45 offen offset:0 nt
s_barrier
v_pk_mul_f32 v[96:97], v[96:97], v[16:17] op_sel_hi:[1,0]
v_pk_mul_f32 v[98:99], v[98:99], v[16:17] op_sel_hi:[1,0]
v_pk_mul_f32 v[128:129], v[128:129], v[18:19] op_sel_hi:[1,0]
v_pk_mul_f32 v[130:131], v[130:131], v[18:19] op_sel_hi:[1,0]
v_pk_mul_f32 v[100:101], v[100:101], v[16:17] op_sel_hi:[1,0]
v_pk_mul_f32 v[102:103], v[102:103], v[16:17] op_sel_hi:[1,0]
v_pk_mul_f32 v[132:133], v[132:133], v[18:19] op_sel_hi:[1,0]
v_pk_mul_f32 v[134:135], v[134:135], v[18:19] op_sel_hi:[1,0]
v_perm_b32 v64, v197, v193, s49
v_perm_b32 v65, v205, v201, s49
v_perm_b32 v68, v197, v193, s50
v_perm_b32 v69, v205, v201, s50
s_cbranch_vccnz L_sk277
s_waitcnt vmcnt(4)
L_sk277:
buffer_load_dwordx4 v[164:167], v249, s[20:23], s45 offen offset:1024 nt
v_permlane32_swap_b32 v20, v21
v_add_f32 v13, v20, v21
v_mov_b32 v14, v13
s_nop 1
v_permlane16_swap_b32 v13, v14
v_add_f32 v13, v13, v14
s_lshl_b32 s46, s40, 9
s_add_u32 s46, s46, 65536
v_lshl_add_u32 v14, v0, 3, s46
ds_write_b64 v14, v[12:13]
v_pk_mul_f32 v[104:105], v[104:105], v[16:17] op_sel_hi:[1,0]
v_pk_mul_f32 v[106:107], v[106:107], v[16:17] op_sel_hi:[1,0]
v_pk_mul_f32 v[136:137], v[136:137], v[18:19] op_sel_hi:[1,0]
v_pk_mul_f32 v[138:139], v[138:139], v[18:19] op_sel_hi:[1,0]
v_pk_mul_f32 v[108:109], v[108:109], v[16:17] op_sel_hi:[1,0]
v_pk_mul_f32 v[110:111], v[110:111], v[16:17] op_sel_hi:[1,0]
v_pk_mul_f32 v[140:141], v[140:141], v[18:19] op_sel_hi:[1,0]
v_pk_mul_f32 v[142:143], v[142:143], v[18:19] op_sel_hi:[1,0]
v_perm_b32 v72, v198, v194, s49
v_perm_b32 v73, v206, v202, s49
v_perm_b32 v76, v198, v194, s50
v_perm_b32 v77, v206, v202, s50
s_waitcnt vmcnt(4)
s_bitcmp1_b32 s88, 0
s_cbranch_scc0 L_ng278
s_waitcnt vmcnt(3)
L_ng278:
buffer_load_dwordx4 v[168:171], v249, s[20:23], s45 offen offset:2048 nt
v_and_b32 v1, 31, v0
v_lshl_add_u32 v1, v1, 4, s47
v_lshrrev_b32 v2, 5, v0
v_lshl_add_u32 v1, v2, 11, v1
v_xor_b32 v2, 0x80, v1
s_mov_b32 s65, 0x7000000
s_lshr_b32 s53, s40, 1
s_and_b32 s54, s40, 1
v_and_b32 v6, 7, v0
v_bfe_u32 v7, v0, 3, 2
v_lshrrev_b32 v8, 5, v0
s_lshl_b32 s46, s54, 3
v_add_u32 v5, s46, v6
s_lshl_b32 s46, s53, 8
s_add_u32 s46, s46, 65536
v_lshl_add_u32 v3, v5, 3, s46
v_and_b32 v4, 1, v7
v_lshlrev_b32 v4, 3, v4
v_xor_b32 v4, v4, v5
v_lshlrev_b32 v4, 4, v4
v_lshl_add_u32 v4, v8, 8, v4
v_lshl_add_u32 v4, v7, 10, v4
s_lshl_b32 s46, s53, 12
v_add_u32 v4, s46, v4
v_pk_mul_f32 v[112:113], v[112:113], v[16:17] op_sel_hi:[1,0]
v_pk_mul_f32 v[114:115], v[114:115], v[16:17] op_sel_hi:[1,0]
v_pk_mul_f32 v[144:145], v[144:145], v[18:19] op_sel_hi:[1,0]
v_pk_mul_f32 v[146:147], v[146:147], v[18:19] op_sel_hi:[1,0]
v_pk_mul_f32 v[116:117], v[116:117], v[16:17] op_sel_hi:[1,0]
v_pk_mul_f32 v[118:119], v[118:119], v[16:17] op_sel_hi:[1,0]
v_pk_mul_f32 v[148:149], v[148:149], v[18:19] op_sel_hi:[1,0]
v_pk_mul_f32 v[150:151], v[150:151], v[18:19] op_sel_hi:[1,0]
v_perm_b32 v80, v199, v195, s49
v_perm_b32 v81, v207, v203, s49
v_perm_b32 v84, v199, v195, s50
v_perm_b32 v85, v207, v203, s50
s_cbranch_vccnz L_sk279
s_waitcnt vmcnt(4)
L_sk279:
buffer_load_dwordx4 v[172:175], v249, s[20:23], s45 offen offset:3072 nt
s_mul_i32 s46, s40, 1152
s_add_u32 s46, s46, 67584
v_mul_u32_u24 v5, 144, v6
v_lshl_add_u32 v5, v8, 6, v5
v_lshl_add_u32 v5, v7, 2, v5
v_add_u32 v5, s46, v5
v_lshrrev_b32 v7, 3, v0
v_lshlrev_b32 v8, 4, v6
v_lshl_add_u32 v15, v7, 8, v8
v_mul_u32_u24 v6, 144, v7
v_add_u32 v6, v6, v8
v_add_u32 v6, s46, v6
s_lshl_b32 s46, s40, 2
s_add_u32 s46, s46, 72192
v_mov_b32 v7, s46
v_mov_b32 v8, 72192
ds_write_b32 v7, v22
v_perm_b32 v58, v212, v208, s49
v_perm_b32 v59, v220, v216, s49
v_perm_b32 v62, v212, v208, s50
v_perm_b32 v63, v220, v216, s50
v_mfma_f32_16x16x32_bf16 v[88:91], v[56:59], a[8:11], v[88:91]
v_mfma_f32_16x16x32_bf16 v[120:123], v[56:59], a[12:15], v[120:123]
v_mfma_f32_16x16x32_bf16 v[92:95], v[60:63], a[8:11], v[92:95]
v_mfma_f32_16x16x32_bf16 v[124:127], v[60:63], a[12:15], v[124:127]
s_add_u32 s45, s45, 32768
s_waitcnt vmcnt(4)
buffer_load_dwordx4 v[176:179], v249, s[20:23], s45 offen offset:0 nt
s_barrier
v_perm_b32 v66, v213, v209, s49
v_perm_b32 v67, v221, v217, s49
v_perm_b32 v70, v213, v209, s50
v_perm_b32 v71, v221, v217, s50
v_mfma_f32_16x16x32_bf16 v[96:99], v[64:67], a[8:11], v[96:99]
v_mfma_f32_16x16x32_bf16 v[128:131], v[64:67], a[12:15], v[128:131]
v_mfma_f32_16x16x32_bf16 v[100:103], v[68:71], a[8:11], v[100:103]
v_mfma_f32_16x16x32_bf16 v[132:135], v[68:71], a[12:15], v[132:135]
s_cbranch_vccnz L_sk281
s_waitcnt vmcnt(4)
L_sk281:
buffer_load_dwordx4 v[180:183], v249, s[20:23], s45 offen offset:1024 nt
v_perm_b32 v74, v214, v210, s49
v_perm_b32 v75, v222, v218, s49
v_perm_b32 v78, v214, v210, s50
v_perm_b32 v79, v222, v218, s50
v_mfma_f32_16x16x32_bf16 v[104:107], v[72:75], a[8:11], v[104:107]
v_mfma_f32_16x16x32_bf16 v[136:139], v[72:75], a[12:15], v[136:139]
v_mfma_f32_16x16x32_bf16 v[108:111], v[76:79], a[8:11], v[108:111]
v_mfma_f32_16x16x32_bf16 v[140:143], v[76:79], a[12:15], v[140:143]
s_waitcnt vmcnt(5)
s_bitcmp1_b32 s88, 1
s_cbranch_scc1 L_sk282
s_waitcnt vmcnt(4)
L_sk282:
buffer_load_dwordx4 v[184:187], v249, s[20:23], s45 offen offset:2048 nt
v_mov_b32 v241, 17
s_mov_b64 exec, 1
buffer_store_byte v241, v22, s[36:39], s42 offen
s_mov_b64 exec, -1
buffer_load_ushort v10, v240, s[36:39], 0 offen offset:128 nt
v_perm_b32 v82, v215, v211, s49
v_perm_b32 v83, v223, v219, s49
v_perm_b32 v86, v215, v211, s50
v_perm_b32 v87, v223, v219, s50
v_mfma_f32_16x16x32_bf16 v[112:115], v[80:83], a[8:11], v[112:115]
v_mfma_f32_16x16x32_bf16 v[144:147], v[80:83], a[12:15], v[144:147]
v_mfma_f32_16x16x32_bf16 v[116:119], v[84:87], a[8:11], v[116:119]
v_mfma_f32_16x16x32_bf16 v[148:151], v[84:87], a[12:15], v[148:151]
s_waitcnt vmcnt(7)
s_cbranch_vccnz L_sk283
s_waitcnt vmcnt(6)
L_sk283:
buffer_load_dwordx4 v[188:191], v249, s[20:23], s45 offen offset:3072 nt
v_mov_b32 v16, v26
v_mov_b32 v18, v26
s_nop 1
v_permlane32_swap_b32 v16, v18
v_pk_mul_f32 v[88:89], v[88:89], v[16:17] op_sel_hi:[1,0]
v_pk_mul_f32 v[90:91], v[90:91], v[16:17] op_sel_hi:[1,0]
v_pk_mul_f32 v[120:121], v[120:121], v[18:19] op_sel_hi:[1,0]
v_pk_mul_f32 v[122:123], v[122:123], v[18:19] op_sel_hi:[1,0]
v_pk_mul_f32 v[92:93], v[92:93], v[16:17] op_sel_hi:[1,0]
v_pk_mul_f32 v[94:95], v[94:95], v[16:17] op_sel_hi:[1,0]
v_pk_mul_f32 v[124:125], v[124:125], v[18:19] op_sel_hi:[1,0]
v_pk_mul_f32 v[126:127], v[126:127], v[18:19] op_sel_hi:[1,0]
v_perm_b32 v56, v228, v224, s49
v_perm_b32 v57, v236, v232, s49
v_perm_b32 v60, v228, v224, s50
v_perm_b32 v61, v236, v232, s50
s_add_u32 s45, s45, 32768
s_waitcnt vmcnt(6)
buffer_load_dwordx4 v[192:195], v249, s[20:23], s45 offen offset:0 nt
s_barrier
v_pk_mul_f32 v[96:97], v[96:97], v[16:17] op_sel_hi:[1,0]
v_pk_mul_f32 v[98:99], v[98:99], v[16:17] op_sel_hi:[1,0]
v_pk_mul_f32 v[128:129], v[128:129], v[18:19] op_sel_hi:[1,0]
v_pk_mul_f32 v[130:131], v[130:131], v[18:19] op_sel_hi:[1,0]
v_pk_mul_f32 v[100:101], v[100:101], v[16:17] op_sel_hi:[1,0]
v_pk_mul_f32 v[102:103], v[102:103], v[16:17] op_sel_hi:[1,0]
v_pk_mul_f32 v[132:133], v[132:133], v[18:19] op_sel_hi:[1,0]
v_pk_mul_f32 v[134:135], v[134:135], v[18:19] op_sel_hi:[1,0]
v_perm_b32 v64, v229, v225, s49
v_perm_b32 v65, v237, v233, s49
v_perm_b32 v68, v229, v225, s50
v_perm_b32 v69, v237, v233, s50
s_cbranch_vccnz L_sk285
s_waitcnt vmcnt(6)
L_sk285:
buffer_load_dwordx4 v[196:199], v249, s[20:23], s45 offen offset:1024 nt
v_pk_mul_f32 v[104:105], v[104:105], v[16:17] op_sel_hi:[1,0]
v_pk_mul_f32 v[106:107], v[106:107], v[16:17] op_sel_hi:[1,0]
v_pk_mul_f32 v[136:137], v[136:137], v[18:19] op_sel_hi:[1,0]
v_pk_mul_f32 v[138:139], v[138:139], v[18:19] op_sel_hi:[1,0]
v_pk_mul_f32 v[108:109], v[108:109], v[16:17] op_sel_hi:[1,0]
v_pk_mul_f32 v[110:111], v[110:111], v[16:17] op_sel_hi:[1,0]
v_pk_mul_f32 v[140:141], v[140:141], v[18:19] op_sel_hi:[1,0]
v_pk_mul_f32 v[142:143], v[142:143], v[18:19] op_sel_hi:[1,0]
v_perm_b32 v72, v230, v226, s49
v_perm_b32 v73, v238, v234, s49
v_perm_b32 v76, v230, v226, s50
v_perm_b32 v77, v238, v234, s50
s_waitcnt vmcnt(6)
s_bitcmp1_b32 s88, 0
s_cbranch_scc0 L_ng286
s_waitcnt vmcnt(5)
L_ng286:
buffer_load_dwordx4 v[200:203], v249, s[20:23], s45 offen offset:2048 nt
v_pk_mul_f32 v[112:113], v[112:113], v[16:17] op_sel_hi:[1,0]
v_pk_mul_f32 v[114:115], v[114:115], v[16:17] op_sel_hi:[1,0]
v_pk_mul_f32 v[144:145], v[144:145], v[18:19] op_sel_hi:[1,0]
v_pk_mul_f32 v[146:147], v[146:147], v[18:19] op_sel_hi:[1,0]
v_pk_mul_f32 v[116:117], v[116:117], v[16:17] op_sel_hi:[1,0]
v_pk_mul_f32 v[118:119], v[118:119], v[16:17] op_sel_hi:[1,0]
v_pk_mul_f32 v[148:149], v[148:149], v[18:19] op_sel_hi:[1,0]
v_pk_mul_f32 v[150:151], v[150:151], v[18:19] op_sel_hi:[1,0]
v_perm_b32 v80, v231, v227, s49
v_perm_b32 v81, v239, v235, s49
v_perm_b32 v84, v231, v227, s50
v_perm_b32 v85, v239, v235, s50
s_cbranch_vccnz L_sk287
s_waitcnt vmcnt(6)
L_sk287:
buffer_load_dwordx4 v[204:207], v249, s[20:23], s45 offen offset:3072 nt
v_perm_b32 v58, v164, v160, s49
v_perm_b32 v59, v172, v168, s49
v_perm_b32 v62, v164, v160, s50
v_perm_b32 v63, v172, v168, s50
v_mfma_f32_16x16x32_bf16 v[88:91], v[56:59], a[16:19], v[88:91]
v_mfma_f32_16x16x32_bf16 v[120:123], v[56:59], a[20:23], v[120:123]
v_mfma_f32_16x16x32_bf16 v[92:95], v[60:63], a[16:19], v[92:95]
v_mfma_f32_16x16x32_bf16 v[124:127], v[60:63], a[20:23], v[124:127]
s_add_u32 s45, s45, 32768
s_waitcnt vmcnt(4)
buffer_load_dwordx4 v[208:211], v249, s[20:23], s45 offen offset:0 nt
s_barrier
v_perm_b32 v66, v165, v161, s49
v_perm_b32 v67, v173, v169, s49
v_perm_b32 v70, v165, v161, s50
v_perm_b32 v71, v173, v169, s50
v_mfma_f32_16x16x32_bf16 v[96:99], v[64:67], a[16:19], v[96:99]
v_mfma_f32_16x16x32_bf16 v[128:131], v[64:67], a[20:23], v[128:131]
v_mfma_f32_16x16x32_bf16 v[100:103], v[68:71], a[16:19], v[100:103]
v_mfma_f32_16x16x32_bf16 v[132:135], v[68:71], a[20:23], v[132:135]
s_cbranch_vccnz L_sk289
s_waitcnt vmcnt(4)
L_sk289:
buffer_load_dwordx4 v[212:215], v249, s[20:23], s45 offen offset:1024 nt
v_perm_b32 v74, v166, v162, s49
v_perm_b32 v75, v174, v170, s49
v_perm_b32 v78, v166, v162, s50
v_perm_b32 v79, v174, v170, s50
v_mfma_f32_16x16x32_bf16 v[104:107], v[72:75], a[16:19], v[104:107]
v_mfma_f32_16x16x32_bf16 v[136:139], v[72:75], a[20:23], v[136:139]
v_mfma_f32_16x16x32_bf16 v[108:111], v[76:79], a[16:19], v[108:111]
v_mfma_f32_16x16x32_bf16 v[140:143], v[76:79], a[20:23], v[140:143]
s_waitcnt vmcnt(5)
s_bitcmp1_b32 s88, 1
s_cbranch_scc1 L_sk290
s_waitcnt vmcnt(4)
L_sk290:
buffer_load_dwordx4 v[216:219], v249, s[20:23], s45 offen offset:2048 nt
v_and_b32 v241, 0xff, v10
v_lshrrev_b32 v10, 8, v10
v_cmp_le_u32 vcc, 17, v241
v_cmp_le_u32 s[90:91], 17, v10
s_nop 0
s_bcnt1_i32_b64 s88, vcc
s_bcnt1_i32_b64 s90, s[90:91]
s_add_u32 s90, s90, s88
s_add_u32 s90, s90, s43
s_cmp_ge_u32 s90, 15
s_cselect_b32 s88, 2, 0
s_cmp_le_u32 s90, 5
s_cselect_b32 s88, 1, s88
s_cmp_ge_u32 s90, 10
s_cselect_b64 vcc, -1, 0
v_perm_b32 v82, v167, v163, s49
v_perm_b32 v83, v175, v171, s49
v_perm_b32 v86, v167, v163, s50
v_perm_b32 v87, v175, v171, s50
v_mfma_f32_16x16x32_bf16 v[112:115], v[80:83], a[16:19], v[112:115]
v_mfma_f32_16x16x32_bf16 v[144:147], v[80:83], a[20:23], v[144:147]
v_mfma_f32_16x16x32_bf16 v[116:119], v[84:87], a[16:19], v[116:119]
v_mfma_f32_16x16x32_bf16 v[148:151], v[84:87], a[20:23], v[148:151]
s_waitcnt vmcnt(5)
s_cbranch_vccnz L_sk291
s_waitcnt vmcnt(4)
L_sk291:
buffer_load_dwordx4 v[220:223], v249, s[20:23], s45 offen offset:3072 nt
v_mov_b32 v16, v27
v_mov_b32 v18, v27
s_nop 1
v_permlane32_swap_b32 v16, v18
v_pk_mul_f32 v[88:89], v[88:89], v[16:17] op_sel_hi:[1,0]
v_pk_mul_f32 v[90:91], v[90:91], v[16:17] op_sel_hi:[1,0]
v_pk_mul_f32 v[120:121], v[120:121], v[18:19] op_sel_hi:[1,0]
v_pk_mul_f32 v[122:123], v[122:123], v[18:19] op_sel_hi:[1,0]
v_pk_mul_f32 v[92:93], v[92:93], v[16:17] op_sel_hi:[1,0]
v_pk_mul_f32 v[94:95], v[94:95], v[16:17] op_sel_hi:[1,0]
v_pk_mul_f32 v[124:125], v[124:125], v[18:19] op_sel_hi:[1,0]
v_pk_mul_f32 v[126:127], v[126:127], v[18:19] op_sel_hi:[1,0]
v_perm_b32 v56, v180, v176, s49
v_perm_b32 v57, v188, v184, s49
v_perm_b32 v60, v180, v176, s50
v_perm_b32 v61, v188, v184, s50
s_add_u32 s45, s45, 32768
s_waitcnt vmcnt(4)
buffer_load_dwordx4 v[224:227], v249, s[20:23], s45 offen offset:0 nt
s_barrier
v_pk_mul_f32 v[96:97], v[96:97], v[16:17] op_sel_hi:[1,0]
v_pk_mul_f32 v[98:99], v[98:99], v[16:17] op_sel_hi:[1,0]
v_pk_mul_f32 v[128:129], v[128:129], v[18:19] op_sel_hi:[1,0]
v_pk_mul_f32 v[130:131], v[130:131], v[18:19] op_sel_hi:[1,0]
v_pk_mul_f32 v[100:101], v[100:101], v[16:17] op_sel_hi:[1,0]
v_pk_mul_f32 v[102:103], v[102:103], v[16:17] op_sel_hi:[1,0]
v_pk_mul_f32 v[132:133], v[132:133], v[18:19] op_sel_hi:[1,0]
v_pk_mul_f32 v[134:135], v[134:135], v[18:19] op_sel_hi:[1,0]
v_perm_b32 v64, v181, v177, s49
v_perm_b32 v65, v189, v185, s49
v_perm_b32 v68, v181, v177, s50
v_perm_b32 v69, v189, v185, s50
s_cbranch_vccnz L_sk293
s_waitcnt vmcnt(4)
L_sk293:
buffer_load_dwordx4 v[228:231], v249, s[20:23], s45 offen offset:1024 nt
v_pk_mul_f32 v[104:105], v[104:105], v[16:17] op_sel_hi:[1,0]
v_pk_mul_f32 v[106:107], v[106:107], v[16:17] op_sel_hi:[1,0]
v_pk_mul_f32 v[136:137], v[136:137], v[18:19] op_sel_hi:[1,0]
v_pk_mul_f32 v[138:139], v[138:139], v[18:19] op_sel_hi:[1,0]
v_pk_mul_f32 v[108:109], v[108:109], v[16:17] op_sel_hi:[1,0]
v_pk_mul_f32 v[110:111], v[110:111], v[16:17] op_sel_hi:[1,0]
v_pk_mul_f32 v[140:141], v[140:141], v[18:19] op_sel_hi:[1,0]
v_pk_mul_f32 v[142:143], v[142:143], v[18:19] op_sel_hi:[1,0]
v_perm_b32 v72, v182, v178, s49
v_perm_b32 v73, v190, v186, s49
v_perm_b32 v76, v182, v178, s50
v_perm_b32 v77, v190, v186, s50
s_waitcnt vmcnt(4)
s_bitcmp1_b32 s88, 0
s_cbranch_scc0 L_ng294
s_waitcnt vmcnt(3)
L_ng294:
buffer_load_dwordx4 v[232:235], v249, s[20:23], s45 offen offset:2048 nt
v_pk_mul_f32 v[112:113], v[112:113], v[16:17] op_sel_hi:[1,0]
v_pk_mul_f32 v[114:115], v[114:115], v[16:17] op_sel_hi:[1,0]
v_pk_mul_f32 v[144:145], v[144:145], v[18:19] op_sel_hi:[1,0]
v_pk_mul_f32 v[146:147], v[146:147], v[18:19] op_sel_hi:[1,0]
v_pk_mul_f32 v[116:117], v[116:117], v[16:17] op_sel_hi:[1,0]
v_pk_mul_f32 v[118:119], v[118:119], v[16:17] op_sel_hi:[1,0]
v_pk_mul_f32 v[148:149], v[148:149], v[18:19] op_sel_hi:[1,0]
v_pk_mul_f32 v[150:151], v[150:151], v[18:19] op_sel_hi:[1,0]
v_perm_b32 v80, v183, v179, s49
v_perm_b32 v81, v191, v187, s49
v_perm_b32 v84, v183, v179, s50
v_perm_b32 v85, v191, v187, s50
s_cbranch_vccnz L_sk295
s_waitcnt vmcnt(4)
L_sk295:
buffer_load_dwordx4 v[236:239], v249, s[20:23], s45 offen offset:3072 nt
v_perm_b32 v58, v196, v192, s49
v_perm_b32 v59, v204, v200, s49
v_perm_b32 v62, v196, v192, s50
v_perm_b32 v63, v204, v200, s50
v_mfma_f32_16x16x32_bf16 v[88:91], v[56:59], a[24:27], v[88:91]
v_mfma_f32_16x16x32_bf16 v[120:123], v[56:59], a[28:31], v[120:123]
v_mfma_f32_16x16x32_bf16 v[92:95], v[60:63], a[24:27], v[92:95]
v_mfma_f32_16x16x32_bf16 v[124:127], v[60:63], a[28:31], v[124:127]
s_add_u32 s45, s45, 32768
s_waitcnt vmcnt(4)
buffer_load_dwordx4 v[160:163], v249, s[20:23], s45 offen offset:0 nt
s_barrier
v_perm_b32 v66, v197, v193, s49
v_perm_b32 v67, v205, v201, s49
v_perm_b32 v70, v197, v193, s50
v_perm_b32 v71, v205, v201, s50
v_mfma_f32_16x16x32_bf16 v[96:99], v[64:67], a[24:27], v[96:99]
v_mfma_f32_16x16x32_bf16 v[128:131], v[64:67], a[28:31], v[128:131]
v_mfma_f32_16x16x32_bf16 v[100:103], v[68:71], a[24:27], v[100:103]
v_mfma_f32_16x16x32_bf16 v[132:135], v[68:71], a[28:31], v[132:135]
s_cbranch_vccnz L_sk297
s_waitcnt vmcnt(4)
L_sk297:
buffer_load_dwordx4 v[164:167], v249, s[20:23], s45 offen offset:1024 nt
v_perm_b32 v74, v198, v194, s49
v_perm_b32 v75, v206, v202, s49
v_perm_b32 v78, v198, v194, s50
v_perm_b32 v79, v206, v202, s50
v_mfma_f32_16x16x32_bf16 v[104:107], v[72:75], a[24:27], v[104:107]
v_mfma_f32_16x16x32_bf16 v[136:139], v[72:75], a[28:31], v[136:139]
v_mfma_f32_16x16x32_bf16 v[108:111], v[76:79], a[24:27], v[108:111]
v_mfma_f32_16x16x32_bf16 v[140:143], v[76:79], a[28:31], v[140:143]
s_waitcnt vmcnt(5)
s_bitcmp1_b32 s88, 1
s_cbranch_scc1 L_sk298
s_waitcnt vmcnt(4)
L_sk298:
buffer_load_dwordx4 v[168:171], v249, s[20:23], s45 offen offset:2048 nt
v_mov_b32 v241, 18
s_mov_b64 exec, 1
buffer_store_byte v241, v22, s[36:39], s42 offen
s_mov_b64 exec, -1
buffer_load_ushort v10, v240, s[36:39], 0 offen offset:128 nt
v_perm_b32 v82, v199, v195, s49
v_perm_b32 v83, v207, v203, s49
v_perm_b32 v86, v199, v195, s50
v_perm_b32 v87, v207, v203, s50
v_mfma_f32_16x16x32_bf16 v[112:115], v[80:83], a[24:27], v[112:115]
v_mfma_f32_16x16x32_bf16 v[144:147], v[80:83], a[28:31], v[144:147]
v_mfma_f32_16x16x32_bf16 v[116:119], v[84:87], a[24:27], v[116:119]
v_mfma_f32_16x16x32_bf16 v[148:151], v[84:87], a[28:31], v[148:151]
s_waitcnt vmcnt(7)
s_cbranch_vccnz L_sk299
s_waitcnt vmcnt(6)
L_sk299:
buffer_load_dwordx4 v[172:175], v249, s[20:23], s45 offen offset:3072 nt
v_mov_b32 v16, v28
v_mov_b32 v18, v28
s_nop 1
v_permlane32_swap_b32 v16, v18
v_pk_mul_f32 v[88:89], v[88:89], v[16:17] op_sel_hi:[1,0]
v_pk_mul_f32 v[90:91], v[90:91], v[16:17] op_sel_hi:[1,0]
v_pk_mul_f32 v[120:121], v[120:121], v[18:19] op_sel_hi:[1,0]
v_pk_mul_f32 v[122:123], v[122:123], v[18:19] op_sel_hi:[1,0]
v_pk_mul_f32 v[92:93], v[92:93], v[16:17] op_sel_hi:[1,0]
v_pk_mul_f32 v[94:95], v[94:95], v[16:17] op_sel_hi:[1,0]
v_pk_mul_f32 v[124:125], v[124:125], v[18:19] op_sel_hi:[1,0]
v_pk_mul_f32 v[126:127], v[126:127], v[18:19] op_sel_hi:[1,0]
v_perm_b32 v56, v212, v208, s49
v_perm_b32 v57, v220, v216, s49
v_perm_b32 v60, v212, v208, s50
v_perm_b32 v61, v220, v216, s50
s_add_u32 s45, s45, 32768
s_waitcnt vmcnt(6)
buffer_load_dwordx4 v[176:179], v249, s[20:23], s45 offen offset:0 nt
s_barrier
v_pk_mul_f32 v[96:97], v[96:97], v[16:17] op_sel_hi:[1,0]
v_pk_mul_f32 v[98:99], v[98:99], v[16:17] op_sel_hi:[1,0]
v_pk_mul_f32 v[128:129], v[128:129], v[18:19] op_sel_hi:[1,0]
v_pk_mul_f32 v[130:131], v[130:131], v[18:19] op_sel_hi:[1,0]
v_pk_mul_f32 v[100:101], v[100:101], v[16:17] op_sel_hi:[1,0]
v_pk_mul_f32 v[102:103], v[102:103], v[16:17] op_sel_hi:[1,0]
v_pk_mul_f32 v[132:133], v[132:133], v[18:19] op_sel_hi:[1,0]
v_pk_mul_f32 v[134:135], v[134:135], v[18:19] op_sel_hi:[1,0]
v_perm_b32 v64, v213, v209, s49
v_perm_b32 v65, v221, v217, s49
v_perm_b32 v68, v213, v209, s50
v_perm_b32 v69, v221, v217, s50
s_cbranch_vccnz L_sk301
s_waitcnt vmcnt(6)
L_sk301:
buffer_load_dwordx4 v[180:183], v249, s[20:23], s45 offen offset:1024 nt
v_pk_mul_f32 v[104:105], v[104:105], v[16:17] op_sel_hi:[1,0]
v_pk_mul_f32 v[106:107], v[106:107], v[16:17] op_sel_hi:[1,0]
v_pk_mul_f32 v[136:137], v[136:137], v[18:19] op_sel_hi:[1,0]
v_pk_mul_f32 v[138:139], v[138:139], v[18:19] op_sel_hi:[1,0]
v_pk_mul_f32 v[108:109], v[108:109], v[16:17] op_sel_hi:[1,0]
v_pk_mul_f32 v[110:111], v[110:111], v[16:17] op_sel_hi:[1,0]
v_pk_mul_f32 v[140:141], v[140:141], v[18:19] op_sel_hi:[1,0]
v_pk_mul_f32 v[142:143], v[142:143], v[18:19] op_sel_hi:[1,0]
v_perm_b32 v72, v214, v210, s49
v_perm_b32 v73, v222, v218, s49
v_perm_b32 v76, v214, v210, s50
v_perm_b32 v77, v222, v218, s50
s_waitcnt vmcnt(6)
s_bitcmp1_b32 s88, 0
s_cbranch_scc0 L_ng302
s_waitcnt vmcnt(5)
L_ng302:
buffer_load_dwordx4 v[184:187], v249, s[20:23], s45 offen offset:2048 nt
v_pk_mul_f32 v[112:113], v[112:113], v[16:17] op_sel_hi:[1,0]
v_pk_mul_f32 v[114:115], v[114:115], v[16:17] op_sel_hi:[1,0]
v_pk_mul_f32 v[144:145], v[144:145], v[18:19] op_sel_hi:[1,0]
v_pk_mul_f32 v[146:147], v[146:147], v[18:19] op_sel_hi:[1,0]
v_pk_mul_f32 v[116:117], v[116:117], v[16:17] op_sel_hi:[1,0]
v_pk_mul_f32 v[118:119], v[118:119], v[16:17] op_sel_hi:[1,0]
v_pk_mul_f32 v[148:149], v[148:149], v[18:19] op_sel_hi:[1,0]
v_pk_mul_f32 v[150:151], v[150:151], v[18:19] op_sel_hi:[1,0]
v_perm_b32 v80, v215, v211, s49
v_perm_b32 v81, v223, v219, s49
v_perm_b32 v84, v215, v211, s50
v_perm_b32 v85, v223, v219, s50
s_cbranch_vccnz L_sk303
s_waitcnt vmcnt(6)
L_sk303:
buffer_load_dwordx4 v[188:191], v249, s[20:23], s45 offen offset:3072 nt
v_perm_b32 v58, v228, v224, s49
v_perm_b32 v59, v236, v232, s49
v_perm_b32 v62, v228, v224, s50
v_perm_b32 v63, v236, v232, s50
v_mfma_f32_16x16x32_bf16 v[88:91], v[56:59], a[32:35], v[88:91]
v_mfma_f32_16x16x32_bf16 v[120:123], v[56:59], a[36:39], v[120:123]
v_mfma_f32_16x16x32_bf16 v[92:95], v[60:63], a[32:35], v[92:95]
v_mfma_f32_16x16x32_bf16 v[124:127], v[60:63], a[36:39], v[124:127]
s_add_u32 s45, s45, 32768
s_waitcnt vmcnt(4)
buffer_load_dwordx4 v[192:195], v249, s[20:23], s45 offen offset:0 nt
s_barrier
v_perm_b32 v66, v229, v225, s49
v_perm_b32 v67, v237, v233, s49
v_perm_b32 v70, v229, v225, s50
v_perm_b32 v71, v237, v233, s50
v_mfma_f32_16x16x32_bf16 v[96:99], v[64:67], a[32:35], v[96:99]
v_mfma_f32_16x16x32_bf16 v[128:131], v[64:67], a[36:39], v[128:131]
v_mfma_f32_16x16x32_bf16 v[100:103], v[68:71], a[32:35], v[100:103]
v_mfma_f32_16x16x32_bf16 v[132:135], v[68:71], a[36:39], v[132:135]
s_cbranch_vccnz L_sk305
s_waitcnt vmcnt(4)
L_sk305:
buffer_load_dwordx4 v[196:199], v249, s[20:23], s45 offen offset:1024 nt
v_perm_b32 v74, v230, v226, s49
v_perm_b32 v75, v238, v234, s49
v_perm_b32 v78, v230, v226, s50
v_perm_b32 v79, v238, v234, s50
v_mfma_f32_16x16x32_bf16 v[104:107], v[72:75], a[32:35], v[104:107]
v_mfma_f32_16x16x32_bf16 v[136:139], v[72:75], a[36:39], v[136:139]
v_mfma_f32_16x16x32_bf16 v[108:111], v[76:79], a[32:35], v[108:111]
v_mfma_f32_16x16x32_bf16 v[140:143], v[76:79], a[36:39], v[140:143]
s_waitcnt vmcnt(5)
s_bitcmp1_b32 s88, 1
s_cbranch_scc1 L_sk306
s_waitcnt vmcnt(4)
L_sk306:
buffer_load_dwordx4 v[200:203], v249, s[20:23], s45 offen offset:2048 nt
v_and_b32 v241, 0xff, v10
v_lshrrev_b32 v10, 8, v10
v_cmp_le_u32 vcc, 18, v241
v_cmp_le_u32 s[90:91], 18, v10
s_nop 0
s_bcnt1_i32_b64 s88, vcc
s_bcnt1_i32_b64 s90, s[90:91]
s_add_u32 s90, s90, s88
s_add_u32 s90, s90, s43
s_cmp_ge_u32 s90, 15
s_cselect_b32 s88, 2, 0
s_cmp_le_u32 s90, 5
s_cselect_b32 s88, 1, s88
s_cmp_ge_u32 s90, 10
s_cselect_b64 vcc, -1, 0
v_perm_b32 v82, v231, v227, s49
v_perm_b32 v83, v239, v235, s49
v_perm_b32 v86, v231, v227, s50
v_perm_b32 v87, v239, v235, s50
v_mfma_f32_16x16x32_bf16 v[112:115], v[80:83], a[32:35], v[112:115]
v_mfma_f32_16x16x32_bf16 v[144:147], v[80:83], a[36:39], v[144:147]
v_mfma_f32_16x16x32_bf16 v[116:119], v[84:87], a[32:35], v[116:119]
v_mfma_f32_16x16x32_bf16 v[148:151], v[84:87], a[36:39], v[148:151]
s_waitcnt vmcnt(5)
s_cbranch_vccnz L_sk307
s_waitcnt vmcnt(4)
L_sk307:
buffer_load_dwordx4 v[204:207], v249, s[20:23], s45 offen offset:3072 nt
v_mov_b32 v16, v29
v_mov_b32 v18, v29
s_nop 1
v_permlane32_swap_b32 v16, v18
v_pk_mul_f32 v[88:89], v[88:89], v[16:17] op_sel_hi:[1,0]
v_pk_mul_f32 v[90:91], v[90:91], v[16:17] op_sel_hi:[1,0]
v_pk_mul_f32 v[120:121], v[120:121], v[18:19] op_sel_hi:[1,0]
v_pk_mul_f32 v[122:123], v[122:123], v[18:19] op_sel_hi:[1,0]
v_pk_mul_f32 v[92:93], v[92:93], v[16:17] op_sel_hi:[1,0]
v_pk_mul_f32 v[94:95], v[94:95], v[16:17] op_sel_hi:[1,0]
v_pk_mul_f32 v[124:125], v[124:125], v[18:19] op_sel_hi:[1,0]
v_pk_mul_f32 v[126:127], v[126:127], v[18:19] op_sel_hi:[1,0]
v_perm_b32 v56, v164, v160, s49
v_perm_b32 v57, v172, v168, s49
v_perm_b32 v60, v164, v160, s50
v_perm_b32 v61, v172, v168, s50
s_add_u32 s45, s45, 32768
s_waitcnt vmcnt(4)
buffer_load_dwordx4 v[208:211], v249, s[20:23], s45 offen offset:0 nt
s_barrier
v_pk_mul_f32 v[96:97], v[96:97], v[16:17] op_sel_hi:[1,0]
v_pk_mul_f32 v[98:99], v[98:99], v[16:17] op_sel_hi:[1,0]
v_pk_mul_f32 v[128:129], v[128:129], v[18:19] op_sel_hi:[1,0]
v_pk_mul_f32 v[130:131], v[130:131], v[18:19] op_sel_hi:[1,0]
v_pk_mul_f32 v[100:101], v[100:101], v[16:17] op_sel_hi:[1,0]
v_pk_mul_f32 v[102:103], v[102:103], v[16:17] op_sel_hi:[1,0]
v_pk_mul_f32 v[132:133], v[132:133], v[18:19] op_sel_hi:[1,0]
v_pk_mul_f32 v[134:135], v[134:135], v[18:19] op_sel_hi:[1,0]
v_perm_b32 v64, v165, v161, s49
v_perm_b32 v65, v173, v169, s49
v_perm_b32 v68, v165, v161, s50
v_perm_b32 v69, v173, v169, s50
s_cbranch_vccnz L_sk309
s_waitcnt vmcnt(4)
L_sk309:
buffer_load_dwordx4 v[212:215], v249, s[20:23], s45 offen offset:1024 nt
v_pk_mul_f32 v[104:105], v[104:105], v[16:17] op_sel_hi:[1,0]
v_pk_mul_f32 v[106:107], v[106:107], v[16:17] op_sel_hi:[1,0]
v_pk_mul_f32 v[136:137], v[136:137], v[18:19] op_sel_hi:[1,0]
v_pk_mul_f32 v[138:139], v[138:139], v[18:19] op_sel_hi:[1,0]
v_pk_mul_f32 v[108:109], v[108:109], v[16:17] op_sel_hi:[1,0]
v_pk_mul_f32 v[110:111], v[110:111], v[16:17] op_sel_hi:[1,0]
v_pk_mul_f32 v[140:141], v[140:141], v[18:19] op_sel_hi:[1,0]
v_pk_mul_f32 v[142:143], v[142:143], v[18:19] op_sel_hi:[1,0]
v_perm_b32 v72, v166, v162, s49
v_perm_b32 v73, v174, v170, s49
v_perm_b32 v76, v166, v162, s50
v_perm_b32 v77, v174, v170, s50
s_waitcnt vmcnt(4)
s_bitcmp1_b32 s88, 0
s_cbranch_scc0 L_ng310
s_waitcnt vmcnt(3)
L_ng310:
buffer_load_dwordx4 v[216:219], v249, s[20:23], s45 offen offset:2048 nt
v_pk_mul_f32 v[112:113], v[112:113], v[16:17] op_sel_hi:[1,0]
v_pk_mul_f32 v[114:115], v[114:115], v[16:17] op_sel_hi:[1,0]
v_pk_mul_f32 v[144:145], v[144:145], v[18:19] op_sel_hi:[1,0]
v_pk_mul_f32 v[146:147], v[146:147], v[18:19] op_sel_hi:[1,0]
v_pk_mul_f32 v[116:117], v[116:117], v[16:17] op_sel_hi:[1,0]
v_pk_mul_f32 v[118:119], v[118:119], v[16:17] op_sel_hi:[1,0]
v_pk_mul_f32 v[148:149], v[148:149], v[18:19] op_sel_hi:[1,0]
v_pk_mul_f32 v[150:151], v[150:151], v[18:19] op_sel_hi:[1,0]
v_perm_b32 v80, v167, v163, s49
v_perm_b32 v81, v175, v171, s49
v_perm_b32 v84, v167, v163, s50
v_perm_b32 v85, v175, v171, s50
s_cbranch_vccnz L_sk311
s_waitcnt vmcnt(4)
L_sk311:
buffer_load_dwordx4 v[220:223], v249, s[20:23], s45 offen offset:3072 nt
v_perm_b32 v58, v180, v176, s49
v_perm_b32 v59, v188, v184, s49
v_perm_b32 v62, v180, v176, s50
v_perm_b32 v63, v188, v184, s50
v_mfma_f32_16x16x32_bf16 v[88:91], v[56:59], a[40:43], v[88:91]
v_mfma_f32_16x16x32_bf16 v[120:123], v[56:59], a[44:47], v[120:123]
v_mfma_f32_16x16x32_bf16 v[92:95], v[60:63], a[40:43], v[92:95]
v_mfma_f32_16x16x32_bf16 v[124:127], v[60:63], a[44:47], v[124:127]
s_add_u32 s45, s45, 32768
s_waitcnt vmcnt(4)
buffer_load_dwordx4 v[224:227], v249, s[20:23], s45 offen offset:0 nt
s_barrier
v_perm_b32 v66, v181, v177, s49
v_perm_b32 v67, v189, v185, s49
v_perm_b32 v70, v181, v177, s50
v_perm_b32 v71, v189, v185, s50
v_mfma_f32_16x16x32_bf16 v[96:99], v[64:67], a[40:43], v[96:99]
v_mfma_f32_16x16x32_bf16 v[128:131], v[64:67], a[44:47], v[128:131]
v_mfma_f32_16x16x32_bf16 v[100:103], v[68:71], a[40:43], v[100:103]
v_mfma_f32_16x16x32_bf16 v[132:135], v[68:71], a[44:47], v[132:135]
s_cbranch_vccnz L_sk313
s_waitcnt vmcnt(4)
L_sk313:
buffer_load_dwordx4 v[228:231], v249, s[20:23], s45 offen offset:1024 nt
v_perm_b32 v74, v182, v178, s49
v_perm_b32 v75, v190, v186, s49
v_perm_b32 v78, v182, v178, s50
v_perm_b32 v79, v190, v186, s50
v_mfma_f32_16x16x32_bf16 v[104:107], v[72:75], a[40:43], v[104:107]
v_mfma_f32_16x16x32_bf16 v[136:139], v[72:75], a[44:47], v[136:139]
v_mfma_f32_16x16x32_bf16 v[108:111], v[76:79], a[40:43], v[108:111]
v_mfma_f32_16x16x32_bf16 v[140:143], v[76:79], a[44:47], v[140:143]
s_waitcnt vmcnt(5)
s_bitcmp1_b32 s88, 1
s_cbranch_scc1 L_sk314
s_waitcnt vmcnt(4)
L_sk314:
buffer_load_dwordx4 v[232:235], v249, s[20:23], s45 offen offset:2048 nt
v_mov_b32 v241, 19
s_mov_b64 exec, 1
buffer_store_byte v241, v22, s[36:39], s42 offen
s_mov_b64 exec, -1
buffer_load_ushort v10, v240, s[36:39], 0 offen offset:128 nt
v_perm_b32 v82, v183, v179, s49
v_perm_b32 v83, v191, v187, s49
v_perm_b32 v86, v183, v179, s50
v_perm_b32 v87, v191, v187, s50
v_mfma_f32_16x16x32_bf16 v[112:115], v[80:83], a[40:43], v[112:115]
v_mfma_f32_16x16x32_bf16 v[144:147], v[80:83], a[44:47], v[144:147]
v_mfma_f32_16x16x32_bf16 v[116:119], v[84:87], a[40:43], v[116:119]
v_mfma_f32_16x16x32_bf16 v[148:151], v[84:87], a[44:47], v[148:151]
s_waitcnt vmcnt(7)
s_cbranch_vccnz L_sk315
s_waitcnt vmcnt(6)
L_sk315:
buffer_load_dwordx4 v[236:239], v249, s[20:23], s45 offen offset:3072 nt
v_mov_b32 v16, v30
v_mov_b32 v18, v30
s_nop 1
v_permlane32_swap_b32 v16, v18
v_pk_mul_f32 v[88:89], v[88:89], v[16:17] op_sel_hi:[1,0]
v_pk_mul_f32 v[90:91], v[90:91], v[16:17] op_sel_hi:[1,0]
v_pk_mul_f32 v[120:121], v[120:121], v[18:19] op_sel_hi:[1,0]
v_pk_mul_f32 v[122:123], v[122:123], v[18:19] op_sel_hi:[1,0]
v_pk_mul_f32 v[92:93], v[92:93], v[16:17] op_sel_hi:[1,0]
v_pk_mul_f32 v[94:95], v[94:95], v[16:17] op_sel_hi:[1,0]
v_pk_mul_f32 v[124:125], v[124:125], v[18:19] op_sel_hi:[1,0]
v_pk_mul_f32 v[126:127], v[126:127], v[18:19] op_sel_hi:[1,0]
v_perm_b32 v56, v196, v192, s49
v_perm_b32 v57, v204, v200, s49
v_perm_b32 v60, v196, v192, s50
v_perm_b32 v61, v204, v200, s50
s_add_u32 s45, s45, 32768
s_waitcnt vmcnt(6)
buffer_load_dwordx4 v[160:163], v249, s[20:23], s45 offen offset:0 nt
s_barrier
v_pk_mul_f32 v[96:97], v[96:97], v[16:17] op_sel_hi:[1,0]
v_pk_mul_f32 v[98:99], v[98:99], v[16:17] op_sel_hi:[1,0]
v_pk_mul_f32 v[128:129], v[128:129], v[18:19] op_sel_hi:[1,0]
v_pk_mul_f32 v[130:131], v[130:131], v[18:19] op_sel_hi:[1,0]
v_pk_mul_f32 v[100:101], v[100:101], v[16:17] op_sel_hi:[1,0]
v_pk_mul_f32 v[102:103], v[102:103], v[16:17] op_sel_hi:[1,0]
v_pk_mul_f32 v[132:133], v[132:133], v[18:19] op_sel_hi:[1,0]
v_pk_mul_f32 v[134:135], v[134:135], v[18:19] op_sel_hi:[1,0]
v_perm_b32 v64, v197, v193, s49
v_perm_b32 v65, v205, v201, s49
v_perm_b32 v68, v197, v193, s50
v_perm_b32 v69, v205, v201, s50
s_cbranch_vccnz L_sk317
s_waitcnt vmcnt(6)
L_sk317:
buffer_load_dwordx4 v[164:167], v249, s[20:23], s45 offen offset:1024 nt
v_pk_mul_f32 v[104:105], v[104:105], v[16:17] op_sel_hi:[1,0]
v_pk_mul_f32 v[106:107], v[106:107], v[16:17] op_sel_hi:[1,0]
v_pk_mul_f32 v[136:137], v[136:137], v[18:19] op_sel_hi:[1,0]
v_pk_mul_f32 v[138:139], v[138:139], v[18:19] op_sel_hi:[1,0]
v_pk_mul_f32 v[108:109], v[108:109], v[16:17] op_sel_hi:[1,0]
v_pk_mul_f32 v[110:111], v[110:111], v[16:17] op_sel_hi:[1,0]
v_pk_mul_f32 v[140:141], v[140:141], v[18:19] op_sel_hi:[1,0]
v_pk_mul_f32 v[142:143], v[142:143], v[18:19] op_sel_hi:[1,0]
v_perm_b32 v72, v198, v194, s49
v_perm_b32 v73, v206, v202, s49
v_perm_b32 v76, v198, v194, s50
v_perm_b32 v77, v206, v202, s50
s_waitcnt vmcnt(6)
s_bitcmp1_b32 s88, 0
s_cbranch_scc0 L_ng318
s_waitcnt vmcnt(5)
L_ng318:
buffer_load_dwordx4 v[168:171], v249, s[20:23], s45 offen offset:2048 nt
v_pk_mul_f32 v[112:113], v[112:113], v[16:17] op_sel_hi:[1,0]
v_pk_mul_f32 v[114:115], v[114:115], v[16:17] op_sel_hi:[1,0]
v_pk_mul_f32 v[144:145], v[144:145], v[18:19] op_sel_hi:[1,0]
v_pk_mul_f32 v[146:147], v[146:147], v[18:19] op_sel_hi:[1,0]
v_pk_mul_f32 v[116:117], v[116:117], v[16:17] op_sel_hi:[1,0]
v_pk_mul_f32 v[118:119], v[118:119], v[16:17] op_sel_hi:[1,0]
v_pk_mul_f32 v[148:149], v[148:149], v[18:19] op_sel_hi:[1,0]
v_pk_mul_f32 v[150:151], v[150:151], v[18:19] op_sel_hi:[1,0]
v_perm_b32 v80, v199, v195, s49
v_perm_b32 v81, v207, v203, s49
v_perm_b32 v84, v199, v195, s50
v_perm_b32 v85, v207, v203, s50
s_cbranch_vccnz L_sk319
s_waitcnt vmcnt(6)
L_sk319:
buffer_load_dwordx4 v[172:175], v249, s[20:23], s45 offen offset:3072 nt
v_perm_b32 v58, v212, v208, s49
v_perm_b32 v59, v220, v216, s49
v_perm_b32 v62, v212, v208, s50
v_perm_b32 v63, v220, v216, s50
v_mfma_f32_16x16x32_bf16 v[88:91], v[56:59], a[48:51], v[88:91]
v_mfma_f32_16x16x32_bf16 v[120:123], v[56:59], a[52:55], v[120:123]
v_mfma_f32_16x16x32_bf16 v[92:95], v[60:63], a[48:51], v[92:95]
v_mfma_f32_16x16x32_bf16 v[124:127], v[60:63], a[52:55], v[124:127]
s_add_u32 s45, s45, 32768
s_waitcnt vmcnt(4)
buffer_load_dwordx4 v[176:179], v249, s[20:23], s45 offen offset:0 nt
s_barrier
v_perm_b32 v66, v213, v209, s49
v_perm_b32 v67, v221, v217, s49
v_perm_b32 v70, v213, v209, s50
v_perm_b32 v71, v221, v217, s50
v_mfma_f32_16x16x32_bf16 v[96:99], v[64:67], a[48:51], v[96:99]
v_mfma_f32_16x16x32_bf16 v[128:131], v[64:67], a[52:55], v[128:131]
v_mfma_f32_16x16x32_bf16 v[100:103], v[68:71], a[48:51], v[100:103]
v_mfma_f32_16x16x32_bf16 v[132:135], v[68:71], a[52:55], v[132:135]
s_cbranch_vccnz L_sk321
s_waitcnt vmcnt(4)
L_sk321:
buffer_load_dwordx4 v[180:183], v249, s[20:23], s45 offen offset:1024 nt
v_perm_b32 v74, v214, v210, s49
v_perm_b32 v75, v222, v218, s49
v_perm_b32 v78, v214, v210, s50
v_perm_b32 v79, v222, v218, s50
v_mfma_f32_16x16x32_bf16 v[104:107], v[72:75], a[48:51], v[104:107]
v_mfma_f32_16x16x32_bf16 v[136:139], v[72:75], a[52:55], v[136:139]
v_mfma_f32_16x16x32_bf16 v[108:111], v[76:79], a[48:51], v[108:111]
v_mfma_f32_16x16x32_bf16 v[140:143], v[76:79], a[52:55], v[140:143]
s_waitcnt vmcnt(5)
s_bitcmp1_b32 s88, 1
s_cbranch_scc1 L_sk322
s_waitcnt vmcnt(4)
L_sk322:
buffer_load_dwordx4 v[184:187], v249, s[20:23], s45 offen offset:2048 nt
v_and_b32 v241, 0xff, v10
v_lshrrev_b32 v10, 8, v10
v_cmp_le_u32 vcc, 19, v241
v_cmp_le_u32 s[90:91], 19, v10
s_nop 0
s_bcnt1_i32_b64 s88, vcc
s_bcnt1_i32_b64 s90, s[90:91]
s_add_u32 s90, s90, s88
s_add_u32 s90, s90, s43
s_cmp_ge_u32 s90, 15
s_cselect_b32 s88, 2, 0
s_cmp_le_u32 s90, 5
s_cselect_b32 s88, 1, s88
s_cmp_ge_u32 s90, 10
s_cselect_b64 vcc, -1, 0
v_perm_b32 v82, v215, v211, s49
v_perm_b32 v83, v223, v219, s49
v_perm_b32 v86, v215, v211, s50
v_perm_b32 v87, v223, v219, s50
v_mfma_f32_16x16x32_bf16 v[112:115], v[80:83], a[48:51], v[112:115]
v_mfma_f32_16x16x32_bf16 v[144:147], v[80:83], a[52:55], v[144:147]
v_mfma_f32_16x16x32_bf16 v[116:119], v[84:87], a[48:51], v[116:119]
v_mfma_f32_16x16x32_bf16 v[148:151], v[84:87], a[52:55], v[148:151]
s_waitcnt vmcnt(5)
s_cbranch_vccnz L_sk323
s_waitcnt vmcnt(4)
L_sk323:
buffer_load_dwordx4 v[188:191], v249, s[20:23], s45 offen offset:3072 nt
v_mov_b32 v16, v31
v_mov_b32 v18, v31
s_nop 1
v_permlane32_swap_b32 v16, v18
v_pk_mul_f32 v[88:89], v[88:89], v[16:17] op_sel_hi:[1,0]
v_pk_mul_f32 v[90:91], v[90:91], v[16:17] op_sel_hi:[1,0]
v_pk_mul_f32 v[120:121], v[120:121], v[18:19] op_sel_hi:[1,0]
v_pk_mul_f32 v[122:123], v[122:123], v[18:19] op_sel_hi:[1,0]
v_pk_mul_f32 v[92:93], v[92:93], v[16:17] op_sel_hi:[1,0]
v_pk_mul_f32 v[94:95], v[94:95], v[16:17] op_sel_hi:[1,0]
v_pk_mul_f32 v[124:125], v[124:125], v[18:19] op_sel_hi:[1,0]
v_pk_mul_f32 v[126:127], v[126:127], v[18:19] op_sel_hi:[1,0]
v_perm_b32 v56, v228, v224, s49
v_perm_b32 v57, v236, v232, s49
v_perm_b32 v60, v228, v224, s50
v_perm_b32 v61, v236, v232, s50
s_add_u32 s45, s45, 32768
s_waitcnt vmcnt(4)
buffer_load_dwordx4 v[192:195], v249, s[20:23], s45 offen offset:0 nt
s_barrier
v_pk_mul_f32 v[96:97], v[96:97], v[16:17] op_sel_hi:[1,0]
v_pk_mul_f32 v[98:99], v[98:99], v[16:17] op_sel_hi:[1,0]
v_pk_mul_f32 v[128:129], v[128:129], v[18:19] op_sel_hi:[1,0]
v_pk_mul_f32 v[130:131], v[130:131], v[18:19] op_sel_hi:[1,0]
v_pk_mul_f32 v[100:101], v[100:101], v[16:17] op_sel_hi:[1,0]
v_pk_mul_f32 v[102:103], v[102:103], v[16:17] op_sel_hi:[1,0]
v_pk_mul_f32 v[132:133], v[132:133], v[18:19] op_sel_hi:[1,0]
v_pk_mul_f32 v[134:135], v[134:135], v[18:19] op_sel_hi:[1,0]
v_perm_b32 v64, v229, v225, s49
v_perm_b32 v65, v237, v233, s49
v_perm_b32 v68, v229, v225, s50
v_perm_b32 v69, v237, v233, s50
s_cbranch_vccnz L_sk325
s_waitcnt vmcnt(4)
L_sk325:
buffer_load_dwordx4 v[196:199], v249, s[20:23], s45 offen offset:1024 nt
v_pk_mul_f32 v[104:105], v[104:105], v[16:17] op_sel_hi:[1,0]
v_pk_mul_f32 v[106:107], v[106:107], v[16:17] op_sel_hi:[1,0]
v_pk_mul_f32 v[136:137], v[136:137], v[18:19] op_sel_hi:[1,0]
v_pk_mul_f32 v[138:139], v[138:139], v[18:19] op_sel_hi:[1,0]
v_pk_mul_f32 v[108:109], v[108:109], v[16:17] op_sel_hi:[1,0]
v_pk_mul_f32 v[110:111], v[110:111], v[16:17] op_sel_hi:[1,0]
v_pk_mul_f32 v[140:141], v[140:141], v[18:19] op_sel_hi:[1,0]
v_pk_mul_f32 v[142:143], v[142:143], v[18:19] op_sel_hi:[1,0]
v_perm_b32 v72, v230, v226, s49
v_perm_b32 v73, v238, v234, s49
v_perm_b32 v76, v230, v226, s50
v_perm_b32 v77, v238, v234, s50
s_waitcnt vmcnt(4)
s_bitcmp1_b32 s88, 0
s_cbranch_scc0 L_ng326
s_waitcnt vmcnt(3)
L_ng326:
buffer_load_dwordx4 v[200:203], v249, s[20:23], s45 offen offset:2048 nt
v_pk_mul_f32 v[112:113], v[112:113], v[16:17] op_sel_hi:[1,0]
v_pk_mul_f32 v[114:115], v[114:115], v[16:17] op_sel_hi:[1,0]
v_pk_mul_f32 v[144:145], v[144:145], v[18:19] op_sel_hi:[1,0]
v_pk_mul_f32 v[146:147], v[146:147], v[18:19] op_sel_hi:[1,0]
v_pk_mul_f32 v[116:117], v[116:117], v[16:17] op_sel_hi:[1,0]
v_pk_mul_f32 v[118:119], v[118:119], v[16:17] op_sel_hi:[1,0]
v_pk_mul_f32 v[148:149], v[148:149], v[18:19] op_sel_hi:[1,0]
v_pk_mul_f32 v[150:151], v[150:151], v[18:19] op_sel_hi:[1,0]
v_perm_b32 v80, v231, v227, s49
v_perm_b32 v81, v239, v235, s49
v_perm_b32 v84, v231, v227, s50
v_perm_b32 v85, v239, v235, s50
s_cbranch_vccnz L_sk327
s_waitcnt vmcnt(4)
L_sk327:
buffer_load_dwordx4 v[204:207], v249, s[20:23], s45 offen offset:3072 nt
v_perm_b32 v58, v164, v160, s49
v_perm_b32 v59, v172, v168, s49
v_perm_b32 v62, v164, v160, s50
v_perm_b32 v63, v172, v168, s50
v_mfma_f32_16x16x32_bf16 v[88:91], v[56:59], a[56:59], v[88:91]
v_mfma_f32_16x16x32_bf16 v[120:123], v[56:59], a[60:63], v[120:123]
v_mfma_f32_16x16x32_bf16 v[92:95], v[60:63], a[56:59], v[92:95]
v_mfma_f32_16x16x32_bf16 v[124:127], v[60:63], a[60:63], v[124:127]
s_add_u32 s45, s45, 32768
s_waitcnt vmcnt(4)
buffer_load_dwordx4 v[208:211], v249, s[20:23], s45 offen offset:0 nt
s_barrier
v_perm_b32 v66, v165, v161, s49
v_perm_b32 v67, v173, v169, s49
v_perm_b32 v70, v165, v161, s50
v_perm_b32 v71, v173, v169, s50
v_mfma_f32_16x16x32_bf16 v[96:99], v[64:67], a[56:59], v[96:99]
v_mfma_f32_16x16x32_bf16 v[128:131], v[64:67], a[60:63], v[128:131]
v_mfma_f32_16x16x32_bf16 v[100:103], v[68:71], a[56:59], v[100:103]
v_mfma_f32_16x16x32_bf16 v[132:135], v[68:71], a[60:63], v[132:135]
s_cbranch_vccnz L_sk329
s_waitcnt vmcnt(4)
L_sk329:
buffer_load_dwordx4 v[212:215], v249, s[20:23], s45 offen offset:1024 nt
v_perm_b32 v74, v166, v162, s49
v_perm_b32 v75, v174, v170, s49
v_perm_b32 v78, v166, v162, s50
v_perm_b32 v79, v174, v170, s50
v_mfma_f32_16x16x32_bf16 v[104:107], v[72:75], a[56:59], v[104:107]
v_mfma_f32_16x16x32_bf16 v[136:139], v[72:75], a[60:63], v[136:139]
v_mfma_f32_16x16x32_bf16 v[108:111], v[76:79], a[56:59], v[108:111]
v_mfma_f32_16x16x32_bf16 v[140:143], v[76:79], a[60:63], v[140:143]
s_waitcnt vmcnt(5)
s_bitcmp1_b32 s88, 1
s_cbranch_scc1 L_sk330
s_waitcnt vmcnt(4)
L_sk330:
buffer_load_dwordx4 v[216:219], v249, s[20:23], s45 offen offset:2048 nt
v_mov_b32 v241, 20
s_mov_b64 exec, 1
buffer_store_byte v241, v22, s[36:39], s42 offen
s_mov_b64 exec, -1
buffer_load_ushort v10, v240, s[36:39], 0 offen offset:128 nt
v_perm_b32 v82, v167, v163, s49
v_perm_b32 v83, v175, v171, s49
v_perm_b32 v86, v167, v163, s50
v_perm_b32 v87, v175, v171, s50
v_mfma_f32_16x16x32_bf16 v[112:115], v[80:83], a[56:59], v[112:115]
v_mfma_f32_16x16x32_bf16 v[144:147], v[80:83], a[60:63], v[144:147]
v_mfma_f32_16x16x32_bf16 v[116:119], v[84:87], a[56:59], v[116:119]
v_mfma_f32_16x16x32_bf16 v[148:151], v[84:87], a[60:63], v[148:151]
s_waitcnt vmcnt(7)
s_cbranch_vccnz L_sk331
s_waitcnt vmcnt(6)
L_sk331:
buffer_load_dwordx4 v[220:223], v249, s[20:23], s45 offen offset:3072 nt
v_mov_b32 v16, v32
v_mov_b32 v18, v32
s_nop 1
v_permlane32_swap_b32 v16, v18
v_pk_mul_f32 v[88:89], v[88:89], v[16:17] op_sel_hi:[1,0]
v_pk_mul_f32 v[90:91], v[90:91], v[16:17] op_sel_hi:[1,0]
v_pk_mul_f32 v[120:121], v[120:121], v[18:19] op_sel_hi:[1,0]
v_pk_mul_f32 v[122:123], v[122:123], v[18:19] op_sel_hi:[1,0]
v_pk_mul_f32 v[92:93], v[92:93], v[16:17] op_sel_hi:[1,0]
v_pk_mul_f32 v[94:95], v[94:95], v[16:17] op_sel_hi:[1,0]
v_pk_mul_f32 v[124:125], v[124:125], v[18:19] op_sel_hi:[1,0]
v_pk_mul_f32 v[126:127], v[126:127], v[18:19] op_sel_hi:[1,0]
v_perm_b32 v56, v180, v176, s49
v_perm_b32 v57, v188, v184, s49
v_perm_b32 v60, v180, v176, s50
v_perm_b32 v61, v188, v184, s50
s_add_u32 s45, s45, 32768
s_waitcnt vmcnt(6)
buffer_load_dwordx4 v[224:227], v249, s[20:23], s45 offen offset:0 nt
s_barrier
v_pk_mul_f32 v[96:97], v[96:97], v[16:17] op_sel_hi:[1,0]
v_pk_mul_f32 v[98:99], v[98:99], v[16:17] op_sel_hi:[1,0]
v_pk_mul_f32 v[128:129], v[128:129], v[18:19] op_sel_hi:[1,0]
v_pk_mul_f32 v[130:131], v[130:131], v[18:19] op_sel_hi:[1,0]
v_pk_mul_f32 v[100:101], v[100:101], v[16:17] op_sel_hi:[1,0]
v_pk_mul_f32 v[102:103], v[102:103], v[16:17] op_sel_hi:[1,0]
v_pk_mul_f32 v[132:133], v[132:133], v[18:19] op_sel_hi:[1,0]
v_pk_mul_f32 v[134:135], v[134:135], v[18:19] op_sel_hi:[1,0]
v_perm_b32 v64, v181, v177, s49
v_perm_b32 v65, v189, v185, s49
v_perm_b32 v68, v181, v177, s50
v_perm_b32 v69, v189, v185, s50
s_cbranch_vccnz L_sk333
s_waitcnt vmcnt(6)
L_sk333:
buffer_load_dwordx4 v[228:231], v249, s[20:23], s45 offen offset:1024 nt
v_pk_mul_f32 v[104:105], v[104:105], v[16:17] op_sel_hi:[1,0]
v_pk_mul_f32 v[106:107], v[106:107], v[16:17] op_sel_hi:[1,0]
v_pk_mul_f32 v[136:137], v[136:137], v[18:19] op_sel_hi:[1,0]
v_pk_mul_f32 v[138:139], v[138:139], v[18:19] op_sel_hi:[1,0]
v_pk_mul_f32 v[108:109], v[108:109], v[16:17] op_sel_hi:[1,0]
v_pk_mul_f32 v[110:111], v[110:111], v[16:17] op_sel_hi:[1,0]
v_pk_mul_f32 v[140:141], v[140:141], v[18:19] op_sel_hi:[1,0]
v_pk_mul_f32 v[142:143], v[142:143], v[18:19] op_sel_hi:[1,0]
v_perm_b32 v72, v182, v178, s49
v_perm_b32 v73, v190, v186, s49
v_perm_b32 v76, v182, v178, s50
v_perm_b32 v77, v190, v186, s50
s_waitcnt vmcnt(6)
s_bitcmp1_b32 s88, 0
s_cbranch_scc0 L_ng334
s_waitcnt vmcnt(5)
L_ng334:
buffer_load_dwordx4 v[232:235], v249, s[20:23], s45 offen offset:2048 nt
v_pk_mul_f32 v[112:113], v[112:113], v[16:17] op_sel_hi:[1,0]
v_pk_mul_f32 v[114:115], v[114:115], v[16:17] op_sel_hi:[1,0]
v_pk_mul_f32 v[144:145], v[144:145], v[18:19] op_sel_hi:[1,0]
v_pk_mul_f32 v[146:147], v[146:147], v[18:19] op_sel_hi:[1,0]
v_pk_mul_f32 v[116:117], v[116:117], v[16:17] op_sel_hi:[1,0]
v_pk_mul_f32 v[118:119], v[118:119], v[16:17] op_sel_hi:[1,0]
v_pk_mul_f32 v[148:149], v[148:149], v[18:19] op_sel_hi:[1,0]
v_pk_mul_f32 v[150:151], v[150:151], v[18:19] op_sel_hi:[1,0]
v_perm_b32 v80, v183, v179, s49
v_perm_b32 v81, v191, v187, s49
v_perm_b32 v84, v183, v179, s50
v_perm_b32 v85, v191, v187, s50
s_cbranch_vccnz L_sk335
s_waitcnt vmcnt(6)
L_sk335:
buffer_load_dwordx4 v[236:239], v249, s[20:23], s45 offen offset:3072 nt
v_perm_b32 v58, v196, v192, s49
v_perm_b32 v59, v204, v200, s49
v_perm_b32 v62, v196, v192, s50
v_perm_b32 v63, v204, v200, s50
v_mfma_f32_16x16x32_bf16 v[88:91], v[56:59], a[64:67], v[88:91]
v_mfma_f32_16x16x32_bf16 v[120:123], v[56:59], a[68:71], v[120:123]
v_mfma_f32_16x16x32_bf16 v[92:95], v[60:63], a[64:67], v[92:95]
v_mfma_f32_16x16x32_bf16 v[124:127], v[60:63], a[68:71], v[124:127]
s_add_u32 s45, s45, 32768
s_waitcnt vmcnt(4)
buffer_load_dwordx4 v[160:163], v249, s[20:23], s45 offen offset:0 nt
s_barrier
v_perm_b32 v66, v197, v193, s49
v_perm_b32 v67, v205, v201, s49
v_perm_b32 v70, v197, v193, s50
v_perm_b32 v71, v205, v201, s50
v_mfma_f32_16x16x32_bf16 v[96:99], v[64:67], a[64:67], v[96:99]
v_mfma_f32_16x16x32_bf16 v[128:131], v[64:67], a[68:71], v[128:131]
v_mfma_f32_16x16x32_bf16 v[100:103], v[68:71], a[64:67], v[100:103]
v_mfma_f32_16x16x32_bf16 v[132:135], v[68:71], a[68:71], v[132:135]
s_cbranch_vccnz L_sk337
s_waitcnt vmcnt(4)
L_sk337:
buffer_load_dwordx4 v[164:167], v249, s[20:23], s45 offen offset:1024 nt
v_perm_b32 v74, v198, v194, s49
v_perm_b32 v75, v206, v202, s49
v_perm_b32 v78, v198, v194, s50
v_perm_b32 v79, v206, v202, s50
v_mfma_f32_16x16x32_bf16 v[104:107], v[72:75], a[64:67], v[104:107]
v_mfma_f32_16x16x32_bf16 v[136:139], v[72:75], a[68:71], v[136:139]
v_mfma_f32_16x16x32_bf16 v[108:111], v[76:79], a[64:67], v[108:111]
v_mfma_f32_16x16x32_bf16 v[140:143], v[76:79], a[68:71], v[140:143]
s_waitcnt vmcnt(5)
s_bitcmp1_b32 s88, 1
s_cbranch_scc1 L_sk338
s_waitcnt vmcnt(4)
L_sk338:
buffer_load_dwordx4 v[168:171], v249, s[20:23], s45 offen offset:2048 nt
v_and_b32 v241, 0xff, v10
v_lshrrev_b32 v10, 8, v10
v_cmp_le_u32 vcc, 20, v241
v_cmp_le_u32 s[90:91], 20, v10
s_nop 0
s_bcnt1_i32_b64 s88, vcc
s_bcnt1_i32_b64 s90, s[90:91]
s_add_u32 s90, s90, s88
s_add_u32 s90, s90, s43
s_cmp_ge_u32 s90, 15
s_cselect_b32 s88, 2, 0
s_cmp_le_u32 s90, 5
s_cselect_b32 s88, 1, s88
s_cmp_ge_u32 s90, 10
s_cselect_b64 vcc, -1, 0
v_perm_b32 v82, v199, v195, s49
v_perm_b32 v83, v207, v203, s49
v_perm_b32 v86, v199, v195, s50
v_perm_b32 v87, v207, v203, s50
v_mfma_f32_16x16x32_bf16 v[112:115], v[80:83], a[64:67], v[112:115]
v_mfma_f32_16x16x32_bf16 v[144:147], v[80:83], a[68:71], v[144:147]
v_mfma_f32_16x16x32_bf16 v[116:119], v[84:87], a[64:67], v[116:119]
v_mfma_f32_16x16x32_bf16 v[148:151], v[84:87], a[68:71], v[148:151]
s_waitcnt vmcnt(5)
s_cbranch_vccnz L_sk339
s_waitcnt vmcnt(4)
L_sk339:
buffer_load_dwordx4 v[172:175], v249, s[20:23], s45 offen offset:3072 nt
v_mov_b32 v16, v33
v_mov_b32 v18, v33
s_nop 1
v_permlane32_swap_b32 v16, v18
v_pk_mul_f32 v[88:89], v[88:89], v[16:17] op_sel_hi:[1,0]
v_pk_mul_f32 v[90:91], v[90:91], v[16:17] op_sel_hi:[1,0]
v_pk_mul_f32 v[120:121], v[120:121], v[18:19] op_sel_hi:[1,0]
v_pk_mul_f32 v[122:123], v[122:123], v[18:19] op_sel_hi:[1,0]
v_pk_mul_f32 v[92:93], v[92:93], v[16:17] op_sel_hi:[1,0]
v_pk_mul_f32 v[94:95], v[94:95], v[16:17] op_sel_hi:[1,0]
v_pk_mul_f32 v[124:125], v[124:125], v[18:19] op_sel_hi:[1,0]
v_pk_mul_f32 v[126:127], v[126:127], v[18:19] op_sel_hi:[1,0]
v_perm_b32 v56, v212, v208, s49
v_perm_b32 v57, v220, v216, s49
v_perm_b32 v60, v212, v208, s50
v_perm_b32 v61, v220, v216, s50
s_add_u32 s45, s45, 32768
s_waitcnt vmcnt(4)
buffer_load_dwordx4 v[176:179], v249, s[20:23], s45 offen offset:0 nt
s_barrier
v_pk_mul_f32 v[96:97], v[96:97], v[16:17] op_sel_hi:[1,0]
v_pk_mul_f32 v[98:99], v[98:99], v[16:17] op_sel_hi:[1,0]
v_pk_mul_f32 v[128:129], v[128:129], v[18:19] op_sel_hi:[1,0]
v_pk_mul_f32 v[130:131], v[130:131], v[18:19] op_sel_hi:[1,0]
v_pk_mul_f32 v[100:101], v[100:101], v[16:17] op_sel_hi:[1,0]
v_pk_mul_f32 v[102:103], v[102:103], v[16:17] op_sel_hi:[1,0]
v_pk_mul_f32 v[132:133], v[132:133], v[18:19] op_sel_hi:[1,0]
v_pk_mul_f32 v[134:135], v[134:135], v[18:19] op_sel_hi:[1,0]
v_perm_b32 v64, v213, v209, s49
v_perm_b32 v65, v221, v217, s49
v_perm_b32 v68, v213, v209, s50
v_perm_b32 v69, v221, v217, s50
s_cbranch_vccnz L_sk341
s_waitcnt vmcnt(4)
L_sk341:
buffer_load_dwordx4 v[180:183], v249, s[20:23], s45 offen offset:1024 nt
v_pk_mul_f32 v[104:105], v[104:105], v[16:17] op_sel_hi:[1,0]
v_pk_mul_f32 v[106:107], v[106:107], v[16:17] op_sel_hi:[1,0]
v_pk_mul_f32 v[136:137], v[136:137], v[18:19] op_sel_hi:[1,0]
v_pk_mul_f32 v[138:139], v[138:139], v[18:19] op_sel_hi:[1,0]
v_pk_mul_f32 v[108:109], v[108:109], v[16:17] op_sel_hi:[1,0]
v_pk_mul_f32 v[110:111], v[110:111], v[16:17] op_sel_hi:[1,0]
v_pk_mul_f32 v[140:141], v[140:141], v[18:19] op_sel_hi:[1,0]
v_pk_mul_f32 v[142:143], v[142:143], v[18:19] op_sel_hi:[1,0]
v_perm_b32 v72, v214, v210, s49
v_perm_b32 v73, v222, v218, s49
v_perm_b32 v76, v214, v210, s50
v_perm_b32 v77, v222, v218, s50
s_waitcnt vmcnt(4)
s_bitcmp1_b32 s88, 0
s_cbranch_scc0 L_ng342
s_waitcnt vmcnt(3)
L_ng342:
buffer_load_dwordx4 v[184:187], v249, s[20:23], s45 offen offset:2048 nt
v_pk_mul_f32 v[112:113], v[112:113], v[16:17] op_sel_hi:[1,0]
v_pk_mul_f32 v[114:115], v[114:115], v[16:17] op_sel_hi:[1,0]
v_pk_mul_f32 v[144:145], v[144:145], v[18:19] op_sel_hi:[1,0]
v_pk_mul_f32 v[146:147], v[146:147], v[18:19] op_sel_hi:[1,0]
v_pk_mul_f32 v[116:117], v[116:117], v[16:17] op_sel_hi:[1,0]
v_pk_mul_f32 v[118:119], v[118:119], v[16:17] op_sel_hi:[1,0]
v_pk_mul_f32 v[148:149], v[148:149], v[18:19] op_sel_hi:[1,0]
v_pk_mul_f32 v[150:151], v[150:151], v[18:19] op_sel_hi:[1,0]
v_perm_b32 v80, v215, v211, s49
v_perm_b32 v81, v223, v219, s49
v_perm_b32 v84, v215, v211, s50
v_perm_b32 v85, v223, v219, s50
s_cbranch_vccnz L_sk343
s_waitcnt vmcnt(4)
L_sk343:
buffer_load_dwordx4 v[188:191], v249, s[20:23], s45 offen offset:3072 nt
v_perm_b32 v58, v228, v224, s49
v_perm_b32 v59, v236, v232, s49
v_perm_b32 v62, v228, v224, s50
v_perm_b32 v63, v236, v232, s50
v_mfma_f32_16x16x32_bf16 v[88:91], v[56:59], a[72:75], v[88:91]
v_mfma_f32_16x16x32_bf16 v[120:123], v[56:59], a[76:79], v[120:123]
v_mfma_f32_16x16x32_bf16 v[92:95], v[60:63], a[72:75], v[92:95]
v_mfma_f32_16x16x32_bf16 v[124:127], v[60:63], a[76:79], v[124:127]
s_add_u32 s45, s45, 32768
s_waitcnt vmcnt(4)
buffer_load_dwordx4 v[192:195], v249, s[20:23], s45 offen offset:0 nt
s_barrier
v_perm_b32 v66, v229, v225, s49
v_perm_b32 v67, v237, v233, s49
v_perm_b32 v70, v229, v225, s50
v_perm_b32 v71, v237, v233, s50
v_mfma_f32_16x16x32_bf16 v[96:99], v[64:67], a[72:75], v[96:99]
v_mfma_f32_16x16x32_bf16 v[128:131], v[64:67], a[76:79], v[128:131]
v_mfma_f32_16x16x32_bf16 v[100:103], v[68:71], a[72:75], v[100:103]
v_mfma_f32_16x16x32_bf16 v[132:135], v[68:71], a[76:79], v[132:135]
s_cbranch_vccnz L_sk345
s_waitcnt vmcnt(4)
L_sk345:
buffer_load_dwordx4 v[196:199], v249, s[20:23], s45 offen offset:1024 nt
v_perm_b32 v74, v230, v226, s49
v_perm_b32 v75, v238, v234, s49
v_perm_b32 v78, v230, v226, s50
v_perm_b32 v79, v238, v234, s50
v_mfma_f32_16x16x32_bf16 v[104:107], v[72:75], a[72:75], v[104:107]
v_mfma_f32_16x16x32_bf16 v[136:139], v[72:75], a[76:79], v[136:139]
v_mfma_f32_16x16x32_bf16 v[108:111], v[76:79], a[72:75], v[108:111]
v_mfma_f32_16x16x32_bf16 v[140:143], v[76:79], a[76:79], v[140:143]
s_waitcnt vmcnt(5)
s_bitcmp1_b32 s88, 1
s_cbranch_scc1 L_sk346
s_waitcnt vmcnt(4)
L_sk346:
buffer_load_dwordx4 v[200:203], v249, s[20:23], s45 offen offset:2048 nt
v_mov_b32 v241, 21
s_mov_b64 exec, 1
buffer_store_byte v241, v22, s[36:39], s42 offen
s_mov_b64 exec, -1
buffer_load_ushort v10, v240, s[36:39], 0 offen offset:128 nt
v_perm_b32 v82, v231, v227, s49
v_perm_b32 v83, v239, v235, s49
v_perm_b32 v86, v231, v227, s50
v_perm_b32 v87, v239, v235, s50
v_mfma_f32_16x16x32_bf16 v[112:115], v[80:83], a[72:75], v[112:115]
v_mfma_f32_16x16x32_bf16 v[144:147], v[80:83], a[76:79], v[144:147]
v_mfma_f32_16x16x32_bf16 v[116:119], v[84:87], a[72:75], v[116:119]
v_mfma_f32_16x16x32_bf16 v[148:151], v[84:87], a[76:79], v[148:151]
s_waitcnt vmcnt(7)
s_cbranch_vccnz L_sk347
s_waitcnt vmcnt(6)
L_sk347:
buffer_load_dwordx4 v[204:207], v249, s[20:23], s45 offen offset:3072 nt
v_mov_b32 v16, v34
v_mov_b32 v18, v34
s_nop 1
v_permlane32_swap_b32 v16, v18
v_pk_mul_f32 v[88:89], v[88:89], v[16:17] op_sel_hi:[1,0]
v_pk_mul_f32 v[90:91], v[90:91], v[16:17] op_sel_hi:[1,0]
v_pk_mul_f32 v[120:121], v[120:121], v[18:19] op_sel_hi:[1,0]
v_pk_mul_f32 v[122:123], v[122:123], v[18:19] op_sel_hi:[1,0]
v_pk_mul_f32 v[92:93], v[92:93], v[16:17] op_sel_hi:[1,0]
v_pk_mul_f32 v[94:95], v[94:95], v[16:17] op_sel_hi:[1,0]
v_pk_mul_f32 v[124:125], v[124:125], v[18:19] op_sel_hi:[1,0]
v_pk_mul_f32 v[126:127], v[126:127], v[18:19] op_sel_hi:[1,0]
v_perm_b32 v56, v164, v160, s49
v_perm_b32 v57, v172, v168, s49
v_perm_b32 v60, v164, v160, s50
v_perm_b32 v61, v172, v168, s50
s_add_u32 s45, s45, 32768
s_waitcnt vmcnt(6)
buffer_load_dwordx4 v[208:211], v249, s[20:23], s45 offen offset:0 nt
s_barrier
v_pk_mul_f32 v[96:97], v[96:97], v[16:17] op_sel_hi:[1,0]
v_pk_mul_f32 v[98:99], v[98:99], v[16:17] op_sel_hi:[1,0]
v_pk_mul_f32 v[128:129], v[128:129], v[18:19] op_sel_hi:[1,0]
v_pk_mul_f32 v[130:131], v[130:131], v[18:19] op_sel_hi:[1,0]
v_pk_mul_f32 v[100:101], v[100:101], v[16:17] op_sel_hi:[1,0]
v_pk_mul_f32 v[102:103], v[102:103], v[16:17] op_sel_hi:[1,0]
v_pk_mul_f32 v[132:133], v[132:133], v[18:19] op_sel_hi:[1,0]
v_pk_mul_f32 v[134:135], v[134:135], v[18:19] op_sel_hi:[1,0]
v_perm_b32 v64, v165, v161, s49
v_perm_b32 v65, v173, v169, s49
v_perm_b32 v68, v165, v161, s50
v_perm_b32 v69, v173, v169, s50
s_cbranch_vccnz L_sk349
s_waitcnt vmcnt(6)
L_sk349:
buffer_load_dwordx4 v[212:215], v249, s[20:23], s45 offen offset:1024 nt
v_pk_mul_f32 v[104:105], v[104:105], v[16:17] op_sel_hi:[1,0]
v_pk_mul_f32 v[106:107], v[106:107], v[16:17] op_sel_hi:[1,0]
v_pk_mul_f32 v[136:137], v[136:137], v[18:19] op_sel_hi:[1,0]
v_pk_mul_f32 v[138:139], v[138:139], v[18:19] op_sel_hi:[1,0]
v_pk_mul_f32 v[108:109], v[108:109], v[16:17] op_sel_hi:[1,0]
v_pk_mul_f32 v[110:111], v[110:111], v[16:17] op_sel_hi:[1,0]
v_pk_mul_f32 v[140:141], v[140:141], v[18:19] op_sel_hi:[1,0]
v_pk_mul_f32 v[142:143], v[142:143], v[18:19] op_sel_hi:[1,0]
v_perm_b32 v72, v166, v162, s49
v_perm_b32 v73, v174, v170, s49
v_perm_b32 v76, v166, v162, s50
v_perm_b32 v77, v174, v170, s50
s_waitcnt vmcnt(6)
s_bitcmp1_b32 s88, 0
s_cbranch_scc0 L_ng350
s_waitcnt vmcnt(5)
L_ng350:
buffer_load_dwordx4 v[216:219], v249, s[20:23], s45 offen offset:2048 nt
v_pk_mul_f32 v[112:113], v[112:113], v[16:17] op_sel_hi:[1,0]
v_pk_mul_f32 v[114:115], v[114:115], v[16:17] op_sel_hi:[1,0]
v_pk_mul_f32 v[144:145], v[144:145], v[18:19] op_sel_hi:[1,0]
v_pk_mul_f32 v[146:147], v[146:147], v[18:19] op_sel_hi:[1,0]
v_pk_mul_f32 v[116:117], v[116:117], v[16:17] op_sel_hi:[1,0]
v_pk_mul_f32 v[118:119], v[118:119], v[16:17] op_sel_hi:[1,0]
v_pk_mul_f32 v[148:149], v[148:149], v[18:19] op_sel_hi:[1,0]
v_pk_mul_f32 v[150:151], v[150:151], v[18:19] op_sel_hi:[1,0]
v_perm_b32 v80, v167, v163, s49
v_perm_b32 v81, v175, v171, s49
v_perm_b32 v84, v167, v163, s50
v_perm_b32 v85, v175, v171, s50
s_cbranch_vccnz L_sk351
s_waitcnt vmcnt(6)
L_sk351:
buffer_load_dwordx4 v[220:223], v249, s[20:23], s45 offen offset:3072 nt
v_perm_b32 v58, v180, v176, s49
v_perm_b32 v59, v188, v184, s49
v_perm_b32 v62, v180, v176, s50
v_perm_b32 v63, v188, v184, s50
v_mfma_f32_16x16x32_bf16 v[88:91], v[56:59], a[80:83], v[88:91]
v_mfma_f32_16x16x32_bf16 v[120:123], v[56:59], a[84:87], v[120:123]
v_mfma_f32_16x16x32_bf16 v[92:95], v[60:63], a[80:83], v[92:95]
v_mfma_f32_16x16x32_bf16 v[124:127], v[60:63], a[84:87], v[124:127]
s_add_u32 s45, s45, 32768
s_waitcnt vmcnt(4)
buffer_load_dwordx4 v[224:227], v249, s[20:23], s45 offen offset:0 nt
s_barrier
v_perm_b32 v66, v181, v177, s49
v_perm_b32 v67, v189, v185, s49
v_perm_b32 v70, v181, v177, s50
v_perm_b32 v71, v189, v185, s50
v_mfma_f32_16x16x32_bf16 v[96:99], v[64:67], a[80:83], v[96:99]
v_mfma_f32_16x16x32_bf16 v[128:131], v[64:67], a[84:87], v[128:131]
v_mfma_f32_16x16x32_bf16 v[100:103], v[68:71], a[80:83], v[100:103]
v_mfma_f32_16x16x32_bf16 v[132:135], v[68:71], a[84:87], v[132:135]
s_cbranch_vccnz L_sk353
s_waitcnt vmcnt(4)
L_sk353:
buffer_load_dwordx4 v[228:231], v249, s[20:23], s45 offen offset:1024 nt
v_perm_b32 v74, v182, v178, s49
v_perm_b32 v75, v190, v186, s49
v_perm_b32 v78, v182, v178, s50
v_perm_b32 v79, v190, v186, s50
v_mfma_f32_16x16x32_bf16 v[104:107], v[72:75], a[80:83], v[104:107]
v_mfma_f32_16x16x32_bf16 v[136:139], v[72:75], a[84:87], v[136:139]
v_mfma_f32_16x16x32_bf16 v[108:111], v[76:79], a[80:83], v[108:111]
v_mfma_f32_16x16x32_bf16 v[140:143], v[76:79], a[84:87], v[140:143]
s_waitcnt vmcnt(5)
s_bitcmp1_b32 s88, 1
s_cbranch_scc1 L_sk354
s_waitcnt vmcnt(4)
L_sk354:
buffer_load_dwordx4 v[232:235], v249, s[20:23], s45 offen offset:2048 nt
v_and_b32 v241, 0xff, v10
v_lshrrev_b32 v10, 8, v10
v_cmp_le_u32 vcc, 21, v241
v_cmp_le_u32 s[90:91], 21, v10
s_nop 0
s_bcnt1_i32_b64 s88, vcc
s_bcnt1_i32_b64 s90, s[90:91]
s_add_u32 s90, s90, s88
s_add_u32 s90, s90, s43
s_cmp_ge_u32 s90, 15
s_cselect_b32 s88, 2, 0
s_cmp_le_u32 s90, 5
s_cselect_b32 s88, 1, s88
s_cmp_ge_u32 s90, 10
s_cselect_b64 vcc, -1, 0
v_perm_b32 v82, v183, v179, s49
v_perm_b32 v83, v191, v187, s49
v_perm_b32 v86, v183, v179, s50
v_perm_b32 v87, v191, v187, s50
v_mfma_f32_16x16x32_bf16 v[112:115], v[80:83], a[80:83], v[112:115]
v_mfma_f32_16x16x32_bf16 v[144:147], v[80:83], a[84:87], v[144:147]
v_mfma_f32_16x16x32_bf16 v[116:119], v[84:87], a[80:83], v[116:119]
v_mfma_f32_16x16x32_bf16 v[148:151], v[84:87], a[84:87], v[148:151]
s_waitcnt vmcnt(5)
s_cbranch_vccnz L_sk355
s_waitcnt vmcnt(4)
L_sk355:
buffer_load_dwordx4 v[236:239], v249, s[20:23], s45 offen offset:3072 nt
v_mov_b32 v16, v35
v_mov_b32 v18, v35
s_nop 1
v_permlane32_swap_b32 v16, v18
v_pk_mul_f32 v[88:89], v[88:89], v[16:17] op_sel_hi:[1,0]
v_pk_mul_f32 v[90:91], v[90:91], v[16:17] op_sel_hi:[1,0]
v_pk_mul_f32 v[120:121], v[120:121], v[18:19] op_sel_hi:[1,0]
v_pk_mul_f32 v[122:123], v[122:123], v[18:19] op_sel_hi:[1,0]
v_pk_mul_f32 v[92:93], v[92:93], v[16:17] op_sel_hi:[1,0]
v_pk_mul_f32 v[94:95], v[94:95], v[16:17] op_sel_hi:[1,0]
v_pk_mul_f32 v[124:125], v[124:125], v[18:19] op_sel_hi:[1,0]
v_pk_mul_f32 v[126:127], v[126:127], v[18:19] op_sel_hi:[1,0]
v_perm_b32 v56, v196, v192, s49
v_perm_b32 v57, v204, v200, s49
v_perm_b32 v60, v196, v192, s50
v_perm_b32 v61, v204, v200, s50
s_add_u32 s45, s45, 32768
s_waitcnt vmcnt(4)
buffer_load_dwordx4 v[160:163], v249, s[20:23], s45 offen offset:0 nt
s_barrier
v_pk_mul_f32 v[96:97], v[96:97], v[16:17] op_sel_hi:[1,0]
v_pk_mul_f32 v[98:99], v[98:99], v[16:17] op_sel_hi:[1,0]
v_pk_mul_f32 v[128:129], v[128:129], v[18:19] op_sel_hi:[1,0]
v_pk_mul_f32 v[130:131], v[130:131], v[18:19] op_sel_hi:[1,0]
v_pk_mul_f32 v[100:101], v[100:101], v[16:17] op_sel_hi:[1,0]
v_pk_mul_f32 v[102:103], v[102:103], v[16:17] op_sel_hi:[1,0]
v_pk_mul_f32 v[132:133], v[132:133], v[18:19] op_sel_hi:[1,0]
v_pk_mul_f32 v[134:135], v[134:135], v[18:19] op_sel_hi:[1,0]
v_perm_b32 v64, v197, v193, s49
v_perm_b32 v65, v205, v201, s49
v_perm_b32 v68, v197, v193, s50
v_perm_b32 v69, v205, v201, s50
s_cbranch_vccnz L_sk357
s_waitcnt vmcnt(4)
L_sk357:
buffer_load_dwordx4 v[164:167], v249, s[20:23], s45 offen offset:1024 nt
v_pk_mul_f32 v[104:105], v[104:105], v[16:17] op_sel_hi:[1,0]
v_pk_mul_f32 v[106:107], v[106:107], v[16:17] op_sel_hi:[1,0]
v_pk_mul_f32 v[136:137], v[136:137], v[18:19] op_sel_hi:[1,0]
v_pk_mul_f32 v[138:139], v[138:139], v[18:19] op_sel_hi:[1,0]
v_pk_mul_f32 v[108:109], v[108:109], v[16:17] op_sel_hi:[1,0]
v_pk_mul_f32 v[110:111], v[110:111], v[16:17] op_sel_hi:[1,0]
v_pk_mul_f32 v[140:141], v[140:141], v[18:19] op_sel_hi:[1,0]
v_pk_mul_f32 v[142:143], v[142:143], v[18:19] op_sel_hi:[1,0]
v_perm_b32 v72, v198, v194, s49
v_perm_b32 v73, v206, v202, s49
v_perm_b32 v76, v198, v194, s50
v_perm_b32 v77, v206, v202, s50
s_waitcnt vmcnt(4)
s_bitcmp1_b32 s88, 0
s_cbranch_scc0 L_ng358
s_waitcnt vmcnt(3)
L_ng358:
buffer_load_dwordx4 v[168:171], v249, s[20:23], s45 offen offset:2048 nt
v_pk_mul_f32 v[112:113], v[112:113], v[16:17] op_sel_hi:[1,0]
v_pk_mul_f32 v[114:115], v[114:115], v[16:17] op_sel_hi:[1,0]
v_pk_mul_f32 v[144:145], v[144:145], v[18:19] op_sel_hi:[1,0]
v_pk_mul_f32 v[146:147], v[146:147], v[18:19] op_sel_hi:[1,0]
v_pk_mul_f32 v[116:117], v[116:117], v[16:17] op_sel_hi:[1,0]
v_pk_mul_f32 v[118:119], v[118:119], v[16:17] op_sel_hi:[1,0]
v_pk_mul_f32 v[148:149], v[148:149], v[18:19] op_sel_hi:[1,0]
v_pk_mul_f32 v[150:151], v[150:151], v[18:19] op_sel_hi:[1,0]
v_perm_b32 v80, v199, v195, s49
v_perm_b32 v81, v207, v203, s49
v_perm_b32 v84, v199, v195, s50
v_perm_b32 v85, v207, v203, s50
s_cbranch_vccnz L_sk359
s_waitcnt vmcnt(4)
L_sk359:
buffer_load_dwordx4 v[172:175], v249, s[20:23], s45 offen offset:3072 nt
v_perm_b32 v58, v212, v208, s49
v_perm_b32 v59, v220, v216, s49
v_perm_b32 v62, v212, v208, s50
v_perm_b32 v63, v220, v216, s50
v_mfma_f32_16x16x32_bf16 v[88:91], v[56:59], a[88:91], v[88:91]
v_mfma_f32_16x16x32_bf16 v[120:123], v[56:59], a[92:95], v[120:123]
v_mfma_f32_16x16x32_bf16 v[92:95], v[60:63], a[88:91], v[92:95]
v_mfma_f32_16x16x32_bf16 v[124:127], v[60:63], a[92:95], v[124:127]
s_add_u32 s45, s45, 32768
s_waitcnt vmcnt(4)
buffer_load_dwordx4 v[176:179], v249, s[20:23], s45 offen offset:0 nt
s_barrier
v_perm_b32 v66, v213, v209, s49
v_perm_b32 v67, v221, v217, s49
v_perm_b32 v70, v213, v209, s50
v_perm_b32 v71, v221, v217, s50
v_mfma_f32_16x16x32_bf16 v[96:99], v[64:67], a[88:91], v[96:99]
v_mfma_f32_16x16x32_bf16 v[128:131], v[64:67], a[92:95], v[128:131]
v_mfma_f32_16x16x32_bf16 v[100:103], v[68:71], a[88:91], v[100:103]
v_mfma_f32_16x16x32_bf16 v[132:135], v[68:71], a[92:95], v[132:135]
s_cbranch_vccnz L_sk361
s_waitcnt vmcnt(4)
L_sk361:
buffer_load_dwordx4 v[180:183], v249, s[20:23], s45 offen offset:1024 nt
v_perm_b32 v74, v214, v210, s49
v_perm_b32 v75, v222, v218, s49
v_perm_b32 v78, v214, v210, s50
v_perm_b32 v79, v222, v218, s50
v_mfma_f32_16x16x32_bf16 v[104:107], v[72:75], a[88:91], v[104:107]
v_mfma_f32_16x16x32_bf16 v[136:139], v[72:75], a[92:95], v[136:139]
v_mfma_f32_16x16x32_bf16 v[108:111], v[76:79], a[88:91], v[108:111]
v_mfma_f32_16x16x32_bf16 v[140:143], v[76:79], a[92:95], v[140:143]
s_waitcnt vmcnt(5)
s_bitcmp1_b32 s88, 1
s_cbranch_scc1 L_sk362
s_waitcnt vmcnt(4)
L_sk362:
buffer_load_dwordx4 v[184:187], v249, s[20:23], s45 offen offset:2048 nt
v_mov_b32 v241, 22
s_mov_b64 exec, 1
buffer_store_byte v241, v22, s[36:39], s42 offen
s_mov_b64 exec, -1
buffer_load_ushort v10, v240, s[36:39], 0 offen offset:128 nt
v_perm_b32 v82, v215, v211, s49
v_perm_b32 v83, v223, v219, s49
v_perm_b32 v86, v215, v211, s50
v_perm_b32 v87, v223, v219, s50
v_mfma_f32_16x16x32_bf16 v[112:115], v[80:83], a[88:91], v[112:115]
v_mfma_f32_16x16x32_bf16 v[144:147], v[80:83], a[92:95], v[144:147]
v_mfma_f32_16x16x32_bf16 v[116:119], v[84:87], a[88:91], v[116:119]
v_mfma_f32_16x16x32_bf16 v[148:151], v[84:87], a[92:95], v[148:151]
s_waitcnt vmcnt(7)
s_cbranch_vccnz L_sk363
s_waitcnt vmcnt(6)
L_sk363:
buffer_load_dwordx4 v[188:191], v249, s[20:23], s45 offen offset:3072 nt
v_mov_b32 v16, v36
v_mov_b32 v18, v36
s_nop 1
v_permlane32_swap_b32 v16, v18
v_pk_mul_f32 v[88:89], v[88:89], v[16:17] op_sel_hi:[1,0]
v_pk_mul_f32 v[90:91], v[90:91], v[16:17] op_sel_hi:[1,0]
v_pk_mul_f32 v[120:121], v[120:121], v[18:19] op_sel_hi:[1,0]
v_pk_mul_f32 v[122:123], v[122:123], v[18:19] op_sel_hi:[1,0]
v_pk_mul_f32 v[92:93], v[92:93], v[16:17] op_sel_hi:[1,0]
v_pk_mul_f32 v[94:95], v[94:95], v[16:17] op_sel_hi:[1,0]
v_pk_mul_f32 v[124:125], v[124:125], v[18:19] op_sel_hi:[1,0]
v_pk_mul_f32 v[126:127], v[126:127], v[18:19] op_sel_hi:[1,0]
v_perm_b32 v56, v228, v224, s49
v_perm_b32 v57, v236, v232, s49
v_perm_b32 v60, v228, v224, s50
v_perm_b32 v61, v236, v232, s50
s_add_u32 s45, s45, 32768
s_waitcnt vmcnt(6)
buffer_load_dwordx4 v[192:195], v249, s[20:23], s45 offen offset:0 nt
s_barrier
v_pk_mul_f32 v[96:97], v[96:97], v[16:17] op_sel_hi:[1,0]
v_pk_mul_f32 v[98:99], v[98:99], v[16:17] op_sel_hi:[1,0]
v_pk_mul_f32 v[128:129], v[128:129], v[18:19] op_sel_hi:[1,0]
v_pk_mul_f32 v[130:131], v[130:131], v[18:19] op_sel_hi:[1,0]
v_pk_mul_f32 v[100:101], v[100:101], v[16:17] op_sel_hi:[1,0]
v_pk_mul_f32 v[102:103], v[102:103], v[16:17] op_sel_hi:[1,0]
v_pk_mul_f32 v[132:133], v[132:133], v[18:19] op_sel_hi:[1,0]
v_pk_mul_f32 v[134:135], v[134:135], v[18:19] op_sel_hi:[1,0]
v_perm_b32 v64, v229, v225, s49
v_perm_b32 v65, v237, v233, s49
v_perm_b32 v68, v229, v225, s50
v_perm_b32 v69, v237, v233, s50
s_cbranch_vccnz L_sk365
s_waitcnt vmcnt(6)
L_sk365:
buffer_load_dwordx4 v[196:199], v249, s[20:23], s45 offen offset:1024 nt
v_pk_mul_f32 v[104:105], v[104:105], v[16:17] op_sel_hi:[1,0]
v_pk_mul_f32 v[106:107], v[106:107], v[16:17] op_sel_hi:[1,0]
v_pk_mul_f32 v[136:137], v[136:137], v[18:19] op_sel_hi:[1,0]
v_pk_mul_f32 v[138:139], v[138:139], v[18:19] op_sel_hi:[1,0]
v_pk_mul_f32 v[108:109], v[108:109], v[16:17] op_sel_hi:[1,0]
v_pk_mul_f32 v[110:111], v[110:111], v[16:17] op_sel_hi:[1,0]
v_pk_mul_f32 v[140:141], v[140:141], v[18:19] op_sel_hi:[1,0]
v_pk_mul_f32 v[142:143], v[142:143], v[18:19] op_sel_hi:[1,0]
v_perm_b32 v72, v230, v226, s49
v_perm_b32 v73, v238, v234, s49
v_perm_b32 v76, v230, v226, s50
v_perm_b32 v77, v238, v234, s50
s_waitcnt vmcnt(6)
s_bitcmp1_b32 s88, 0
s_cbranch_scc0 L_ng366
s_waitcnt vmcnt(5)
L_ng366:
buffer_load_dwordx4 v[200:203], v249, s[20:23], s45 offen offset:2048 nt
v_pk_mul_f32 v[112:113], v[112:113], v[16:17] op_sel_hi:[1,0]
v_pk_mul_f32 v[114:115], v[114:115], v[16:17] op_sel_hi:[1,0]
v_pk_mul_f32 v[144:145], v[144:145], v[18:19] op_sel_hi:[1,0]
v_pk_mul_f32 v[146:147], v[146:147], v[18:19] op_sel_hi:[1,0]
v_pk_mul_f32 v[116:117], v[116:117], v[16:17] op_sel_hi:[1,0]
v_pk_mul_f32 v[118:119], v[118:119], v[16:17] op_sel_hi:[1,0]
v_pk_mul_f32 v[148:149], v[148:149], v[18:19] op_sel_hi:[1,0]
v_pk_mul_f32 v[150:151], v[150:151], v[18:19] op_sel_hi:[1,0]
v_perm_b32 v80, v231, v227, s49
v_perm_b32 v81, v239, v235, s49
v_perm_b32 v84, v231, v227, s50
v_perm_b32 v85, v239, v235, s50
s_cbranch_vccnz L_sk367
s_waitcnt vmcnt(6)
L_sk367:
buffer_load_dwordx4 v[204:207], v249, s[20:23], s45 offen offset:3072 nt
v_perm_b32 v58, v164, v160, s49
v_perm_b32 v59, v172, v168, s49
v_perm_b32 v62, v164, v160, s50
v_perm_b32 v63, v172, v168, s50
v_mfma_f32_16x16x32_bf16 v[88:91], v[56:59], a[96:99], v[88:91]
v_mfma_f32_16x16x32_bf16 v[120:123], v[56:59], a[100:103], v[120:123]
v_mfma_f32_16x16x32_bf16 v[92:95], v[60:63], a[96:99], v[92:95]
v_mfma_f32_16x16x32_bf16 v[124:127], v[60:63], a[100:103], v[124:127]
s_add_u32 s45, s45, 32768
s_waitcnt vmcnt(4)
buffer_load_dwordx4 v[208:211], v249, s[20:23], s45 offen offset:0 nt
s_barrier
v_perm_b32 v66, v165, v161, s49
v_perm_b32 v67, v173, v169, s49
v_perm_b32 v70, v165, v161, s50
v_perm_b32 v71, v173, v169, s50
v_mfma_f32_16x16x32_bf16 v[96:99], v[64:67], a[96:99], v[96:99]
v_mfma_f32_16x16x32_bf16 v[128:131], v[64:67], a[100:103], v[128:131]
v_mfma_f32_16x16x32_bf16 v[100:103], v[68:71], a[96:99], v[100:103]
v_mfma_f32_16x16x32_bf16 v[132:135], v[68:71], a[100:103], v[132:135]
s_cbranch_vccnz L_sk369
s_waitcnt vmcnt(4)
L_sk369:
buffer_load_dwordx4 v[212:215], v249, s[20:23], s45 offen offset:1024 nt
v_perm_b32 v74, v166, v162, s49
v_perm_b32 v75, v174, v170, s49
v_perm_b32 v78, v166, v162, s50
v_perm_b32 v79, v174, v170, s50
v_mfma_f32_16x16x32_bf16 v[104:107], v[72:75], a[96:99], v[104:107]
v_mfma_f32_16x16x32_bf16 v[136:139], v[72:75], a[100:103], v[136:139]
v_mfma_f32_16x16x32_bf16 v[108:111], v[76:79], a[96:99], v[108:111]
v_mfma_f32_16x16x32_bf16 v[140:143], v[76:79], a[100:103], v[140:143]
s_waitcnt vmcnt(5)
s_bitcmp1_b32 s88, 1
s_cbranch_scc1 L_sk370
s_waitcnt vmcnt(4)
L_sk370:
buffer_load_dwordx4 v[216:219], v249, s[20:23], s45 offen offset:2048 nt
v_and_b32 v241, 0xff, v10
v_lshrrev_b32 v10, 8, v10
v_cmp_le_u32 vcc, 22, v241
v_cmp_le_u32 s[90:91], 22, v10
s_nop 0
s_bcnt1_i32_b64 s88, vcc
s_bcnt1_i32_b64 s90, s[90:91]
s_add_u32 s90, s90, s88
s_add_u32 s90, s90, s43
s_cmp_ge_u32 s90, 15
s_cselect_b32 s88, 2, 0
s_cmp_le_u32 s90, 5
s_cselect_b32 s88, 1, s88
s_cmp_ge_u32 s90, 10
s_cselect_b64 vcc, -1, 0
v_perm_b32 v82, v167, v163, s49
v_perm_b32 v83, v175, v171, s49
v_perm_b32 v86, v167, v163, s50
v_perm_b32 v87, v175, v171, s50
v_mfma_f32_16x16x32_bf16 v[112:115], v[80:83], a[96:99], v[112:115]
v_mfma_f32_16x16x32_bf16 v[144:147], v[80:83], a[100:103], v[144:147]
v_mfma_f32_16x16x32_bf16 v[116:119], v[84:87], a[96:99], v[116:119]
v_mfma_f32_16x16x32_bf16 v[148:151], v[84:87], a[100:103], v[148:151]
s_waitcnt vmcnt(5)
s_cbranch_vccnz L_sk371
s_waitcnt vmcnt(4)
L_sk371:
buffer_load_dwordx4 v[220:223], v249, s[20:23], s45 offen offset:3072 nt
v_mov_b32 v16, v37
v_mov_b32 v18, v37
s_nop 1
v_permlane32_swap_b32 v16, v18
v_pk_mul_f32 v[88:89], v[88:89], v[16:17] op_sel_hi:[1,0]
v_pk_mul_f32 v[90:91], v[90:91], v[16:17] op_sel_hi:[1,0]
v_pk_mul_f32 v[120:121], v[120:121], v[18:19] op_sel_hi:[1,0]
v_pk_mul_f32 v[122:123], v[122:123], v[18:19] op_sel_hi:[1,0]
v_pk_mul_f32 v[92:93], v[92:93], v[16:17] op_sel_hi:[1,0]
v_pk_mul_f32 v[94:95], v[94:95], v[16:17] op_sel_hi:[1,0]
v_pk_mul_f32 v[124:125], v[124:125], v[18:19] op_sel_hi:[1,0]
v_pk_mul_f32 v[126:127], v[126:127], v[18:19] op_sel_hi:[1,0]
v_perm_b32 v56, v180, v176, s49
v_perm_b32 v57, v188, v184, s49
v_perm_b32 v60, v180, v176, s50
v_perm_b32 v61, v188, v184, s50
s_add_u32 s45, s45, 32768
s_waitcnt vmcnt(4)
buffer_load_dwordx4 v[224:227], v249, s[20:23], s45 offen offset:0 nt
s_barrier
v_pk_mul_f32 v[96:97], v[96:97], v[16:17] op_sel_hi:[1,0]
v_pk_mul_f32 v[98:99], v[98:99], v[16:17] op_sel_hi:[1,0]
v_pk_mul_f32 v[128:129], v[128:129], v[18:19] op_sel_hi:[1,0]
v_pk_mul_f32 v[130:131], v[130:131], v[18:19] op_sel_hi:[1,0]
v_pk_mul_f32 v[100:101], v[100:101], v[16:17] op_sel_hi:[1,0]
v_pk_mul_f32 v[102:103], v[102:103], v[16:17] op_sel_hi:[1,0]
v_pk_mul_f32 v[132:133], v[132:133], v[18:19] op_sel_hi:[1,0]
v_pk_mul_f32 v[134:135], v[134:135], v[18:19] op_sel_hi:[1,0]
v_perm_b32 v64, v181, v177, s49
v_perm_b32 v65, v189, v185, s49
v_perm_b32 v68, v181, v177, s50
v_perm_b32 v69, v189, v185, s50
s_cbranch_vccnz L_sk373
s_waitcnt vmcnt(4)
L_sk373:
buffer_load_dwordx4 v[228:231], v249, s[20:23], s45 offen offset:1024 nt
v_pk_mul_f32 v[104:105], v[104:105], v[16:17] op_sel_hi:[1,0]
v_pk_mul_f32 v[106:107], v[106:107], v[16:17] op_sel_hi:[1,0]
v_pk_mul_f32 v[136:137], v[136:137], v[18:19] op_sel_hi:[1,0]
v_pk_mul_f32 v[138:139], v[138:139], v[18:19] op_sel_hi:[1,0]
v_pk_mul_f32 v[108:109], v[108:109], v[16:17] op_sel_hi:[1,0]
v_pk_mul_f32 v[110:111], v[110:111], v[16:17] op_sel_hi:[1,0]
v_pk_mul_f32 v[140:141], v[140:141], v[18:19] op_sel_hi:[1,0]
v_pk_mul_f32 v[142:143], v[142:143], v[18:19] op_sel_hi:[1,0]
v_perm_b32 v72, v182, v178, s49
v_perm_b32 v73, v190, v186, s49
v_perm_b32 v76, v182, v178, s50
v_perm_b32 v77, v190, v186, s50
s_waitcnt vmcnt(4)
s_bitcmp1_b32 s88, 0
s_cbranch_scc0 L_ng374
s_waitcnt vmcnt(3)
L_ng374:
buffer_load_dwordx4 v[232:235], v249, s[20:23], s45 offen offset:2048 nt
v_pk_mul_f32 v[112:113], v[112:113], v[16:17] op_sel_hi:[1,0]
v_pk_mul_f32 v[114:115], v[114:115], v[16:17] op_sel_hi:[1,0]
v_pk_mul_f32 v[144:145], v[144:145], v[18:19] op_sel_hi:[1,0]
v_pk_mul_f32 v[146:147], v[146:147], v[18:19] op_sel_hi:[1,0]
v_pk_mul_f32 v[116:117], v[116:117], v[16:17] op_sel_hi:[1,0]
v_pk_mul_f32 v[118:119], v[118:119], v[16:17] op_sel_hi:[1,0]
v_pk_mul_f32 v[148:149], v[148:149], v[18:19] op_sel_hi:[1,0]
v_pk_mul_f32 v[150:151], v[150:151], v[18:19] op_sel_hi:[1,0]
v_perm_b32 v80, v183, v179, s49
v_perm_b32 v81, v191, v187, s49
v_perm_b32 v84, v183, v179, s50
v_perm_b32 v85, v191, v187, s50
s_cbranch_vccnz L_sk375
s_waitcnt vmcnt(4)
L_sk375:
buffer_load_dwordx4 v[236:239], v249, s[20:23], s45 offen offset:3072 nt
v_perm_b32 v58, v196, v192, s49
v_perm_b32 v59, v204, v200, s49
v_perm_b32 v62, v196, v192, s50
v_perm_b32 v63, v204, v200, s50
v_mfma_f32_16x16x32_bf16 v[88:91], v[56:59], a[104:107], v[88:91]
v_mfma_f32_16x16x32_bf16 v[120:123], v[56:59], a[108:111], v[120:123]
v_mfma_f32_16x16x32_bf16 v[92:95], v[60:63], a[104:107], v[92:95]
v_mfma_f32_16x16x32_bf16 v[124:127], v[60:63], a[108:111], v[124:127]
s_add_u32 s45, s45, 32768
s_waitcnt vmcnt(4)
buffer_load_dwordx4 v[160:163], v249, s[20:23], s45 offen offset:0 nt
s_barrier
v_perm_b32 v66, v197, v193, s49
v_perm_b32 v67, v205, v201, s49
v_perm_b32 v70, v197, v193, s50
v_perm_b32 v71, v205, v201, s50
v_mfma_f32_16x16x32_bf16 v[96:99], v[64:67], a[104:107], v[96:99]
v_mfma_f32_16x16x32_bf16 v[128:131], v[64:67], a[108:111], v[128:131]
v_mfma_f32_16x16x32_bf16 v[100:103], v[68:71], a[104:107], v[100:103]
v_mfma_f32_16x16x32_bf16 v[132:135], v[68:71], a[108:111], v[132:135]
s_cbranch_vccnz L_sk377
s_waitcnt vmcnt(4)
L_sk377:
buffer_load_dwordx4 v[164:167], v249, s[20:23], s45 offen offset:1024 nt
v_perm_b32 v74, v198, v194, s49
v_perm_b32 v75, v206, v202, s49
v_perm_b32 v78, v198, v194, s50
v_perm_b32 v79, v206, v202, s50
v_mfma_f32_16x16x32_bf16 v[104:107], v[72:75], a[104:107], v[104:107]
v_mfma_f32_16x16x32_bf16 v[136:139], v[72:75], a[108:111], v[136:139]
v_mfma_f32_16x16x32_bf16 v[108:111], v[76:79], a[104:107], v[108:111]
v_mfma_f32_16x16x32_bf16 v[140:143], v[76:79], a[108:111], v[140:143]
s_waitcnt vmcnt(5)
s_bitcmp1_b32 s88, 1
s_cbranch_scc1 L_sk378
s_waitcnt vmcnt(4)
L_sk378:
buffer_load_dwordx4 v[168:171], v249, s[20:23], s45 offen offset:2048 nt
v_mov_b32 v241, 23
s_mov_b64 exec, 1
buffer_store_byte v241, v22, s[36:39], s42 offen
s_mov_b64 exec, -1
buffer_load_ushort v10, v240, s[36:39], 0 offen offset:128 nt
v_perm_b32 v82, v199, v195, s49
v_perm_b32 v83, v207, v203, s49
v_perm_b32 v86, v199, v195, s50
v_perm_b32 v87, v207, v203, s50
v_mfma_f32_16x16x32_bf16 v[112:115], v[80:83], a[104:107], v[112:115]
v_mfma_f32_16x16x32_bf16 v[144:147], v[80:83], a[108:111], v[144:147]
v_mfma_f32_16x16x32_bf16 v[116:119], v[84:87], a[104:107], v[116:119]
v_mfma_f32_16x16x32_bf16 v[148:151], v[84:87], a[108:111], v[148:151]
s_waitcnt vmcnt(7)
s_cbranch_vccnz L_sk379
s_waitcnt vmcnt(6)
L_sk379:
buffer_load_dwordx4 v[172:175], v249, s[20:23], s45 offen offset:3072 nt
v_mov_b32 v16, v38
v_mov_b32 v18, v38
s_nop 1
v_permlane32_swap_b32 v16, v18
v_pk_mul_f32 v[88:89], v[88:89], v[16:17] op_sel_hi:[1,0]
v_pk_mul_f32 v[90:91], v[90:91], v[16:17] op_sel_hi:[1,0]
v_pk_mul_f32 v[120:121], v[120:121], v[18:19] op_sel_hi:[1,0]
v_pk_mul_f32 v[122:123], v[122:123], v[18:19] op_sel_hi:[1,0]
v_pk_mul_f32 v[92:93], v[92:93], v[16:17] op_sel_hi:[1,0]
v_pk_mul_f32 v[94:95], v[94:95], v[16:17] op_sel_hi:[1,0]
v_pk_mul_f32 v[124:125], v[124:125], v[18:19] op_sel_hi:[1,0]
v_pk_mul_f32 v[126:127], v[126:127], v[18:19] op_sel_hi:[1,0]
v_perm_b32 v56, v212, v208, s49
v_perm_b32 v57, v220, v216, s49
v_perm_b32 v60, v212, v208, s50
v_perm_b32 v61, v220, v216, s50
s_add_u32 s45, s45, 32768
s_waitcnt vmcnt(6)
buffer_load_dwordx4 v[176:179], v249, s[20:23], s45 offen offset:0 nt
s_barrier
v_pk_mul_f32 v[96:97], v[96:97], v[16:17] op_sel_hi:[1,0]
v_pk_mul_f32 v[98:99], v[98:99], v[16:17] op_sel_hi:[1,0]
v_pk_mul_f32 v[128:129], v[128:129], v[18:19] op_sel_hi:[1,0]
v_pk_mul_f32 v[130:131], v[130:131], v[18:19] op_sel_hi:[1,0]
v_pk_mul_f32 v[100:101], v[100:101], v[16:17] op_sel_hi:[1,0]
v_pk_mul_f32 v[102:103], v[102:103], v[16:17] op_sel_hi:[1,0]
v_pk_mul_f32 v[132:133], v[132:133], v[18:19] op_sel_hi:[1,0]
v_pk_mul_f32 v[134:135], v[134:135], v[18:19] op_sel_hi:[1,0]
v_perm_b32 v64, v213, v209, s49
v_perm_b32 v65, v221, v217, s49
v_perm_b32 v68, v213, v209, s50
v_perm_b32 v69, v221, v217, s50
s_cbranch_vccnz L_sk381
s_waitcnt vmcnt(6)
L_sk381:
buffer_load_dwordx4 v[180:183], v249, s[20:23], s45 offen offset:1024 nt
v_pk_mul_f32 v[104:105], v[104:105], v[16:17] op_sel_hi:[1,0]
v_pk_mul_f32 v[106:107], v[106:107], v[16:17] op_sel_hi:[1,0]
v_pk_mul_f32 v[136:137], v[136:137], v[18:19] op_sel_hi:[1,0]
v_pk_mul_f32 v[138:139], v[138:139], v[18:19] op_sel_hi:[1,0]
v_pk_mul_f32 v[108:109], v[108:109], v[16:17] op_sel_hi:[1,0]
v_pk_mul_f32 v[110:111], v[110:111], v[16:17] op_sel_hi:[1,0]
v_pk_mul_f32 v[140:141], v[140:141], v[18:19] op_sel_hi:[1,0]
v_pk_mul_f32 v[142:143], v[142:143], v[18:19] op_sel_hi:[1,0]
v_perm_b32 v72, v214, v210, s49
v_perm_b32 v73, v222, v218, s49
v_perm_b32 v76, v214, v210, s50
v_perm_b32 v77, v222, v218, s50
s_waitcnt vmcnt(6)
s_bitcmp1_b32 s88, 0
s_cbranch_scc0 L_ng382
s_waitcnt vmcnt(5)
L_ng382:
buffer_load_dwordx4 v[184:187], v249, s[20:23], s45 offen offset:2048 nt
v_pk_mul_f32 v[112:113], v[112:113], v[16:17] op_sel_hi:[1,0]
v_pk_mul_f32 v[114:115], v[114:115], v[16:17] op_sel_hi:[1,0]
v_pk_mul_f32 v[144:145], v[144:145], v[18:19] op_sel_hi:[1,0]
v_pk_mul_f32 v[146:147], v[146:147], v[18:19] op_sel_hi:[1,0]
v_pk_mul_f32 v[116:117], v[116:117], v[16:17] op_sel_hi:[1,0]
v_pk_mul_f32 v[118:119], v[118:119], v[16:17] op_sel_hi:[1,0]
v_pk_mul_f32 v[148:149], v[148:149], v[18:19] op_sel_hi:[1,0]
v_pk_mul_f32 v[150:151], v[150:151], v[18:19] op_sel_hi:[1,0]
v_perm_b32 v80, v215, v211, s49
v_perm_b32 v81, v223, v219, s49
v_perm_b32 v84, v215, v211, s50
v_perm_b32 v85, v223, v219, s50
s_cbranch_vccnz L_sk383
s_waitcnt vmcnt(6)
L_sk383:
buffer_load_dwordx4 v[188:191], v249, s[20:23], s45 offen offset:3072 nt
v_perm_b32 v58, v228, v224, s49
v_perm_b32 v59, v236, v232, s49
v_perm_b32 v62, v228, v224, s50
v_perm_b32 v63, v236, v232, s50
v_mfma_f32_16x16x32_bf16 v[88:91], v[56:59], a[112:115], v[88:91]
v_mfma_f32_16x16x32_bf16 v[120:123], v[56:59], a[116:119], v[120:123]
v_mfma_f32_16x16x32_bf16 v[92:95], v[60:63], a[112:115], v[92:95]
v_mfma_f32_16x16x32_bf16 v[124:127], v[60:63], a[116:119], v[124:127]
s_add_u32 s45, s45, 32768
s_waitcnt vmcnt(4)
buffer_load_dwordx4 v[192:195], v249, s[20:23], s45 offen offset:0 nt
s_barrier
v_perm_b32 v66, v229, v225, s49
v_perm_b32 v67, v237, v233, s49
v_perm_b32 v70, v229, v225, s50
v_perm_b32 v71, v237, v233, s50
v_mfma_f32_16x16x32_bf16 v[96:99], v[64:67], a[112:115], v[96:99]
v_mfma_f32_16x16x32_bf16 v[128:131], v[64:67], a[116:119], v[128:131]
v_mfma_f32_16x16x32_bf16 v[100:103], v[68:71], a[112:115], v[100:103]
v_mfma_f32_16x16x32_bf16 v[132:135], v[68:71], a[116:119], v[132:135]
s_cbranch_vccnz L_sk385
s_waitcnt vmcnt(4)
L_sk385:
buffer_load_dwordx4 v[196:199], v249, s[20:23], s45 offen offset:1024 nt
v_perm_b32 v74, v230, v226, s49
v_perm_b32 v75, v238, v234, s49
v_perm_b32 v78, v230, v226, s50
v_perm_b32 v79, v238, v234, s50
v_mfma_f32_16x16x32_bf16 v[104:107], v[72:75], a[112:115], v[104:107]
v_mfma_f32_16x16x32_bf16 v[136:139], v[72:75], a[116:119], v[136:139]
v_mfma_f32_16x16x32_bf16 v[108:111], v[76:79], a[112:115], v[108:111]
v_mfma_f32_16x16x32_bf16 v[140:143], v[76:79], a[116:119], v[140:143]
s_waitcnt vmcnt(5)
s_bitcmp1_b32 s88, 1
s_cbranch_scc1 L_sk386
s_waitcnt vmcnt(4)
L_sk386:
buffer_load_dwordx4 v[200:203], v249, s[20:23], s45 offen offset:2048 nt
v_and_b32 v241, 0xff, v10
v_lshrrev_b32 v10, 8, v10
v_cmp_le_u32 vcc, 23, v241
v_cmp_le_u32 s[90:91], 23, v10
s_nop 0
s_bcnt1_i32_b64 s88, vcc
s_bcnt1_i32_b64 s90, s[90:91]
s_add_u32 s90, s90, s88
s_add_u32 s90, s90, s43
s_cmp_ge_u32 s90, 15
s_cselect_b32 s88, 2, 0
s_cmp_le_u32 s90, 5
s_cselect_b32 s88, 1, s88
s_cmp_ge_u32 s90, 10
s_cselect_b64 vcc, -1, 0
v_perm_b32 v82, v231, v227, s49
v_perm_b32 v83, v239, v235, s49
v_perm_b32 v86, v231, v227, s50
v_perm_b32 v87, v239, v235, s50
v_mfma_f32_16x16x32_bf16 v[112:115], v[80:83], a[112:115], v[112:115]
v_mfma_f32_16x16x32_bf16 v[144:147], v[80:83], a[116:119], v[144:147]
v_mfma_f32_16x16x32_bf16 v[116:119], v[84:87], a[112:115], v[116:119]
v_mfma_f32_16x16x32_bf16 v[148:151], v[84:87], a[116:119], v[148:151]
s_waitcnt vmcnt(5)
s_cbranch_vccnz L_sk387
s_waitcnt vmcnt(4)
L_sk387:
buffer_load_dwordx4 v[204:207], v249, s[20:23], s45 offen offset:3072 nt
v_mov_b32 v16, v39
v_mov_b32 v18, v39
s_nop 1
v_permlane32_swap_b32 v16, v18
v_pk_mul_f32 v[88:89], v[88:89], v[16:17] op_sel_hi:[1,0]
v_pk_mul_f32 v[90:91], v[90:91], v[16:17] op_sel_hi:[1,0]
v_pk_mul_f32 v[120:121], v[120:121], v[18:19] op_sel_hi:[1,0]
v_pk_mul_f32 v[122:123], v[122:123], v[18:19] op_sel_hi:[1,0]
v_pk_mul_f32 v[92:93], v[92:93], v[16:17] op_sel_hi:[1,0]
v_pk_mul_f32 v[94:95], v[94:95], v[16:17] op_sel_hi:[1,0]
v_pk_mul_f32 v[124:125], v[124:125], v[18:19] op_sel_hi:[1,0]
v_pk_mul_f32 v[126:127], v[126:127], v[18:19] op_sel_hi:[1,0]
v_perm_b32 v56, v164, v160, s49
v_perm_b32 v57, v172, v168, s49
v_perm_b32 v60, v164, v160, s50
v_perm_b32 v61, v172, v168, s50
s_add_u32 s45, s45, 32768
s_waitcnt vmcnt(4)
buffer_load_dwordx4 v[208:211], v249, s[20:23], s45 offen offset:0 nt
s_barrier
v_pk_mul_f32 v[96:97], v[96:97], v[16:17] op_sel_hi:[1,0]
v_pk_mul_f32 v[98:99], v[98:99], v[16:17] op_sel_hi:[1,0]
v_pk_mul_f32 v[128:129], v[128:129], v[18:19] op_sel_hi:[1,0]
v_pk_mul_f32 v[130:131], v[130:131], v[18:19] op_sel_hi:[1,0]
v_pk_mul_f32 v[100:101], v[100:101], v[16:17] op_sel_hi:[1,0]
v_pk_mul_f32 v[102:103], v[102:103], v[16:17] op_sel_hi:[1,0]
v_pk_mul_f32 v[132:133], v[132:133], v[18:19] op_sel_hi:[1,0]
v_pk_mul_f32 v[134:135], v[134:135], v[18:19] op_sel_hi:[1,0]
v_perm_b32 v64, v165, v161, s49
v_perm_b32 v65, v173, v169, s49
v_perm_b32 v68, v165, v161, s50
v_perm_b32 v69, v173, v169, s50
s_cbranch_vccnz L_sk389
s_waitcnt vmcnt(4)
L_sk389:
buffer_load_dwordx4 v[212:215], v249, s[20:23], s45 offen offset:1024 nt
v_pk_mul_f32 v[104:105], v[104:105], v[16:17] op_sel_hi:[1,0]
v_pk_mul_f32 v[106:107], v[106:107], v[16:17] op_sel_hi:[1,0]
v_pk_mul_f32 v[136:137], v[136:137], v[18:19] op_sel_hi:[1,0]
v_pk_mul_f32 v[138:139], v[138:139], v[18:19] op_sel_hi:[1,0]
v_pk_mul_f32 v[108:109], v[108:109], v[16:17] op_sel_hi:[1,0]
v_pk_mul_f32 v[110:111], v[110:111], v[16:17] op_sel_hi:[1,0]
v_pk_mul_f32 v[140:141], v[140:141], v[18:19] op_sel_hi:[1,0]
v_pk_mul_f32 v[142:143], v[142:143], v[18:19] op_sel_hi:[1,0]
v_perm_b32 v72, v166, v162, s49
v_perm_b32 v73, v174, v170, s49
v_perm_b32 v76, v166, v162, s50
v_perm_b32 v77, v174, v170, s50
s_waitcnt vmcnt(4)
s_bitcmp1_b32 s88, 0
s_cbranch_scc0 L_ng390
s_waitcnt vmcnt(3)
L_ng390:
buffer_load_dwordx4 v[216:219], v249, s[20:23], s45 offen offset:2048 nt
v_pk_mul_f32 v[112:113], v[112:113], v[16:17] op_sel_hi:[1,0]
v_pk_mul_f32 v[114:115], v[114:115], v[16:17] op_sel_hi:[1,0]
v_pk_mul_f32 v[144:145], v[144:145], v[18:19] op_sel_hi:[1,0]
v_pk_mul_f32 v[146:147], v[146:147], v[18:19] op_sel_hi:[1,0]
v_pk_mul_f32 v[116:117], v[116:117], v[16:17] op_sel_hi:[1,0]
v_pk_mul_f32 v[118:119], v[118:119], v[16:17] op_sel_hi:[1,0]
v_pk_mul_f32 v[148:149], v[148:149], v[18:19] op_sel_hi:[1,0]
v_pk_mul_f32 v[150:151], v[150:151], v[18:19] op_sel_hi:[1,0]
v_perm_b32 v80, v167, v163, s49
v_perm_b32 v81, v175, v171, s49
v_perm_b32 v84, v167, v163, s50
v_perm_b32 v85, v175, v171, s50
s_cbranch_vccnz L_sk391
s_waitcnt vmcnt(4)
L_sk391:
buffer_load_dwordx4 v[220:223], v249, s[20:23], s45 offen offset:3072 nt
v_perm_b32 v58, v180, v176, s49
v_perm_b32 v59, v188, v184, s49
v_perm_b32 v62, v180, v176, s50
v_perm_b32 v63, v188, v184, s50
v_mfma_f32_16x16x32_bf16 v[88:91], v[56:59], a[120:123], v[88:91]
v_mfma_f32_16x16x32_bf16 v[120:123], v[56:59], a[124:127], v[120:123]
v_mfma_f32_16x16x32_bf16 v[92:95], v[60:63], a[120:123], v[92:95]
v_mfma_f32_16x16x32_bf16 v[124:127], v[60:63], a[124:127], v[124:127]
s_add_u32 s45, s45, 32768
s_waitcnt vmcnt(4)
buffer_load_dwordx4 v[224:227], v249, s[20:23], s45 offen offset:0 nt
s_barrier
v_perm_b32 v66, v181, v177, s49
v_perm_b32 v67, v189, v185, s49
v_perm_b32 v70, v181, v177, s50
v_perm_b32 v71, v189, v185, s50
v_mfma_f32_16x16x32_bf16 v[96:99], v[64:67], a[120:123], v[96:99]
v_mfma_f32_16x16x32_bf16 v[128:131], v[64:67], a[124:127], v[128:131]
v_mfma_f32_16x16x32_bf16 v[100:103], v[68:71], a[120:123], v[100:103]
v_mfma_f32_16x16x32_bf16 v[132:135], v[68:71], a[124:127], v[132:135]
s_cbranch_vccnz L_sk393
s_waitcnt vmcnt(4)
L_sk393:
buffer_load_dwordx4 v[228:231], v249, s[20:23], s45 offen offset:1024 nt
v_perm_b32 v74, v182, v178, s49
v_perm_b32 v75, v190, v186, s49
v_perm_b32 v78, v182, v178, s50
v_perm_b32 v79, v190, v186, s50
v_mfma_f32_16x16x32_bf16 v[104:107], v[72:75], a[120:123], v[104:107]
v_mfma_f32_16x16x32_bf16 v[136:139], v[72:75], a[124:127], v[136:139]
v_mfma_f32_16x16x32_bf16 v[108:111], v[76:79], a[120:123], v[108:111]
v_mfma_f32_16x16x32_bf16 v[140:143], v[76:79], a[124:127], v[140:143]
s_waitcnt vmcnt(5)
s_bitcmp1_b32 s88, 1
s_cbranch_scc1 L_sk394
s_waitcnt vmcnt(4)
L_sk394:
buffer_load_dwordx4 v[232:235], v249, s[20:23], s45 offen offset:2048 nt
v_mov_b32 v241, 24
s_mov_b64 exec, 1
buffer_store_byte v241, v22, s[36:39], s42 offen
s_mov_b64 exec, -1
buffer_load_ushort v10, v240, s[36:39], 0 offen offset:128 nt
v_perm_b32 v82, v183, v179, s49
v_perm_b32 v83, v191, v187, s49
v_perm_b32 v86, v183, v179, s50
v_perm_b32 v87, v191, v187, s50
v_mfma_f32_16x16x32_bf16 v[112:115], v[80:83], a[120:123], v[112:115]
v_mfma_f32_16x16x32_bf16 v[144:147], v[80:83], a[124:127], v[144:147]
v_mfma_f32_16x16x32_bf16 v[116:119], v[84:87], a[120:123], v[116:119]
v_mfma_f32_16x16x32_bf16 v[148:151], v[84:87], a[124:127], v[148:151]
s_waitcnt vmcnt(7)
s_cbranch_vccnz L_sk395
s_waitcnt vmcnt(6)
L_sk395:
buffer_load_dwordx4 v[236:239], v249, s[20:23], s45 offen offset:3072 nt
v_mov_b32 v16, v40
v_mov_b32 v18, v40
s_nop 1
v_permlane32_swap_b32 v16, v18
v_pk_mul_f32 v[88:89], v[88:89], v[16:17] op_sel_hi:[1,0]
v_pk_mul_f32 v[90:91], v[90:91], v[16:17] op_sel_hi:[1,0]
v_pk_mul_f32 v[120:121], v[120:121], v[18:19] op_sel_hi:[1,0]
v_pk_mul_f32 v[122:123], v[122:123], v[18:19] op_sel_hi:[1,0]
v_pk_mul_f32 v[92:93], v[92:93], v[16:17] op_sel_hi:[1,0]
v_pk_mul_f32 v[94:95], v[94:95], v[16:17] op_sel_hi:[1,0]
v_pk_mul_f32 v[124:125], v[124:125], v[18:19] op_sel_hi:[1,0]
v_pk_mul_f32 v[126:127], v[126:127], v[18:19] op_sel_hi:[1,0]
v_perm_b32 v56, v196, v192, s49
v_perm_b32 v57, v204, v200, s49
v_perm_b32 v60, v196, v192, s50
v_perm_b32 v61, v204, v200, s50
s_add_u32 s45, s45, 32768
s_waitcnt vmcnt(6)
buffer_load_dwordx4 v[160:163], v249, s[20:23], s45 offen offset:0 nt
s_barrier
v_pk_mul_f32 v[96:97], v[96:97], v[16:17] op_sel_hi:[1,0]
v_pk_mul_f32 v[98:99], v[98:99], v[16:17] op_sel_hi:[1,0]
v_pk_mul_f32 v[128:129], v[128:129], v[18:19] op_sel_hi:[1,0]
v_pk_mul_f32 v[130:131], v[130:131], v[18:19] op_sel_hi:[1,0]
v_pk_mul_f32 v[100:101], v[100:101], v[16:17] op_sel_hi:[1,0]
v_pk_mul_f32 v[102:103], v[102:103], v[16:17] op_sel_hi:[1,0]
v_pk_mul_f32 v[132:133], v[132:133], v[18:19] op_sel_hi:[1,0]
v_pk_mul_f32 v[134:135], v[134:135], v[18:19] op_sel_hi:[1,0]
v_perm_b32 v64, v197, v193, s49
v_perm_b32 v65, v205, v201, s49
v_perm_b32 v68, v197, v193, s50
v_perm_b32 v69, v205, v201, s50
s_cbranch_vccnz L_sk397
s_waitcnt vmcnt(6)
L_sk397:
buffer_load_dwordx4 v[164:167], v249, s[20:23], s45 offen offset:1024 nt
v_pk_mul_f32 v[104:105], v[104:105], v[16:17] op_sel_hi:[1,0]
v_pk_mul_f32 v[106:107], v[106:107], v[16:17] op_sel_hi:[1,0]
v_pk_mul_f32 v[136:137], v[136:137], v[18:19] op_sel_hi:[1,0]
v_pk_mul_f32 v[138:139], v[138:139], v[18:19] op_sel_hi:[1,0]
v_pk_mul_f32 v[108:109], v[108:109], v[16:17] op_sel_hi:[1,0]
v_pk_mul_f32 v[110:111], v[110:111], v[16:17] op_sel_hi:[1,0]
v_pk_mul_f32 v[140:141], v[140:141], v[18:19] op_sel_hi:[1,0]
v_pk_mul_f32 v[142:143], v[142:143], v[18:19] op_sel_hi:[1,0]
v_perm_b32 v72, v198, v194, s49
v_perm_b32 v73, v206, v202, s49
v_perm_b32 v76, v198, v194, s50
v_perm_b32 v77, v206, v202, s50
s_waitcnt vmcnt(6)
s_bitcmp1_b32 s88, 0
s_cbranch_scc0 L_ng398
s_waitcnt vmcnt(5)
L_ng398:
buffer_load_dwordx4 v[168:171], v249, s[20:23], s45 offen offset:2048 nt
v_pk_mul_f32 v[112:113], v[112:113], v[16:17] op_sel_hi:[1,0]
v_pk_mul_f32 v[114:115], v[114:115], v[16:17] op_sel_hi:[1,0]
v_pk_mul_f32 v[144:145], v[144:145], v[18:19] op_sel_hi:[1,0]
v_pk_mul_f32 v[146:147], v[146:147], v[18:19] op_sel_hi:[1,0]
v_pk_mul_f32 v[116:117], v[116:117], v[16:17] op_sel_hi:[1,0]
v_pk_mul_f32 v[118:119], v[118:119], v[16:17] op_sel_hi:[1,0]
v_pk_mul_f32 v[148:149], v[148:149], v[18:19] op_sel_hi:[1,0]
v_pk_mul_f32 v[150:151], v[150:151], v[18:19] op_sel_hi:[1,0]
v_perm_b32 v80, v199, v195, s49
v_perm_b32 v81, v207, v203, s49
v_perm_b32 v84, v199, v195, s50
v_perm_b32 v85, v207, v203, s50
s_cbranch_vccnz L_sk399
s_waitcnt vmcnt(6)
L_sk399:
buffer_load_dwordx4 v[172:175], v249, s[20:23], s45 offen offset:3072 nt
v_perm_b32 v58, v212, v208, s49
v_perm_b32 v59, v220, v216, s49
v_perm_b32 v62, v212, v208, s50
v_perm_b32 v63, v220, v216, s50
v_mfma_f32_16x16x32_bf16 v[88:91], v[56:59], a[128:131], v[88:91]
v_mfma_f32_16x16x32_bf16 v[120:123], v[56:59], a[132:135], v[120:123]
v_mfma_f32_16x16x32_bf16 v[92:95], v[60:63], a[128:131], v[92:95]
v_mfma_f32_16x16x32_bf16 v[124:127], v[60:63], a[132:135], v[124:127]
s_add_u32 s45, s45, 32768
s_waitcnt vmcnt(4)
buffer_load_dwordx4 v[176:179], v249, s[20:23], s45 offen offset:0 nt
s_barrier
v_perm_b32 v66, v213, v209, s49
v_perm_b32 v67, v221, v217, s49
v_perm_b32 v70, v213, v209, s50
v_perm_b32 v71, v221, v217, s50
v_mfma_f32_16x16x32_bf16 v[96:99], v[64:67], a[128:131], v[96:99]
v_mfma_f32_16x16x32_bf16 v[128:131], v[64:67], a[132:135], v[128:131]
v_mfma_f32_16x16x32_bf16 v[100:103], v[68:71], a[128:131], v[100:103]
v_mfma_f32_16x16x32_bf16 v[132:135], v[68:71], a[132:135], v[132:135]
s_cbranch_vccnz L_sk401
s_waitcnt vmcnt(4)
L_sk401:
buffer_load_dwordx4 v[180:183], v249, s[20:23], s45 offen offset:1024 nt
v_perm_b32 v74, v214, v210, s49
v_perm_b32 v75, v222, v218, s49
v_perm_b32 v78, v214, v210, s50
v_perm_b32 v79, v222, v218, s50
v_mfma_f32_16x16x32_bf16 v[104:107], v[72:75], a[128:131], v[104:107]
v_mfma_f32_16x16x32_bf16 v[136:139], v[72:75], a[132:135], v[136:139]
v_mfma_f32_16x16x32_bf16 v[108:111], v[76:79], a[128:131], v[108:111]
v_mfma_f32_16x16x32_bf16 v[140:143], v[76:79], a[132:135], v[140:143]
s_waitcnt vmcnt(5)
s_bitcmp1_b32 s88, 1
s_cbranch_scc1 L_sk402
s_waitcnt vmcnt(4)
L_sk402:
buffer_load_dwordx4 v[184:187], v249, s[20:23], s45 offen offset:2048 nt
v_and_b32 v241, 0xff, v10
v_lshrrev_b32 v10, 8, v10
v_cmp_le_u32 vcc, 24, v241
v_cmp_le_u32 s[90:91], 24, v10
s_nop 0
s_bcnt1_i32_b64 s88, vcc
s_bcnt1_i32_b64 s90, s[90:91]
s_add_u32 s90, s90, s88
s_add_u32 s90, s90, s43
s_cmp_ge_u32 s90, 15
s_cselect_b32 s88, 2, 0
s_cmp_le_u32 s90, 5
s_cselect_b32 s88, 1, s88
s_cmp_ge_u32 s90, 10
s_cselect_b64 vcc, -1, 0
v_perm_b32 v82, v215, v211, s49
v_perm_b32 v83, v223, v219, s49
v_perm_b32 v86, v215, v211, s50
v_perm_b32 v87, v223, v219, s50
v_mfma_f32_16x16x32_bf16 v[112:115], v[80:83], a[128:131], v[112:115]
v_mfma_f32_16x16x32_bf16 v[144:147], v[80:83], a[132:135], v[144:147]
v_mfma_f32_16x16x32_bf16 v[116:119], v[84:87], a[128:131], v[116:119]
v_mfma_f32_16x16x32_bf16 v[148:151], v[84:87], a[132:135], v[148:151]
s_waitcnt vmcnt(5)
s_cbranch_vccnz L_sk403
s_waitcnt vmcnt(4)
L_sk403:
buffer_load_dwordx4 v[188:191], v249, s[20:23], s45 offen offset:3072 nt
v_mov_b32 v16, v41
v_mov_b32 v18, v41
s_nop 1
v_permlane32_swap_b32 v16, v18
v_pk_mul_f32 v[88:89], v[88:89], v[16:17] op_sel_hi:[1,0]
v_pk_mul_f32 v[90:91], v[90:91], v[16:17] op_sel_hi:[1,0]
v_pk_mul_f32 v[120:121], v[120:121], v[18:19] op_sel_hi:[1,0]
v_pk_mul_f32 v[122:123], v[122:123], v[18:19] op_sel_hi:[1,0]
v_pk_mul_f32 v[92:93], v[92:93], v[16:17] op_sel_hi:[1,0]
v_pk_mul_f32 v[94:95], v[94:95], v[16:17] op_sel_hi:[1,0]
v_pk_mul_f32 v[124:125], v[124:125], v[18:19] op_sel_hi:[1,0]
v_pk_mul_f32 v[126:127], v[126:127], v[18:19] op_sel_hi:[1,0]
v_perm_b32 v56, v228, v224, s49
v_perm_b32 v57, v236, v232, s49
v_perm_b32 v60, v228, v224, s50
v_perm_b32 v61, v236, v232, s50
s_add_u32 s45, s45, 32768
s_waitcnt vmcnt(4)
buffer_load_dwordx4 v[192:195], v249, s[20:23], s45 offen offset:0 nt
s_barrier
v_pk_mul_f32 v[96:97], v[96:97], v[16:17] op_sel_hi:[1,0]
v_pk_mul_f32 v[98:99], v[98:99], v[16:17] op_sel_hi:[1,0]
v_pk_mul_f32 v[128:129], v[128:129], v[18:19] op_sel_hi:[1,0]
v_pk_mul_f32 v[130:131], v[130:131], v[18:19] op_sel_hi:[1,0]
v_pk_mul_f32 v[100:101], v[100:101], v[16:17] op_sel_hi:[1,0]
v_pk_mul_f32 v[102:103], v[102:103], v[16:17] op_sel_hi:[1,0]
v_pk_mul_f32 v[132:133], v[132:133], v[18:19] op_sel_hi:[1,0]
v_pk_mul_f32 v[134:135], v[134:135], v[18:19] op_sel_hi:[1,0]
v_perm_b32 v64, v229, v225, s49
v_perm_b32 v65, v237, v233, s49
v_perm_b32 v68, v229, v225, s50
v_perm_b32 v69, v237, v233, s50
s_cbranch_vccnz L_sk405
s_waitcnt vmcnt(4)
L_sk405:
buffer_load_dwordx4 v[196:199], v249, s[20:23], s45 offen offset:1024 nt
v_pk_mul_f32 v[104:105], v[104:105], v[16:17] op_sel_hi:[1,0]
v_pk_mul_f32 v[106:107], v[106:107], v[16:17] op_sel_hi:[1,0]
v_pk_mul_f32 v[136:137], v[136:137], v[18:19] op_sel_hi:[1,0]
v_pk_mul_f32 v[138:139], v[138:139], v[18:19] op_sel_hi:[1,0]
v_pk_mul_f32 v[108:109], v[108:109], v[16:17] op_sel_hi:[1,0]
v_pk_mul_f32 v[110:111], v[110:111], v[16:17] op_sel_hi:[1,0]
v_pk_mul_f32 v[140:141], v[140:141], v[18:19] op_sel_hi:[1,0]
v_pk_mul_f32 v[142:143], v[142:143], v[18:19] op_sel_hi:[1,0]
v_perm_b32 v72, v230, v226, s49
v_perm_b32 v73, v238, v234, s49
v_perm_b32 v76, v230, v226, s50
v_perm_b32 v77, v238, v234, s50
s_waitcnt vmcnt(4)
s_bitcmp1_b32 s88, 0
s_cbranch_scc0 L_ng406
s_waitcnt vmcnt(3)
L_ng406:
buffer_load_dwordx4 v[200:203], v249, s[20:23], s45 offen offset:2048 nt
v_pk_mul_f32 v[112:113], v[112:113], v[16:17] op_sel_hi:[1,0]
v_pk_mul_f32 v[114:115], v[114:115], v[16:17] op_sel_hi:[1,0]
v_pk_mul_f32 v[144:145], v[144:145], v[18:19] op_sel_hi:[1,0]
v_pk_mul_f32 v[146:147], v[146:147], v[18:19] op_sel_hi:[1,0]
v_pk_mul_f32 v[116:117], v[116:117], v[16:17] op_sel_hi:[1,0]
v_pk_mul_f32 v[118:119], v[118:119], v[16:17] op_sel_hi:[1,0]
v_pk_mul_f32 v[148:149], v[148:149], v[18:19] op_sel_hi:[1,0]
v_pk_mul_f32 v[150:151], v[150:151], v[18:19] op_sel_hi:[1,0]
v_perm_b32 v80, v231, v227, s49
v_perm_b32 v81, v239, v235, s49
v_perm_b32 v84, v231, v227, s50
v_perm_b32 v85, v239, v235, s50
s_cbranch_vccnz L_sk407
s_waitcnt vmcnt(4)
L_sk407:
buffer_load_dwordx4 v[204:207], v249, s[20:23], s45 offen offset:3072 nt
v_perm_b32 v58, v164, v160, s49
v_perm_b32 v59, v172, v168, s49
v_perm_b32 v62, v164, v160, s50
v_perm_b32 v63, v172, v168, s50
v_mfma_f32_16x16x32_bf16 v[88:91], v[56:59], a[136:139], v[88:91]
v_mfma_f32_16x16x32_bf16 v[120:123], v[56:59], a[140:143], v[120:123]
v_mfma_f32_16x16x32_bf16 v[92:95], v[60:63], a[136:139], v[92:95]
v_mfma_f32_16x16x32_bf16 v[124:127], v[60:63], a[140:143], v[124:127]
s_add_u32 s45, s45, 32768
s_waitcnt vmcnt(4)
buffer_load_dwordx4 v[208:211], v249, s[20:23], s45 offen offset:0 nt
s_barrier
v_perm_b32 v66, v165, v161, s49
v_perm_b32 v67, v173, v169, s49
v_perm_b32 v70, v165, v161, s50
v_perm_b32 v71, v173, v169, s50
v_mfma_f32_16x16x32_bf16 v[96:99], v[64:67], a[136:139], v[96:99]
v_mfma_f32_16x16x32_bf16 v[128:131], v[64:67], a[140:143], v[128:131]
v_mfma_f32_16x16x32_bf16 v[100:103], v[68:71], a[136:139], v[100:103]
v_mfma_f32_16x16x32_bf16 v[132:135], v[68:71], a[140:143], v[132:135]
s_cbranch_vccnz L_sk409
s_waitcnt vmcnt(4)
L_sk409:
buffer_load_dwordx4 v[212:215], v249, s[20:23], s45 offen offset:1024 nt
v_perm_b32 v74, v166, v162, s49
v_perm_b32 v75, v174, v170, s49
v_perm_b32 v78, v166, v162, s50
v_perm_b32 v79, v174, v170, s50
v_mfma_f32_16x16x32_bf16 v[104:107], v[72:75], a[136:139], v[104:107]
v_mfma_f32_16x16x32_bf16 v[136:139], v[72:75], a[140:143], v[136:139]
v_mfma_f32_16x16x32_bf16 v[108:111], v[76:79], a[136:139], v[108:111]
v_mfma_f32_16x16x32_bf16 v[140:143], v[76:79], a[140:143], v[140:143]
s_waitcnt vmcnt(5)
s_bitcmp1_b32 s88, 1
s_cbranch_scc1 L_sk410
s_waitcnt vmcnt(4)
L_sk410:
buffer_load_dwordx4 v[216:219], v249, s[20:23], s45 offen offset:2048 nt
v_mov_b32 v241, 25
s_mov_b64 exec, 1
buffer_store_byte v241, v22, s[36:39], s42 offen
s_mov_b64 exec, -1
buffer_load_ushort v10, v240, s[36:39], 0 offen offset:128 nt
v_perm_b32 v82, v167, v163, s49
v_perm_b32 v83, v175, v171, s49
v_perm_b32 v86, v167, v163, s50
v_perm_b32 v87, v175, v171, s50
v_mfma_f32_16x16x32_bf16 v[112:115], v[80:83], a[136:139], v[112:115]
v_mfma_f32_16x16x32_bf16 v[144:147], v[80:83], a[140:143], v[144:147]
v_mfma_f32_16x16x32_bf16 v[116:119], v[84:87], a[136:139], v[116:119]
v_mfma_f32_16x16x32_bf16 v[148:151], v[84:87], a[140:143], v[148:151]
s_waitcnt vmcnt(7)
s_cbranch_vccnz L_sk411
s_waitcnt vmcnt(6)
L_sk411:
buffer_load_dwordx4 v[220:223], v249, s[20:23], s45 offen offset:3072 nt
v_mov_b32 v16, v42
v_mov_b32 v18, v42
s_nop 1
v_permlane32_swap_b32 v16, v18
v_pk_mul_f32 v[88:89], v[88:89], v[16:17] op_sel_hi:[1,0]
v_pk_mul_f32 v[90:91], v[90:91], v[16:17] op_sel_hi:[1,0]
v_pk_mul_f32 v[120:121], v[120:121], v[18:19] op_sel_hi:[1,0]
v_pk_mul_f32 v[122:123], v[122:123], v[18:19] op_sel_hi:[1,0]
v_pk_mul_f32 v[92:93], v[92:93], v[16:17] op_sel_hi:[1,0]
v_pk_mul_f32 v[94:95], v[94:95], v[16:17] op_sel_hi:[1,0]
v_pk_mul_f32 v[124:125], v[124:125], v[18:19] op_sel_hi:[1,0]
v_pk_mul_f32 v[126:127], v[126:127], v[18:19] op_sel_hi:[1,0]
v_perm_b32 v56, v180, v176, s49
v_perm_b32 v57, v188, v184, s49
v_perm_b32 v60, v180, v176, s50
v_perm_b32 v61, v188, v184, s50
s_add_u32 s45, s45, 32768
s_waitcnt vmcnt(6)
buffer_load_dwordx4 v[224:227], v249, s[20:23], s45 offen offset:0 nt
s_barrier
v_pk_mul_f32 v[96:97], v[96:97], v[16:17] op_sel_hi:[1,0]
v_pk_mul_f32 v[98:99], v[98:99], v[16:17] op_sel_hi:[1,0]
v_pk_mul_f32 v[128:129], v[128:129], v[18:19] op_sel_hi:[1,0]
v_pk_mul_f32 v[130:131], v[130:131], v[18:19] op_sel_hi:[1,0]
v_pk_mul_f32 v[100:101], v[100:101], v[16:17] op_sel_hi:[1,0]
v_pk_mul_f32 v[102:103], v[102:103], v[16:17] op_sel_hi:[1,0]
v_pk_mul_f32 v[132:133], v[132:133], v[18:19] op_sel_hi:[1,0]
v_pk_mul_f32 v[134:135], v[134:135], v[18:19] op_sel_hi:[1,0]
v_perm_b32 v64, v181, v177, s49
v_perm_b32 v65, v189, v185, s49
v_perm_b32 v68, v181, v177, s50
v_perm_b32 v69, v189, v185, s50
s_cbranch_vccnz L_sk413
s_waitcnt vmcnt(6)
L_sk413:
buffer_load_dwordx4 v[228:231], v249, s[20:23], s45 offen offset:1024 nt
v_pk_mul_f32 v[104:105], v[104:105], v[16:17] op_sel_hi:[1,0]
v_pk_mul_f32 v[106:107], v[106:107], v[16:17] op_sel_hi:[1,0]
v_pk_mul_f32 v[136:137], v[136:137], v[18:19] op_sel_hi:[1,0]
v_pk_mul_f32 v[138:139], v[138:139], v[18:19] op_sel_hi:[1,0]
v_pk_mul_f32 v[108:109], v[108:109], v[16:17] op_sel_hi:[1,0]
v_pk_mul_f32 v[110:111], v[110:111], v[16:17] op_sel_hi:[1,0]
v_pk_mul_f32 v[140:141], v[140:141], v[18:19] op_sel_hi:[1,0]
v_pk_mul_f32 v[142:143], v[142:143], v[18:19] op_sel_hi:[1,0]
v_perm_b32 v72, v182, v178, s49
v_perm_b32 v73, v190, v186, s49
v_perm_b32 v76, v182, v178, s50
v_perm_b32 v77, v190, v186, s50
s_waitcnt vmcnt(6)
s_bitcmp1_b32 s88, 0
s_cbranch_scc0 L_ng414
s_waitcnt vmcnt(5)
L_ng414:
buffer_load_dwordx4 v[232:235], v249, s[20:23], s45 offen offset:2048 nt
v_pk_mul_f32 v[112:113], v[112:113], v[16:17] op_sel_hi:[1,0]
v_pk_mul_f32 v[114:115], v[114:115], v[16:17] op_sel_hi:[1,0]
v_pk_mul_f32 v[144:145], v[144:145], v[18:19] op_sel_hi:[1,0]
v_pk_mul_f32 v[146:147], v[146:147], v[18:19] op_sel_hi:[1,0]
v_pk_mul_f32 v[116:117], v[116:117], v[16:17] op_sel_hi:[1,0]
v_pk_mul_f32 v[118:119], v[118:119], v[16:17] op_sel_hi:[1,0]
v_pk_mul_f32 v[148:149], v[148:149], v[18:19] op_sel_hi:[1,0]
v_pk_mul_f32 v[150:151], v[150:151], v[18:19] op_sel_hi:[1,0]
v_perm_b32 v80, v183, v179, s49
v_perm_b32 v81, v191, v187, s49
v_perm_b32 v84, v183, v179, s50
v_perm_b32 v85, v191, v187, s50
s_cbranch_vccnz L_sk415
s_waitcnt vmcnt(6)
L_sk415:
buffer_load_dwordx4 v[236:239], v249, s[20:23], s45 offen offset:3072 nt
v_perm_b32 v58, v196, v192, s49
v_perm_b32 v59, v204, v200, s49
v_perm_b32 v62, v196, v192, s50
v_perm_b32 v63, v204, v200, s50
v_mfma_f32_16x16x32_bf16 v[88:91], v[56:59], a[144:147], v[88:91]
v_mfma_f32_16x16x32_bf16 v[120:123], v[56:59], a[148:151], v[120:123]
v_mfma_f32_16x16x32_bf16 v[92:95], v[60:63], a[144:147], v[92:95]
v_mfma_f32_16x16x32_bf16 v[124:127], v[60:63], a[148:151], v[124:127]
s_add_u32 s45, s45, 32768
s_waitcnt vmcnt(4)
buffer_load_dwordx4 v[160:163], v249, s[20:23], s45 offen offset:0 nt
s_barrier
v_perm_b32 v66, v197, v193, s49
v_perm_b32 v67, v205, v201, s49
v_perm_b32 v70, v197, v193, s50
v_perm_b32 v71, v205, v201, s50
v_mfma_f32_16x16x32_bf16 v[96:99], v[64:67], a[144:147], v[96:99]
v_mfma_f32_16x16x32_bf16 v[128:131], v[64:67], a[148:151], v[128:131]
v_mfma_f32_16x16x32_bf16 v[100:103], v[68:71], a[144:147], v[100:103]
v_mfma_f32_16x16x32_bf16 v[132:135], v[68:71], a[148:151], v[132:135]
s_cbranch_vccnz L_sk417
s_waitcnt vmcnt(4)
L_sk417:
buffer_load_dwordx4 v[164:167], v249, s[20:23], s45 offen offset:1024 nt
v_perm_b32 v74, v198, v194, s49
v_perm_b32 v75, v206, v202, s49
v_perm_b32 v78, v198, v194, s50
v_perm_b32 v79, v206, v202, s50
v_mfma_f32_16x16x32_bf16 v[104:107], v[72:75], a[144:147], v[104:107]
v_mfma_f32_16x16x32_bf16 v[136:139], v[72:75], a[148:151], v[136:139]
v_mfma_f32_16x16x32_bf16 v[108:111], v[76:79], a[144:147], v[108:111]
v_mfma_f32_16x16x32_bf16 v[140:143], v[76:79], a[148:151], v[140:143]
s_waitcnt vmcnt(5)
s_bitcmp1_b32 s88, 1
s_cbranch_scc1 L_sk418
s_waitcnt vmcnt(4)
L_sk418:
buffer_load_dwordx4 v[168:171], v249, s[20:23], s45 offen offset:2048 nt
v_and_b32 v241, 0xff, v10
v_lshrrev_b32 v10, 8, v10
v_cmp_le_u32 vcc, 25, v241
v_cmp_le_u32 s[90:91], 25, v10
s_nop 0
s_bcnt1_i32_b64 s88, vcc
s_bcnt1_i32_b64 s90, s[90:91]
s_add_u32 s90, s90, s88
s_add_u32 s90, s90, s43
s_cmp_ge_u32 s90, 15
s_cselect_b32 s88, 2, 0
s_cmp_le_u32 s90, 5
s_cselect_b32 s88, 1, s88
s_cmp_ge_u32 s90, 10
s_cselect_b64 vcc, -1, 0
v_perm_b32 v82, v199, v195, s49
v_perm_b32 v83, v207, v203, s49
v_perm_b32 v86, v199, v195, s50
v_perm_b32 v87, v207, v203, s50
v_mfma_f32_16x16x32_bf16 v[112:115], v[80:83], a[144:147], v[112:115]
v_mfma_f32_16x16x32_bf16 v[144:147], v[80:83], a[148:151], v[144:147]
v_mfma_f32_16x16x32_bf16 v[116:119], v[84:87], a[144:147], v[116:119]
v_mfma_f32_16x16x32_bf16 v[148:151], v[84:87], a[148:151], v[148:151]
s_waitcnt vmcnt(5)
s_cbranch_vccnz L_sk419
s_waitcnt vmcnt(4)
L_sk419:
buffer_load_dwordx4 v[172:175], v249, s[20:23], s45 offen offset:3072 nt
v_mov_b32 v16, v43
v_mov_b32 v18, v43
s_nop 1
v_permlane32_swap_b32 v16, v18
v_pk_mul_f32 v[88:89], v[88:89], v[16:17] op_sel_hi:[1,0]
v_pk_mul_f32 v[90:91], v[90:91], v[16:17] op_sel_hi:[1,0]
v_pk_mul_f32 v[120:121], v[120:121], v[18:19] op_sel_hi:[1,0]
v_pk_mul_f32 v[122:123], v[122:123], v[18:19] op_sel_hi:[1,0]
v_pk_mul_f32 v[92:93], v[92:93], v[16:17] op_sel_hi:[1,0]
v_pk_mul_f32 v[94:95], v[94:95], v[16:17] op_sel_hi:[1,0]
v_pk_mul_f32 v[124:125], v[124:125], v[18:19] op_sel_hi:[1,0]
v_pk_mul_f32 v[126:127], v[126:127], v[18:19] op_sel_hi:[1,0]
v_perm_b32 v56, v212, v208, s49
v_perm_b32 v57, v220, v216, s49
v_perm_b32 v60, v212, v208, s50
v_perm_b32 v61, v220, v216, s50
s_add_u32 s45, s45, 32768
s_waitcnt vmcnt(4)
buffer_load_dwordx4 v[176:179], v249, s[20:23], s45 offen offset:0 nt
s_barrier
v_pk_mul_f32 v[96:97], v[96:97], v[16:17] op_sel_hi:[1,0]
v_pk_mul_f32 v[98:99], v[98:99], v[16:17] op_sel_hi:[1,0]
v_pk_mul_f32 v[128:129], v[128:129], v[18:19] op_sel_hi:[1,0]
v_pk_mul_f32 v[130:131], v[130:131], v[18:19] op_sel_hi:[1,0]
v_pk_mul_f32 v[100:101], v[100:101], v[16:17] op_sel_hi:[1,0]
v_pk_mul_f32 v[102:103], v[102:103], v[16:17] op_sel_hi:[1,0]
v_pk_mul_f32 v[132:133], v[132:133], v[18:19] op_sel_hi:[1,0]
v_pk_mul_f32 v[134:135], v[134:135], v[18:19] op_sel_hi:[1,0]
v_perm_b32 v64, v213, v209, s49
v_perm_b32 v65, v221, v217, s49
v_perm_b32 v68, v213, v209, s50
v_perm_b32 v69, v221, v217, s50
s_cbranch_vccnz L_sk421
s_waitcnt vmcnt(4)
L_sk421:
buffer_load_dwordx4 v[180:183], v249, s[20:23], s45 offen offset:1024 nt
v_pk_mul_f32 v[104:105], v[104:105], v[16:17] op_sel_hi:[1,0]
v_pk_mul_f32 v[106:107], v[106:107], v[16:17] op_sel_hi:[1,0]
v_pk_mul_f32 v[136:137], v[136:137], v[18:19] op_sel_hi:[1,0]
v_pk_mul_f32 v[138:139], v[138:139], v[18:19] op_sel_hi:[1,0]
v_pk_mul_f32 v[108:109], v[108:109], v[16:17] op_sel_hi:[1,0]
v_pk_mul_f32 v[110:111], v[110:111], v[16:17] op_sel_hi:[1,0]
v_pk_mul_f32 v[140:141], v[140:141], v[18:19] op_sel_hi:[1,0]
v_pk_mul_f32 v[142:143], v[142:143], v[18:19] op_sel_hi:[1,0]
v_perm_b32 v72, v214, v210, s49
v_perm_b32 v73, v222, v218, s49
v_perm_b32 v76, v214, v210, s50
v_perm_b32 v77, v222, v218, s50
s_waitcnt vmcnt(4)
s_bitcmp1_b32 s88, 0
s_cbranch_scc0 L_ng422
s_waitcnt vmcnt(3)
L_ng422:
buffer_load_dwordx4 v[184:187], v249, s[20:23], s45 offen offset:2048 nt
v_pk_mul_f32 v[112:113], v[112:113], v[16:17] op_sel_hi:[1,0]
v_pk_mul_f32 v[114:115], v[114:115], v[16:17] op_sel_hi:[1,0]
v_pk_mul_f32 v[144:145], v[144:145], v[18:19] op_sel_hi:[1,0]
v_pk_mul_f32 v[146:147], v[146:147], v[18:19] op_sel_hi:[1,0]
v_pk_mul_f32 v[116:117], v[116:117], v[16:17] op_sel_hi:[1,0]
v_pk_mul_f32 v[118:119], v[118:119], v[16:17] op_sel_hi:[1,0]
v_pk_mul_f32 v[148:149], v[148:149], v[18:19] op_sel_hi:[1,0]
v_pk_mul_f32 v[150:151], v[150:151], v[18:19] op_sel_hi:[1,0]
v_perm_b32 v80, v215, v211, s49
v_perm_b32 v81, v223, v219, s49
v_perm_b32 v84, v215, v211, s50
v_perm_b32 v85, v223, v219, s50
s_cbranch_vccnz L_sk423
s_waitcnt vmcnt(4)
L_sk423:
buffer_load_dwordx4 v[188:191], v249, s[20:23], s45 offen offset:3072 nt
v_perm_b32 v58, v228, v224, s49
v_perm_b32 v59, v236, v232, s49
v_perm_b32 v62, v228, v224, s50
v_perm_b32 v63, v236, v232, s50
v_mfma_f32_16x16x32_bf16 v[88:91], v[56:59], a[152:155], v[88:91]
v_mfma_f32_16x16x32_bf16 v[120:123], v[56:59], a[156:159], v[120:123]
v_mfma_f32_16x16x32_bf16 v[92:95], v[60:63], a[152:155], v[92:95]
v_mfma_f32_16x16x32_bf16 v[124:127], v[60:63], a[156:159], v[124:127]
s_add_u32 s45, s45, 32768
s_waitcnt vmcnt(4)
buffer_load_dwordx4 v[192:195], v249, s[20:23], s45 offen offset:0 nt
s_barrier
v_perm_b32 v66, v229, v225, s49
v_perm_b32 v67, v237, v233, s49
v_perm_b32 v70, v229, v225, s50
v_perm_b32 v71, v237, v233, s50
v_mfma_f32_16x16x32_bf16 v[96:99], v[64:67], a[152:155], v[96:99]
v_mfma_f32_16x16x32_bf16 v[128:131], v[64:67], a[156:159], v[128:131]
v_mfma_f32_16x16x32_bf16 v[100:103], v[68:71], a[152:155], v[100:103]
v_mfma_f32_16x16x32_bf16 v[132:135], v[68:71], a[156:159], v[132:135]
s_cbranch_vccnz L_sk425
s_waitcnt vmcnt(4)
L_sk425:
buffer_load_dwordx4 v[196:199], v249, s[20:23], s45 offen offset:1024 nt
v_perm_b32 v74, v230, v226, s49
v_perm_b32 v75, v238, v234, s49
v_perm_b32 v78, v230, v226, s50
v_perm_b32 v79, v238, v234, s50
v_mfma_f32_16x16x32_bf16 v[104:107], v[72:75], a[152:155], v[104:107]
v_mfma_f32_16x16x32_bf16 v[136:139], v[72:75], a[156:159], v[136:139]
v_mfma_f32_16x16x32_bf16 v[108:111], v[76:79], a[152:155], v[108:111]
v_mfma_f32_16x16x32_bf16 v[140:143], v[76:79], a[156:159], v[140:143]
s_waitcnt vmcnt(5)
s_bitcmp1_b32 s88, 1
s_cbranch_scc1 L_sk426
s_waitcnt vmcnt(4)
L_sk426:
buffer_load_dwordx4 v[200:203], v249, s[20:23], s45 offen offset:2048 nt
v_mov_b32 v241, 26
s_mov_b64 exec, 1
buffer_store_byte v241, v22, s[36:39], s42 offen
s_mov_b64 exec, -1
buffer_load_ushort v10, v240, s[36:39], 0 offen offset:128 nt
v_perm_b32 v82, v231, v227, s49
v_perm_b32 v83, v239, v235, s49
v_perm_b32 v86, v231, v227, s50
v_perm_b32 v87, v239, v235, s50
v_mfma_f32_16x16x32_bf16 v[112:115], v[80:83], a[152:155], v[112:115]
v_mfma_f32_16x16x32_bf16 v[144:147], v[80:83], a[156:159], v[144:147]
v_mfma_f32_16x16x32_bf16 v[116:119], v[84:87], a[152:155], v[116:119]
v_mfma_f32_16x16x32_bf16 v[148:151], v[84:87], a[156:159], v[148:151]
s_waitcnt vmcnt(7)
s_cbranch_vccnz L_sk427
s_waitcnt vmcnt(6)
L_sk427:
buffer_load_dwordx4 v[204:207], v249, s[20:23], s45 offen offset:3072 nt
v_mov_b32 v16, v44
v_mov_b32 v18, v44
s_nop 1
v_permlane32_swap_b32 v16, v18
v_pk_mul_f32 v[88:89], v[88:89], v[16:17] op_sel_hi:[1,0]
v_pk_mul_f32 v[90:91], v[90:91], v[16:17] op_sel_hi:[1,0]
v_pk_mul_f32 v[120:121], v[120:121], v[18:19] op_sel_hi:[1,0]
v_pk_mul_f32 v[122:123], v[122:123], v[18:19] op_sel_hi:[1,0]
v_pk_mul_f32 v[92:93], v[92:93], v[16:17] op_sel_hi:[1,0]
v_pk_mul_f32 v[94:95], v[94:95], v[16:17] op_sel_hi:[1,0]
v_pk_mul_f32 v[124:125], v[124:125], v[18:19] op_sel_hi:[1,0]
v_pk_mul_f32 v[126:127], v[126:127], v[18:19] op_sel_hi:[1,0]
v_perm_b32 v56, v164, v160, s49
v_perm_b32 v57, v172, v168, s49
v_perm_b32 v60, v164, v160, s50
v_perm_b32 v61, v172, v168, s50
s_add_u32 s45, s45, 32768
s_waitcnt vmcnt(6)
buffer_load_dwordx4 v[208:211], v249, s[20:23], s45 offen offset:0 nt
s_barrier
v_pk_mul_f32 v[96:97], v[96:97], v[16:17] op_sel_hi:[1,0]
v_pk_mul_f32 v[98:99], v[98:99], v[16:17] op_sel_hi:[1,0]
v_pk_mul_f32 v[128:129], v[128:129], v[18:19] op_sel_hi:[1,0]
v_pk_mul_f32 v[130:131], v[130:131], v[18:19] op_sel_hi:[1,0]
v_pk_mul_f32 v[100:101], v[100:101], v[16:17] op_sel_hi:[1,0]
v_pk_mul_f32 v[102:103], v[102:103], v[16:17] op_sel_hi:[1,0]
v_pk_mul_f32 v[132:133], v[132:133], v[18:19] op_sel_hi:[1,0]
v_pk_mul_f32 v[134:135], v[134:135], v[18:19] op_sel_hi:[1,0]
v_perm_b32 v64, v165, v161, s49
v_perm_b32 v65, v173, v169, s49
v_perm_b32 v68, v165, v161, s50
v_perm_b32 v69, v173, v169, s50
s_cbranch_vccnz L_sk429
s_waitcnt vmcnt(6)
L_sk429:
buffer_load_dwordx4 v[212:215], v249, s[20:23], s45 offen offset:1024 nt
v_pk_mul_f32 v[104:105], v[104:105], v[16:17] op_sel_hi:[1,0]
v_pk_mul_f32 v[106:107], v[106:107], v[16:17] op_sel_hi:[1,0]
v_pk_mul_f32 v[136:137], v[136:137], v[18:19] op_sel_hi:[1,0]
v_pk_mul_f32 v[138:139], v[138:139], v[18:19] op_sel_hi:[1,0]
v_pk_mul_f32 v[108:109], v[108:109], v[16:17] op_sel_hi:[1,0]
v_pk_mul_f32 v[110:111], v[110:111], v[16:17] op_sel_hi:[1,0]
v_pk_mul_f32 v[140:141], v[140:141], v[18:19] op_sel_hi:[1,0]
v_pk_mul_f32 v[142:143], v[142:143], v[18:19] op_sel_hi:[1,0]
v_perm_b32 v72, v166, v162, s49
v_perm_b32 v73, v174, v170, s49
v_perm_b32 v76, v166, v162, s50
v_perm_b32 v77, v174, v170, s50
s_waitcnt vmcnt(6)
s_bitcmp1_b32 s88, 0
s_cbranch_scc0 L_ng430
s_waitcnt vmcnt(5)
L_ng430:
buffer_load_dwordx4 v[216:219], v249, s[20:23], s45 offen offset:2048 nt
v_pk_mul_f32 v[112:113], v[112:113], v[16:17] op_sel_hi:[1,0]
v_pk_mul_f32 v[114:115], v[114:115], v[16:17] op_sel_hi:[1,0]
v_pk_mul_f32 v[144:145], v[144:145], v[18:19] op_sel_hi:[1,0]
v_pk_mul_f32 v[146:147], v[146:147], v[18:19] op_sel_hi:[1,0]
v_pk_mul_f32 v[116:117], v[116:117], v[16:17] op_sel_hi:[1,0]
v_pk_mul_f32 v[118:119], v[118:119], v[16:17] op_sel_hi:[1,0]
v_pk_mul_f32 v[148:149], v[148:149], v[18:19] op_sel_hi:[1,0]
v_pk_mul_f32 v[150:151], v[150:151], v[18:19] op_sel_hi:[1,0]
v_perm_b32 v80, v167, v163, s49
v_perm_b32 v81, v175, v171, s49
v_perm_b32 v84, v167, v163, s50
v_perm_b32 v85, v175, v171, s50
s_cbranch_vccnz L_sk431
s_waitcnt vmcnt(6)
L_sk431:
buffer_load_dwordx4 v[220:223], v249, s[20:23], s45 offen offset:3072 nt
v_perm_b32 v58, v180, v176, s49
v_perm_b32 v59, v188, v184, s49
v_perm_b32 v62, v180, v176, s50
v_perm_b32 v63, v188, v184, s50
v_mfma_f32_16x16x32_bf16 v[88:91], v[56:59], a[160:163], v[88:91]
v_mfma_f32_16x16x32_bf16 v[120:123], v[56:59], a[164:167], v[120:123]
v_mfma_f32_16x16x32_bf16 v[92:95], v[60:63], a[160:163], v[92:95]
v_mfma_f32_16x16x32_bf16 v[124:127], v[60:63], a[164:167], v[124:127]
s_add_u32 s45, s45, 32768
s_waitcnt vmcnt(4)
buffer_load_dwordx4 v[224:227], v249, s[20:23], s45 offen offset:0 nt
s_barrier
v_perm_b32 v66, v181, v177, s49
v_perm_b32 v67, v189, v185, s49
v_perm_b32 v70, v181, v177, s50
v_perm_b32 v71, v189, v185, s50
v_mfma_f32_16x16x32_bf16 v[96:99], v[64:67], a[160:163], v[96:99]
v_mfma_f32_16x16x32_bf16 v[128:131], v[64:67], a[164:167], v[128:131]
v_mfma_f32_16x16x32_bf16 v[100:103], v[68:71], a[160:163], v[100:103]
v_mfma_f32_16x16x32_bf16 v[132:135], v[68:71], a[164:167], v[132:135]
s_cbranch_vccnz L_sk433
s_waitcnt vmcnt(4)
L_sk433:
buffer_load_dwordx4 v[228:231], v249, s[20:23], s45 offen offset:1024 nt
v_perm_b32 v74, v182, v178, s49
v_perm_b32 v75, v190, v186, s49
v_perm_b32 v78, v182, v178, s50
v_perm_b32 v79, v190, v186, s50
v_mfma_f32_16x16x32_bf16 v[104:107], v[72:75], a[160:163], v[104:107]
v_mfma_f32_16x16x32_bf16 v[136:139], v[72:75], a[164:167], v[136:139]
v_mfma_f32_16x16x32_bf16 v[108:111], v[76:79], a[160:163], v[108:111]
v_mfma_f32_16x16x32_bf16 v[140:143], v[76:79], a[164:167], v[140:143]
s_waitcnt vmcnt(5)
s_bitcmp1_b32 s88, 1
s_cbranch_scc1 L_sk434
s_waitcnt vmcnt(4)
L_sk434:
buffer_load_dwordx4 v[232:235], v249, s[20:23], s45 offen offset:2048 nt
v_and_b32 v241, 0xff, v10
v_lshrrev_b32 v10, 8, v10
v_cmp_le_u32 vcc, 26, v241
v_cmp_le_u32 s[90:91], 26, v10
s_nop 0
s_bcnt1_i32_b64 s88, vcc
s_bcnt1_i32_b64 s90, s[90:91]
s_add_u32 s90, s90, s88
s_add_u32 s90, s90, s43
s_cmp_ge_u32 s90, 15
s_cselect_b32 s88, 2, 0
s_cmp_le_u32 s90, 5
s_cselect_b32 s88, 1, s88
s_cmp_ge_u32 s90, 10
s_cselect_b64 vcc, -1, 0
v_perm_b32 v82, v183, v179, s49
v_perm_b32 v83, v191, v187, s49
v_perm_b32 v86, v183, v179, s50
v_perm_b32 v87, v191, v187, s50
v_mfma_f32_16x16x32_bf16 v[112:115], v[80:83], a[160:163], v[112:115]
v_mfma_f32_16x16x32_bf16 v[144:147], v[80:83], a[164:167], v[144:147]
v_mfma_f32_16x16x32_bf16 v[116:119], v[84:87], a[160:163], v[116:119]
v_mfma_f32_16x16x32_bf16 v[148:151], v[84:87], a[164:167], v[148:151]
s_waitcnt vmcnt(5)
s_cbranch_vccnz L_sk435
s_waitcnt vmcnt(4)
L_sk435:
buffer_load_dwordx4 v[236:239], v249, s[20:23], s45 offen offset:3072 nt
v_mov_b32 v16, v45
v_mov_b32 v18, v45
s_nop 1
v_permlane32_swap_b32 v16, v18
v_pk_mul_f32 v[88:89], v[88:89], v[16:17] op_sel_hi:[1,0]
v_pk_mul_f32 v[90:91], v[90:91], v[16:17] op_sel_hi:[1,0]
v_pk_mul_f32 v[120:121], v[120:121], v[18:19] op_sel_hi:[1,0]
v_pk_mul_f32 v[122:123], v[122:123], v[18:19] op_sel_hi:[1,0]
v_pk_mul_f32 v[92:93], v[92:93], v[16:17] op_sel_hi:[1,0]
v_pk_mul_f32 v[94:95], v[94:95], v[16:17] op_sel_hi:[1,0]
v_pk_mul_f32 v[124:125], v[124:125], v[18:19] op_sel_hi:[1,0]
v_pk_mul_f32 v[126:127], v[126:127], v[18:19] op_sel_hi:[1,0]
v_perm_b32 v56, v196, v192, s49
v_perm_b32 v57, v204, v200, s49
v_perm_b32 v60, v196, v192, s50
v_perm_b32 v61, v204, v200, s50
s_add_u32 s45, s45, 32768
s_waitcnt vmcnt(4)
buffer_load_dwordx4 v[160:163], v249, s[20:23], s45 offen offset:0 nt
s_barrier
v_pk_mul_f32 v[96:97], v[96:97], v[16:17] op_sel_hi:[1,0]
v_pk_mul_f32 v[98:99], v[98:99], v[16:17] op_sel_hi:[1,0]
v_pk_mul_f32 v[128:129], v[128:129], v[18:19] op_sel_hi:[1,0]
v_pk_mul_f32 v[130:131], v[130:131], v[18:19] op_sel_hi:[1,0]
v_pk_mul_f32 v[100:101], v[100:101], v[16:17] op_sel_hi:[1,0]
v_pk_mul_f32 v[102:103], v[102:103], v[16:17] op_sel_hi:[1,0]
v_pk_mul_f32 v[132:133], v[132:133], v[18:19] op_sel_hi:[1,0]
v_pk_mul_f32 v[134:135], v[134:135], v[18:19] op_sel_hi:[1,0]
v_perm_b32 v64, v197, v193, s49
v_perm_b32 v65, v205, v201, s49
v_perm_b32 v68, v197, v193, s50
v_perm_b32 v69, v205, v201, s50
s_cbranch_vccnz L_sk437
s_waitcnt vmcnt(4)
L_sk437:
buffer_load_dwordx4 v[164:167], v249, s[20:23], s45 offen offset:1024 nt
v_pk_mul_f32 v[104:105], v[104:105], v[16:17] op_sel_hi:[1,0]
v_pk_mul_f32 v[106:107], v[106:107], v[16:17] op_sel_hi:[1,0]
v_pk_mul_f32 v[136:137], v[136:137], v[18:19] op_sel_hi:[1,0]
v_pk_mul_f32 v[138:139], v[138:139], v[18:19] op_sel_hi:[1,0]
v_pk_mul_f32 v[108:109], v[108:109], v[16:17] op_sel_hi:[1,0]
v_pk_mul_f32 v[110:111], v[110:111], v[16:17] op_sel_hi:[1,0]
v_pk_mul_f32 v[140:141], v[140:141], v[18:19] op_sel_hi:[1,0]
v_pk_mul_f32 v[142:143], v[142:143], v[18:19] op_sel_hi:[1,0]
v_perm_b32 v72, v198, v194, s49
v_perm_b32 v73, v206, v202, s49
v_perm_b32 v76, v198, v194, s50
v_perm_b32 v77, v206, v202, s50
s_waitcnt vmcnt(4)
s_bitcmp1_b32 s88, 0
s_cbranch_scc0 L_ng438
s_waitcnt vmcnt(3)
L_ng438:
buffer_load_dwordx4 v[168:171], v249, s[20:23], s45 offen offset:2048 nt
v_pk_mul_f32 v[112:113], v[112:113], v[16:17] op_sel_hi:[1,0]
v_pk_mul_f32 v[114:115], v[114:115], v[16:17] op_sel_hi:[1,0]
v_pk_mul_f32 v[144:145], v[144:145], v[18:19] op_sel_hi:[1,0]
v_pk_mul_f32 v[146:147], v[146:147], v[18:19] op_sel_hi:[1,0]
v_pk_mul_f32 v[116:117], v[116:117], v[16:17] op_sel_hi:[1,0]
v_pk_mul_f32 v[118:119], v[118:119], v[16:17] op_sel_hi:[1,0]
v_pk_mul_f32 v[148:149], v[148:149], v[18:19] op_sel_hi:[1,0]
v_pk_mul_f32 v[150:151], v[150:151], v[18:19] op_sel_hi:[1,0]
v_perm_b32 v80, v199, v195, s49
v_perm_b32 v81, v207, v203, s49
v_perm_b32 v84, v199, v195, s50
v_perm_b32 v85, v207, v203, s50
s_cbranch_vccnz L_sk439
s_waitcnt vmcnt(4)
L_sk439:
buffer_load_dwordx4 v[172:175], v249, s[20:23], s45 offen offset:3072 nt
v_perm_b32 v58, v212, v208, s49
v_perm_b32 v59, v220, v216, s49
v_perm_b32 v62, v212, v208, s50
v_perm_b32 v63, v220, v216, s50
v_mfma_f32_16x16x32_bf16 v[88:91], v[56:59], a[168:171], v[88:91]
v_mfma_f32_16x16x32_bf16 v[120:123], v[56:59], a[172:175], v[120:123]
v_mfma_f32_16x16x32_bf16 v[92:95], v[60:63], a[168:171], v[92:95]
v_mfma_f32_16x16x32_bf16 v[124:127], v[60:63], a[172:175], v[124:127]
s_add_u32 s45, s45, 32768
s_waitcnt vmcnt(4)
buffer_load_dwordx4 v[176:179], v249, s[20:23], s45 offen offset:0 nt
s_barrier
v_perm_b32 v66, v213, v209, s49
v_perm_b32 v67, v221, v217, s49
v_perm_b32 v70, v213, v209, s50
v_perm_b32 v71, v221, v217, s50
v_mfma_f32_16x16x32_bf16 v[96:99], v[64:67], a[168:171], v[96:99]
v_mfma_f32_16x16x32_bf16 v[128:131], v[64:67], a[172:175], v[128:131]
v_mfma_f32_16x16x32_bf16 v[100:103], v[68:71], a[168:171], v[100:103]
v_mfma_f32_16x16x32_bf16 v[132:135], v[68:71], a[172:175], v[132:135]
s_cbranch_vccnz L_sk441
s_waitcnt vmcnt(4)
L_sk441:
buffer_load_dwordx4 v[180:183], v249, s[20:23], s45 offen offset:1024 nt
v_perm_b32 v74, v214, v210, s49
v_perm_b32 v75, v222, v218, s49
v_perm_b32 v78, v214, v210, s50
v_perm_b32 v79, v222, v218, s50
v_mfma_f32_16x16x32_bf16 v[104:107], v[72:75], a[168:171], v[104:107]
v_mfma_f32_16x16x32_bf16 v[136:139], v[72:75], a[172:175], v[136:139]
v_mfma_f32_16x16x32_bf16 v[108:111], v[76:79], a[168:171], v[108:111]
v_mfma_f32_16x16x32_bf16 v[140:143], v[76:79], a[172:175], v[140:143]
s_waitcnt vmcnt(5)
s_bitcmp1_b32 s88, 1
s_cbranch_scc1 L_sk442
s_waitcnt vmcnt(4)
L_sk442:
buffer_load_dwordx4 v[184:187], v249, s[20:23], s45 offen offset:2048 nt
v_mov_b32 v241, 27
s_mov_b64 exec, 1
buffer_store_byte v241, v22, s[36:39], s42 offen
s_mov_b64 exec, -1
buffer_load_ushort v10, v240, s[36:39], 0 offen offset:128 nt
v_perm_b32 v82, v215, v211, s49
v_perm_b32 v83, v223, v219, s49
v_perm_b32 v86, v215, v211, s50
v_perm_b32 v87, v223, v219, s50
v_mfma_f32_16x16x32_bf16 v[112:115], v[80:83], a[168:171], v[112:115]
v_mfma_f32_16x16x32_bf16 v[144:147], v[80:83], a[172:175], v[144:147]
v_mfma_f32_16x16x32_bf16 v[116:119], v[84:87], a[168:171], v[116:119]
v_mfma_f32_16x16x32_bf16 v[148:151], v[84:87], a[172:175], v[148:151]
s_waitcnt vmcnt(7)
s_cbranch_vccnz L_sk443
s_waitcnt vmcnt(6)
L_sk443:
buffer_load_dwordx4 v[188:191], v249, s[20:23], s45 offen offset:3072 nt
v_mov_b32 v16, v46
v_mov_b32 v18, v46
s_nop 1
v_permlane32_swap_b32 v16, v18
v_pk_mul_f32 v[88:89], v[88:89], v[16:17] op_sel_hi:[1,0]
v_pk_mul_f32 v[90:91], v[90:91], v[16:17] op_sel_hi:[1,0]
v_pk_mul_f32 v[120:121], v[120:121], v[18:19] op_sel_hi:[1,0]
v_pk_mul_f32 v[122:123], v[122:123], v[18:19] op_sel_hi:[1,0]
v_pk_mul_f32 v[92:93], v[92:93], v[16:17] op_sel_hi:[1,0]
v_pk_mul_f32 v[94:95], v[94:95], v[16:17] op_sel_hi:[1,0]
v_pk_mul_f32 v[124:125], v[124:125], v[18:19] op_sel_hi:[1,0]
v_pk_mul_f32 v[126:127], v[126:127], v[18:19] op_sel_hi:[1,0]
v_perm_b32 v56, v228, v224, s49
v_perm_b32 v57, v236, v232, s49
v_perm_b32 v60, v228, v224, s50
v_perm_b32 v61, v236, v232, s50
s_add_u32 s45, s45, 32768
s_waitcnt vmcnt(6)
buffer_load_dwordx4 v[192:195], v249, s[20:23], s45 offen offset:0 nt
s_barrier
v_pk_mul_f32 v[96:97], v[96:97], v[16:17] op_sel_hi:[1,0]
v_pk_mul_f32 v[98:99], v[98:99], v[16:17] op_sel_hi:[1,0]
v_pk_mul_f32 v[128:129], v[128:129], v[18:19] op_sel_hi:[1,0]
v_pk_mul_f32 v[130:131], v[130:131], v[18:19] op_sel_hi:[1,0]
v_pk_mul_f32 v[100:101], v[100:101], v[16:17] op_sel_hi:[1,0]
v_pk_mul_f32 v[102:103], v[102:103], v[16:17] op_sel_hi:[1,0]
v_pk_mul_f32 v[132:133], v[132:133], v[18:19] op_sel_hi:[1,0]
v_pk_mul_f32 v[134:135], v[134:135], v[18:19] op_sel_hi:[1,0]
v_perm_b32 v64, v229, v225, s49
v_perm_b32 v65, v237, v233, s49
v_perm_b32 v68, v229, v225, s50
v_perm_b32 v69, v237, v233, s50
s_cbranch_vccnz L_sk445
s_waitcnt vmcnt(6)
L_sk445:
buffer_load_dwordx4 v[196:199], v249, s[20:23], s45 offen offset:1024 nt
v_pk_mul_f32 v[104:105], v[104:105], v[16:17] op_sel_hi:[1,0]
v_pk_mul_f32 v[106:107], v[106:107], v[16:17] op_sel_hi:[1,0]
v_pk_mul_f32 v[136:137], v[136:137], v[18:19] op_sel_hi:[1,0]
v_pk_mul_f32 v[138:139], v[138:139], v[18:19] op_sel_hi:[1,0]
v_pk_mul_f32 v[108:109], v[108:109], v[16:17] op_sel_hi:[1,0]
v_pk_mul_f32 v[110:111], v[110:111], v[16:17] op_sel_hi:[1,0]
v_pk_mul_f32 v[140:141], v[140:141], v[18:19] op_sel_hi:[1,0]
v_pk_mul_f32 v[142:143], v[142:143], v[18:19] op_sel_hi:[1,0]
v_perm_b32 v72, v230, v226, s49
v_perm_b32 v73, v238, v234, s49
v_perm_b32 v76, v230, v226, s50
v_perm_b32 v77, v238, v234, s50
s_waitcnt vmcnt(6)
s_bitcmp1_b32 s88, 0
s_cbranch_scc0 L_ng446
s_waitcnt vmcnt(5)
L_ng446:
buffer_load_dwordx4 v[200:203], v249, s[20:23], s45 offen offset:2048 nt
v_pk_mul_f32 v[112:113], v[112:113], v[16:17] op_sel_hi:[1,0]
v_pk_mul_f32 v[114:115], v[114:115], v[16:17] op_sel_hi:[1,0]
v_pk_mul_f32 v[144:145], v[144:145], v[18:19] op_sel_hi:[1,0]
v_pk_mul_f32 v[146:147], v[146:147], v[18:19] op_sel_hi:[1,0]
v_pk_mul_f32 v[116:117], v[116:117], v[16:17] op_sel_hi:[1,0]
v_pk_mul_f32 v[118:119], v[118:119], v[16:17] op_sel_hi:[1,0]
v_pk_mul_f32 v[148:149], v[148:149], v[18:19] op_sel_hi:[1,0]
v_pk_mul_f32 v[150:151], v[150:151], v[18:19] op_sel_hi:[1,0]
v_perm_b32 v80, v231, v227, s49
v_perm_b32 v81, v239, v235, s49
v_perm_b32 v84, v231, v227, s50
v_perm_b32 v85, v239, v235, s50
s_cbranch_vccnz L_sk447
s_waitcnt vmcnt(6)
L_sk447:
buffer_load_dwordx4 v[204:207], v249, s[20:23], s45 offen offset:3072 nt
v_perm_b32 v58, v164, v160, s49
v_perm_b32 v59, v172, v168, s49
v_perm_b32 v62, v164, v160, s50
v_perm_b32 v63, v172, v168, s50
v_mfma_f32_16x16x32_bf16 v[88:91], v[56:59], a[176:179], v[88:91]
v_mfma_f32_16x16x32_bf16 v[120:123], v[56:59], a[180:183], v[120:123]
v_mfma_f32_16x16x32_bf16 v[92:95], v[60:63], a[176:179], v[92:95]
v_mfma_f32_16x16x32_bf16 v[124:127], v[60:63], a[180:183], v[124:127]
s_add_u32 s45, s45, 32768
s_waitcnt vmcnt(4)
buffer_load_dwordx4 v[208:211], v249, s[20:23], s45 offen offset:0 nt
s_barrier
v_perm_b32 v66, v165, v161, s49
v_perm_b32 v67, v173, v169, s49
v_perm_b32 v70, v165, v161, s50
v_perm_b32 v71, v173, v169, s50
v_mfma_f32_16x16x32_bf16 v[96:99], v[64:67], a[176:179], v[96:99]
v_mfma_f32_16x16x32_bf16 v[128:131], v[64:67], a[180:183], v[128:131]
v_mfma_f32_16x16x32_bf16 v[100:103], v[68:71], a[176:179], v[100:103]
v_mfma_f32_16x16x32_bf16 v[132:135], v[68:71], a[180:183], v[132:135]
s_cbranch_vccnz L_sk449
s_waitcnt vmcnt(4)
L_sk449:
buffer_load_dwordx4 v[212:215], v249, s[20:23], s45 offen offset:1024 nt
v_perm_b32 v74, v166, v162, s49
v_perm_b32 v75, v174, v170, s49
v_perm_b32 v78, v166, v162, s50
v_perm_b32 v79, v174, v170, s50
v_mfma_f32_16x16x32_bf16 v[104:107], v[72:75], a[176:179], v[104:107]
v_mfma_f32_16x16x32_bf16 v[136:139], v[72:75], a[180:183], v[136:139]
v_mfma_f32_16x16x32_bf16 v[108:111], v[76:79], a[176:179], v[108:111]
v_mfma_f32_16x16x32_bf16 v[140:143], v[76:79], a[180:183], v[140:143]
s_waitcnt vmcnt(5)
s_bitcmp1_b32 s88, 1
s_cbranch_scc1 L_sk450
s_waitcnt vmcnt(4)
L_sk450:
buffer_load_dwordx4 v[216:219], v249, s[20:23], s45 offen offset:2048 nt
v_and_b32 v241, 0xff, v10
v_lshrrev_b32 v10, 8, v10
v_cmp_le_u32 vcc, 27, v241
v_cmp_le_u32 s[90:91], 27, v10
s_nop 0
s_bcnt1_i32_b64 s88, vcc
s_bcnt1_i32_b64 s90, s[90:91]
s_add_u32 s90, s90, s88
s_add_u32 s90, s90, s43
s_cmp_ge_u32 s90, 15
s_cselect_b32 s88, 2, 0
s_cmp_le_u32 s90, 5
s_cselect_b32 s88, 1, s88
s_cmp_ge_u32 s90, 10
s_cselect_b64 vcc, -1, 0
v_perm_b32 v82, v167, v163, s49
v_perm_b32 v83, v175, v171, s49
v_perm_b32 v86, v167, v163, s50
v_perm_b32 v87, v175, v171, s50
v_mfma_f32_16x16x32_bf16 v[112:115], v[80:83], a[176:179], v[112:115]
v_mfma_f32_16x16x32_bf16 v[144:147], v[80:83], a[180:183], v[144:147]
v_mfma_f32_16x16x32_bf16 v[116:119], v[84:87], a[176:179], v[116:119]
v_mfma_f32_16x16x32_bf16 v[148:151], v[84:87], a[180:183], v[148:151]
s_waitcnt vmcnt(5)
s_cbranch_vccnz L_sk451
s_waitcnt vmcnt(4)
L_sk451:
buffer_load_dwordx4 v[220:223], v249, s[20:23], s45 offen offset:3072 nt
v_mov_b32 v16, v47
v_mov_b32 v18, v47
s_nop 1
v_permlane32_swap_b32 v16, v18
v_pk_mul_f32 v[88:89], v[88:89], v[16:17] op_sel_hi:[1,0]
v_pk_mul_f32 v[90:91], v[90:91], v[16:17] op_sel_hi:[1,0]
v_pk_mul_f32 v[120:121], v[120:121], v[18:19] op_sel_hi:[1,0]
v_pk_mul_f32 v[122:123], v[122:123], v[18:19] op_sel_hi:[1,0]
v_pk_mul_f32 v[92:93], v[92:93], v[16:17] op_sel_hi:[1,0]
v_pk_mul_f32 v[94:95], v[94:95], v[16:17] op_sel_hi:[1,0]
v_pk_mul_f32 v[124:125], v[124:125], v[18:19] op_sel_hi:[1,0]
v_pk_mul_f32 v[126:127], v[126:127], v[18:19] op_sel_hi:[1,0]
v_perm_b32 v56, v180, v176, s49
v_perm_b32 v57, v188, v184, s49
v_perm_b32 v60, v180, v176, s50
v_perm_b32 v61, v188, v184, s50
s_add_u32 s45, s45, 32768
s_waitcnt vmcnt(4)
buffer_load_dwordx4 v[224:227], v249, s[20:23], s45 offen offset:0 nt
s_barrier
v_pk_mul_f32 v[96:97], v[96:97], v[16:17] op_sel_hi:[1,0]
v_pk_mul_f32 v[98:99], v[98:99], v[16:17] op_sel_hi:[1,0]
v_pk_mul_f32 v[128:129], v[128:129], v[18:19] op_sel_hi:[1,0]
v_pk_mul_f32 v[130:131], v[130:131], v[18:19] op_sel_hi:[1,0]
v_pk_mul_f32 v[100:101], v[100:101], v[16:17] op_sel_hi:[1,0]
v_pk_mul_f32 v[102:103], v[102:103], v[16:17] op_sel_hi:[1,0]
v_pk_mul_f32 v[132:133], v[132:133], v[18:19] op_sel_hi:[1,0]
v_pk_mul_f32 v[134:135], v[134:135], v[18:19] op_sel_hi:[1,0]
v_perm_b32 v64, v181, v177, s49
v_perm_b32 v65, v189, v185, s49
v_perm_b32 v68, v181, v177, s50
v_perm_b32 v69, v189, v185, s50
s_cbranch_vccnz L_sk453
s_waitcnt vmcnt(4)
L_sk453:
buffer_load_dwordx4 v[228:231], v249, s[20:23], s45 offen offset:1024 nt
v_pk_mul_f32 v[104:105], v[104:105], v[16:17] op_sel_hi:[1,0]
v_pk_mul_f32 v[106:107], v[106:107], v[16:17] op_sel_hi:[1,0]
v_pk_mul_f32 v[136:137], v[136:137], v[18:19] op_sel_hi:[1,0]
v_pk_mul_f32 v[138:139], v[138:139], v[18:19] op_sel_hi:[1,0]
v_pk_mul_f32 v[108:109], v[108:109], v[16:17] op_sel_hi:[1,0]
v_pk_mul_f32 v[110:111], v[110:111], v[16:17] op_sel_hi:[1,0]
v_pk_mul_f32 v[140:141], v[140:141], v[18:19] op_sel_hi:[1,0]
v_pk_mul_f32 v[142:143], v[142:143], v[18:19] op_sel_hi:[1,0]
v_perm_b32 v72, v182, v178, s49
v_perm_b32 v73, v190, v186, s49
v_perm_b32 v76, v182, v178, s50
v_perm_b32 v77, v190, v186, s50
s_waitcnt vmcnt(4)
s_bitcmp1_b32 s88, 0
s_cbranch_scc0 L_ng454
s_waitcnt vmcnt(3)
L_ng454:
buffer_load_dwordx4 v[232:235], v249, s[20:23], s45 offen offset:2048 nt
v_pk_mul_f32 v[112:113], v[112:113], v[16:17] op_sel_hi:[1,0]
v_pk_mul_f32 v[114:115], v[114:115], v[16:17] op_sel_hi:[1,0]
v_pk_mul_f32 v[144:145], v[144:145], v[18:19] op_sel_hi:[1,0]
v_pk_mul_f32 v[146:147], v[146:147], v[18:19] op_sel_hi:[1,0]
v_pk_mul_f32 v[116:117], v[116:117], v[16:17] op_sel_hi:[1,0]
v_pk_mul_f32 v[118:119], v[118:119], v[16:17] op_sel_hi:[1,0]
v_pk_mul_f32 v[148:149], v[148:149], v[18:19] op_sel_hi:[1,0]
v_pk_mul_f32 v[150:151], v[150:151], v[18:19] op_sel_hi:[1,0]
v_perm_b32 v80, v183, v179, s49
v_perm_b32 v81, v191, v187, s49
v_perm_b32 v84, v183, v179, s50
v_perm_b32 v85, v191, v187, s50
s_cbranch_vccnz L_sk455
s_waitcnt vmcnt(4)
L_sk455:
buffer_load_dwordx4 v[236:239], v249, s[20:23], s45 offen offset:3072 nt
v_perm_b32 v58, v196, v192, s49
v_perm_b32 v59, v204, v200, s49
v_perm_b32 v62, v196, v192, s50
v_perm_b32 v63, v204, v200, s50
v_mfma_f32_16x16x32_bf16 v[88:91], v[56:59], a[184:187], v[88:91]
v_mfma_f32_16x16x32_bf16 v[120:123], v[56:59], a[188:191], v[120:123]
v_mfma_f32_16x16x32_bf16 v[92:95], v[60:63], a[184:187], v[92:95]
v_mfma_f32_16x16x32_bf16 v[124:127], v[60:63], a[188:191], v[124:127]
s_add_u32 s45, s45, 32768
s_waitcnt vmcnt(4)
buffer_load_dwordx4 v[160:163], v249, s[20:23], s45 offen offset:0 nt
s_barrier
v_perm_b32 v66, v197, v193, s49
v_perm_b32 v67, v205, v201, s49
v_perm_b32 v70, v197, v193, s50
v_perm_b32 v71, v205, v201, s50
v_mfma_f32_16x16x32_bf16 v[96:99], v[64:67], a[184:187], v[96:99]
v_mfma_f32_16x16x32_bf16 v[128:131], v[64:67], a[188:191], v[128:131]
v_mfma_f32_16x16x32_bf16 v[100:103], v[68:71], a[184:187], v[100:103]
v_mfma_f32_16x16x32_bf16 v[132:135], v[68:71], a[188:191], v[132:135]
s_cbranch_vccnz L_sk457
s_waitcnt vmcnt(4)
L_sk457:
buffer_load_dwordx4 v[164:167], v249, s[20:23], s45 offen offset:1024 nt
v_perm_b32 v74, v198, v194, s49
v_perm_b32 v75, v206, v202, s49
v_perm_b32 v78, v198, v194, s50
v_perm_b32 v79, v206, v202, s50
v_mfma_f32_16x16x32_bf16 v[104:107], v[72:75], a[184:187], v[104:107]
v_mfma_f32_16x16x32_bf16 v[136:139], v[72:75], a[188:191], v[136:139]
v_mfma_f32_16x16x32_bf16 v[108:111], v[76:79], a[184:187], v[108:111]
v_mfma_f32_16x16x32_bf16 v[140:143], v[76:79], a[188:191], v[140:143]
s_waitcnt vmcnt(5)
s_bitcmp1_b32 s88, 1
s_cbranch_scc1 L_sk458
s_waitcnt vmcnt(4)
L_sk458:
buffer_load_dwordx4 v[168:171], v249, s[20:23], s45 offen offset:2048 nt
v_mov_b32 v241, 28
s_mov_b64 exec, 1
buffer_store_byte v241, v22, s[36:39], s42 offen
s_mov_b64 exec, -1
buffer_load_ushort v10, v240, s[36:39], 0 offen offset:128 nt
v_perm_b32 v82, v199, v195, s49
v_perm_b32 v83, v207, v203, s49
v_perm_b32 v86, v199, v195, s50
v_perm_b32 v87, v207, v203, s50
v_mfma_f32_16x16x32_bf16 v[112:115], v[80:83], a[184:187], v[112:115]
v_mfma_f32_16x16x32_bf16 v[144:147], v[80:83], a[188:191], v[144:147]
v_mfma_f32_16x16x32_bf16 v[116:119], v[84:87], a[184:187], v[116:119]
v_mfma_f32_16x16x32_bf16 v[148:151], v[84:87], a[188:191], v[148:151]
s_waitcnt vmcnt(7)
s_cbranch_vccnz L_sk459
s_waitcnt vmcnt(6)
L_sk459:
buffer_load_dwordx4 v[172:175], v249, s[20:23], s45 offen offset:3072 nt
v_mov_b32 v16, v48
v_mov_b32 v18, v48
s_nop 1
v_permlane32_swap_b32 v16, v18
v_pk_mul_f32 v[88:89], v[88:89], v[16:17] op_sel_hi:[1,0]
v_pk_mul_f32 v[90:91], v[90:91], v[16:17] op_sel_hi:[1,0]
v_pk_mul_f32 v[120:121], v[120:121], v[18:19] op_sel_hi:[1,0]
v_pk_mul_f32 v[122:123], v[122:123], v[18:19] op_sel_hi:[1,0]
v_pk_mul_f32 v[92:93], v[92:93], v[16:17] op_sel_hi:[1,0]
v_pk_mul_f32 v[94:95], v[94:95], v[16:17] op_sel_hi:[1,0]
v_pk_mul_f32 v[124:125], v[124:125], v[18:19] op_sel_hi:[1,0]
v_pk_mul_f32 v[126:127], v[126:127], v[18:19] op_sel_hi:[1,0]
v_perm_b32 v56, v212, v208, s49
v_perm_b32 v57, v220, v216, s49
v_perm_b32 v60, v212, v208, s50
v_perm_b32 v61, v220, v216, s50
s_add_u32 s45, s45, 32768
s_waitcnt vmcnt(6)
buffer_load_dwordx4 v[176:179], v249, s[20:23], s45 offen offset:0 nt
s_barrier
v_pk_mul_f32 v[96:97], v[96:97], v[16:17] op_sel_hi:[1,0]
v_pk_mul_f32 v[98:99], v[98:99], v[16:17] op_sel_hi:[1,0]
v_pk_mul_f32 v[128:129], v[128:129], v[18:19] op_sel_hi:[1,0]
v_pk_mul_f32 v[130:131], v[130:131], v[18:19] op_sel_hi:[1,0]
v_pk_mul_f32 v[100:101], v[100:101], v[16:17] op_sel_hi:[1,0]
v_pk_mul_f32 v[102:103], v[102:103], v[16:17] op_sel_hi:[1,0]
v_pk_mul_f32 v[132:133], v[132:133], v[18:19] op_sel_hi:[1,0]
v_pk_mul_f32 v[134:135], v[134:135], v[18:19] op_sel_hi:[1,0]
v_perm_b32 v64, v213, v209, s49
v_perm_b32 v65, v221, v217, s49
v_perm_b32 v68, v213, v209, s50
v_perm_b32 v69, v221, v217, s50
s_cbranch_vccnz L_sk461
s_waitcnt vmcnt(6)
L_sk461:
buffer_load_dwordx4 v[180:183], v249, s[20:23], s45 offen offset:1024 nt
v_pk_mul_f32 v[104:105], v[104:105], v[16:17] op_sel_hi:[1,0]
v_pk_mul_f32 v[106:107], v[106:107], v[16:17] op_sel_hi:[1,0]
v_pk_mul_f32 v[136:137], v[136:137], v[18:19] op_sel_hi:[1,0]
v_pk_mul_f32 v[138:139], v[138:139], v[18:19] op_sel_hi:[1,0]
v_pk_mul_f32 v[108:109], v[108:109], v[16:17] op_sel_hi:[1,0]
v_pk_mul_f32 v[110:111], v[110:111], v[16:17] op_sel_hi:[1,0]
v_pk_mul_f32 v[140:141], v[140:141], v[18:19] op_sel_hi:[1,0]
v_pk_mul_f32 v[142:143], v[142:143], v[18:19] op_sel_hi:[1,0]
v_perm_b32 v72, v214, v210, s49
v_perm_b32 v73, v222, v218, s49
v_perm_b32 v76, v214, v210, s50
v_perm_b32 v77, v222, v218, s50
s_waitcnt vmcnt(6)
s_bitcmp1_b32 s88, 0
s_cbranch_scc0 L_ng462
s_waitcnt vmcnt(5)
L_ng462:
buffer_load_dwordx4 v[184:187], v249, s[20:23], s45 offen offset:2048 nt
v_pk_mul_f32 v[112:113], v[112:113], v[16:17] op_sel_hi:[1,0]
v_pk_mul_f32 v[114:115], v[114:115], v[16:17] op_sel_hi:[1,0]
v_pk_mul_f32 v[144:145], v[144:145], v[18:19] op_sel_hi:[1,0]
v_pk_mul_f32 v[146:147], v[146:147], v[18:19] op_sel_hi:[1,0]
v_pk_mul_f32 v[116:117], v[116:117], v[16:17] op_sel_hi:[1,0]
v_pk_mul_f32 v[118:119], v[118:119], v[16:17] op_sel_hi:[1,0]
v_pk_mul_f32 v[148:149], v[148:149], v[18:19] op_sel_hi:[1,0]
v_pk_mul_f32 v[150:151], v[150:151], v[18:19] op_sel_hi:[1,0]
v_perm_b32 v80, v215, v211, s49
v_perm_b32 v81, v223, v219, s49
v_perm_b32 v84, v215, v211, s50
v_perm_b32 v85, v223, v219, s50
s_cbranch_vccnz L_sk463
s_waitcnt vmcnt(6)
L_sk463:
buffer_load_dwordx4 v[188:191], v249, s[20:23], s45 offen offset:3072 nt
v_perm_b32 v58, v228, v224, s49
v_perm_b32 v59, v236, v232, s49
v_perm_b32 v62, v228, v224, s50
v_perm_b32 v63, v236, v232, s50
v_mfma_f32_16x16x32_bf16 v[88:91], v[56:59], a[192:195], v[88:91]
v_mfma_f32_16x16x32_bf16 v[120:123], v[56:59], a[196:199], v[120:123]
v_mfma_f32_16x16x32_bf16 v[92:95], v[60:63], a[192:195], v[92:95]
v_mfma_f32_16x16x32_bf16 v[124:127], v[60:63], a[196:199], v[124:127]
s_add_u32 s45, s45, 32768
s_waitcnt vmcnt(4)
buffer_load_dwordx4 v[192:195], v249, s[20:23], s45 offen offset:0 nt
s_barrier
v_perm_b32 v66, v229, v225, s49
v_perm_b32 v67, v237, v233, s49
v_perm_b32 v70, v229, v225, s50
v_perm_b32 v71, v237, v233, s50
v_mfma_f32_16x16x32_bf16 v[96:99], v[64:67], a[192:195], v[96:99]
v_mfma_f32_16x16x32_bf16 v[128:131], v[64:67], a[196:199], v[128:131]
v_mfma_f32_16x16x32_bf16 v[100:103], v[68:71], a[192:195], v[100:103]
v_mfma_f32_16x16x32_bf16 v[132:135], v[68:71], a[196:199], v[132:135]
s_cbranch_vccnz L_sk465
s_waitcnt vmcnt(4)
L_sk465:
buffer_load_dwordx4 v[196:199], v249, s[20:23], s45 offen offset:1024 nt
v_perm_b32 v74, v230, v226, s49
v_perm_b32 v75, v238, v234, s49
v_perm_b32 v78, v230, v226, s50
v_perm_b32 v79, v238, v234, s50
v_mfma_f32_16x16x32_bf16 v[104:107], v[72:75], a[192:195], v[104:107]
v_mfma_f32_16x16x32_bf16 v[136:139], v[72:75], a[196:199], v[136:139]
v_mfma_f32_16x16x32_bf16 v[108:111], v[76:79], a[192:195], v[108:111]
v_mfma_f32_16x16x32_bf16 v[140:143], v[76:79], a[196:199], v[140:143]
s_waitcnt vmcnt(5)
s_bitcmp1_b32 s88, 1
s_cbranch_scc1 L_sk466
s_waitcnt vmcnt(4)
L_sk466:
buffer_load_dwordx4 v[200:203], v249, s[20:23], s45 offen offset:2048 nt
v_and_b32 v241, 0xff, v10
v_lshrrev_b32 v10, 8, v10
v_cmp_le_u32 vcc, 28, v241
v_cmp_le_u32 s[90:91], 28, v10
s_nop 0
s_bcnt1_i32_b64 s88, vcc
s_bcnt1_i32_b64 s90, s[90:91]
s_add_u32 s90, s90, s88
s_add_u32 s90, s90, s43
s_cmp_ge_u32 s90, 15
s_cselect_b32 s88, 2, 0
s_cmp_le_u32 s90, 5
s_cselect_b32 s88, 1, s88
s_cmp_ge_u32 s90, 10
s_cselect_b64 vcc, -1, 0
v_perm_b32 v82, v231, v227, s49
v_perm_b32 v83, v239, v235, s49
v_perm_b32 v86, v231, v227, s50
v_perm_b32 v87, v239, v235, s50
v_mfma_f32_16x16x32_bf16 v[112:115], v[80:83], a[192:195], v[112:115]
v_mfma_f32_16x16x32_bf16 v[144:147], v[80:83], a[196:199], v[144:147]
v_mfma_f32_16x16x32_bf16 v[116:119], v[84:87], a[192:195], v[116:119]
v_mfma_f32_16x16x32_bf16 v[148:151], v[84:87], a[196:199], v[148:151]
s_waitcnt vmcnt(5)
s_cbranch_vccnz L_sk467
s_waitcnt vmcnt(4)
L_sk467:
buffer_load_dwordx4 v[204:207], v249, s[20:23], s45 offen offset:3072 nt
v_mov_b32 v16, v49
v_mov_b32 v18, v49
s_nop 1
v_permlane32_swap_b32 v16, v18
v_pk_mul_f32 v[88:89], v[88:89], v[16:17] op_sel_hi:[1,0]
v_pk_mul_f32 v[90:91], v[90:91], v[16:17] op_sel_hi:[1,0]
v_pk_mul_f32 v[120:121], v[120:121], v[18:19] op_sel_hi:[1,0]
v_pk_mul_f32 v[122:123], v[122:123], v[18:19] op_sel_hi:[1,0]
v_pk_mul_f32 v[92:93], v[92:93], v[16:17] op_sel_hi:[1,0]
v_pk_mul_f32 v[94:95], v[94:95], v[16:17] op_sel_hi:[1,0]
v_pk_mul_f32 v[124:125], v[124:125], v[18:19] op_sel_hi:[1,0]
v_pk_mul_f32 v[126:127], v[126:127], v[18:19] op_sel_hi:[1,0]
v_perm_b32 v56, v164, v160, s49
v_perm_b32 v57, v172, v168, s49
v_perm_b32 v60, v164, v160, s50
v_perm_b32 v61, v172, v168, s50
s_add_u32 s45, s45, 32768
s_waitcnt vmcnt(4)
buffer_load_dwordx4 v[208:211], v249, s[20:23], s45 offen offset:0 nt
s_barrier
v_pk_mul_f32 v[96:97], v[96:97], v[16:17] op_sel_hi:[1,0]
v_pk_mul_f32 v[98:99], v[98:99], v[16:17] op_sel_hi:[1,0]
v_pk_mul_f32 v[128:129], v[128:129], v[18:19] op_sel_hi:[1,0]
v_pk_mul_f32 v[130:131], v[130:131], v[18:19] op_sel_hi:[1,0]
v_pk_mul_f32 v[100:101], v[100:101], v[16:17] op_sel_hi:[1,0]
v_pk_mul_f32 v[102:103], v[102:103], v[16:17] op_sel_hi:[1,0]
v_pk_mul_f32 v[132:133], v[132:133], v[18:19] op_sel_hi:[1,0]
v_pk_mul_f32 v[134:135], v[134:135], v[18:19] op_sel_hi:[1,0]
v_perm_b32 v64, v165, v161, s49
v_perm_b32 v65, v173, v169, s49
v_perm_b32 v68, v165, v161, s50
v_perm_b32 v69, v173, v169, s50
s_cbranch_vccnz L_sk469
s_waitcnt vmcnt(4)
L_sk469:
buffer_load_dwordx4 v[212:215], v249, s[20:23], s45 offen offset:1024 nt
v_pk_mul_f32 v[104:105], v[104:105], v[16:17] op_sel_hi:[1,0]
v_pk_mul_f32 v[106:107], v[106:107], v[16:17] op_sel_hi:[1,0]
v_pk_mul_f32 v[136:137], v[136:137], v[18:19] op_sel_hi:[1,0]
v_pk_mul_f32 v[138:139], v[138:139], v[18:19] op_sel_hi:[1,0]
v_pk_mul_f32 v[108:109], v[108:109], v[16:17] op_sel_hi:[1,0]
v_pk_mul_f32 v[110:111], v[110:111], v[16:17] op_sel_hi:[1,0]
v_pk_mul_f32 v[140:141], v[140:141], v[18:19] op_sel_hi:[1,0]
v_pk_mul_f32 v[142:143], v[142:143], v[18:19] op_sel_hi:[1,0]
v_perm_b32 v72, v166, v162, s49
v_perm_b32 v73, v174, v170, s49
v_perm_b32 v76, v166, v162, s50
v_perm_b32 v77, v174, v170, s50
s_waitcnt vmcnt(4)
s_bitcmp1_b32 s88, 0
s_cbranch_scc0 L_ng470
s_waitcnt vmcnt(3)
L_ng470:
buffer_load_dwordx4 v[216:219], v249, s[20:23], s45 offen offset:2048 nt
v_pk_mul_f32 v[112:113], v[112:113], v[16:17] op_sel_hi:[1,0]
v_pk_mul_f32 v[114:115], v[114:115], v[16:17] op_sel_hi:[1,0]
v_pk_mul_f32 v[144:145], v[144:145], v[18:19] op_sel_hi:[1,0]
v_pk_mul_f32 v[146:147], v[146:147], v[18:19] op_sel_hi:[1,0]
v_pk_mul_f32 v[116:117], v[116:117], v[16:17] op_sel_hi:[1,0]
v_pk_mul_f32 v[118:119], v[118:119], v[16:17] op_sel_hi:[1,0]
v_pk_mul_f32 v[148:149], v[148:149], v[18:19] op_sel_hi:[1,0]
v_pk_mul_f32 v[150:151], v[150:151], v[18:19] op_sel_hi:[1,0]
v_perm_b32 v80, v167, v163, s49
v_perm_b32 v81, v175, v171, s49
v_perm_b32 v84, v167, v163, s50
v_perm_b32 v85, v175, v171, s50
s_cbranch_vccnz L_sk471
s_waitcnt vmcnt(4)
L_sk471:
buffer_load_dwordx4 v[220:223], v249, s[20:23], s45 offen offset:3072 nt
v_perm_b32 v58, v180, v176, s49
v_perm_b32 v59, v188, v184, s49
v_perm_b32 v62, v180, v176, s50
v_perm_b32 v63, v188, v184, s50
v_mfma_f32_16x16x32_bf16 v[88:91], v[56:59], a[200:203], v[88:91]
v_mfma_f32_16x16x32_bf16 v[120:123], v[56:59], a[204:207], v[120:123]
v_mfma_f32_16x16x32_bf16 v[92:95], v[60:63], a[200:203], v[92:95]
v_mfma_f32_16x16x32_bf16 v[124:127], v[60:63], a[204:207], v[124:127]
s_add_u32 s45, s45, 32768
s_waitcnt vmcnt(4)
buffer_load_dwordx4 v[224:227], v249, s[20:23], s45 offen offset:0 nt
v_mov_b32 v241, 29
s_mov_b64 exec, 1
buffer_store_byte v241, v22, s[36:39], s42 offen
s_mov_b64 exec, -1
buffer_load_ushort v10, v240, s[36:39], 0 offen offset:128 nt
s_barrier
v_perm_b32 v66, v181, v177, s49
v_perm_b32 v67, v189, v185, s49
v_perm_b32 v70, v181, v177, s50
v_perm_b32 v71, v189, v185, s50
v_mfma_f32_16x16x32_bf16 v[96:99], v[64:67], a[200:203], v[96:99]
v_mfma_f32_16x16x32_bf16 v[128:131], v[64:67], a[204:207], v[128:131]
v_mfma_f32_16x16x32_bf16 v[100:103], v[68:71], a[200:203], v[100:103]
v_mfma_f32_16x16x32_bf16 v[132:135], v[68:71], a[204:207], v[132:135]
s_cbranch_vccnz L_sk473
s_waitcnt vmcnt(6)
L_sk473:
buffer_load_dwordx4 v[228:231], v249, s[20:23], s45 offen offset:1024 nt
v_perm_b32 v74, v182, v178, s49
v_perm_b32 v75, v190, v186, s49
v_perm_b32 v78, v182, v178, s50
v_perm_b32 v79, v190, v186, s50
v_mfma_f32_16x16x32_bf16 v[104:107], v[72:75], a[200:203], v[104:107]
v_mfma_f32_16x16x32_bf16 v[136:139], v[72:75], a[204:207], v[136:139]
v_mfma_f32_16x16x32_bf16 v[108:111], v[76:79], a[200:203], v[108:111]
v_mfma_f32_16x16x32_bf16 v[140:143], v[76:79], a[204:207], v[140:143]
s_waitcnt vmcnt(7)
s_bitcmp1_b32 s88, 1
s_cbranch_scc1 L_sk474
s_waitcnt vmcnt(6)
L_sk474:
buffer_load_dwordx4 v[232:235], v249, s[20:23], s45 offen offset:2048 nt
v_perm_b32 v82, v183, v179, s49
v_perm_b32 v83, v191, v187, s49
v_perm_b32 v86, v183, v179, s50
v_perm_b32 v87, v191, v187, s50
v_mfma_f32_16x16x32_bf16 v[112:115], v[80:83], a[200:203], v[112:115]
v_mfma_f32_16x16x32_bf16 v[144:147], v[80:83], a[204:207], v[144:147]
v_mfma_f32_16x16x32_bf16 v[116:119], v[84:87], a[200:203], v[116:119]
v_mfma_f32_16x16x32_bf16 v[148:151], v[84:87], a[204:207], v[148:151]
s_waitcnt vmcnt(7)
s_cbranch_vccnz L_sk475
s_waitcnt vmcnt(6)
L_sk475:
buffer_load_dwordx4 v[236:239], v249, s[20:23], s45 offen offset:3072 nt
v_mov_b32 v16, v50
v_mov_b32 v18, v50
s_nop 1
v_permlane32_swap_b32 v16, v18
v_pk_mul_f32 v[88:89], v[88:89], v[16:17] op_sel_hi:[1,0]
v_pk_mul_f32 v[90:91], v[90:91], v[16:17] op_sel_hi:[1,0]
v_pk_mul_f32 v[120:121], v[120:121], v[18:19] op_sel_hi:[1,0]
v_pk_mul_f32 v[122:123], v[122:123], v[18:19] op_sel_hi:[1,0]
v_pk_mul_f32 v[92:93], v[92:93], v[16:17] op_sel_hi:[1,0]
v_pk_mul_f32 v[94:95], v[94:95], v[16:17] op_sel_hi:[1,0]
v_pk_mul_f32 v[124:125], v[124:125], v[18:19] op_sel_hi:[1,0]
v_pk_mul_f32 v[126:127], v[126:127], v[18:19] op_sel_hi:[1,0]
v_perm_b32 v56, v196, v192, s49
v_perm_b32 v57, v204, v200, s49
v_perm_b32 v60, v196, v192, s50
v_perm_b32 v61, v204, v200, s50
s_add_u32 s45, s45, 32768
s_waitcnt vmcnt(6)
buffer_load_dwordx4 v[160:163], v249, s[20:23], s45 offen offset:0 nt
s_barrier
v_pk_mul_f32 v[96:97], v[96:97], v[16:17] op_sel_hi:[1,0]
v_pk_mul_f32 v[98:99], v[98:99], v[16:17] op_sel_hi:[1,0]
v_pk_mul_f32 v[128:129], v[128:129], v[18:19] op_sel_hi:[1,0]
v_pk_mul_f32 v[130:131], v[130:131], v[18:19] op_sel_hi:[1,0]
v_pk_mul_f32 v[100:101], v[100:101], v[16:17] op_sel_hi:[1,0]
v_pk_mul_f32 v[102:103], v[102:103], v[16:17] op_sel_hi:[1,0]
v_pk_mul_f32 v[132:133], v[132:133], v[18:19] op_sel_hi:[1,0]
v_pk_mul_f32 v[134:135], v[134:135], v[18:19] op_sel_hi:[1,0]
v_perm_b32 v64, v197, v193, s49
v_perm_b32 v65, v205, v201, s49
v_perm_b32 v68, v197, v193, s50
v_perm_b32 v69, v205, v201, s50
s_cbranch_vccnz L_sk477
s_waitcnt vmcnt(6)
L_sk477:
buffer_load_dwordx4 v[164:167], v249, s[20:23], s45 offen offset:1024 nt
v_pk_mul_f32 v[104:105], v[104:105], v[16:17] op_sel_hi:[1,0]
v_pk_mul_f32 v[106:107], v[106:107], v[16:17] op_sel_hi:[1,0]
v_pk_mul_f32 v[136:137], v[136:137], v[18:19] op_sel_hi:[1,0]
v_pk_mul_f32 v[138:139], v[138:139], v[18:19] op_sel_hi:[1,0]
v_pk_mul_f32 v[108:109], v[108:109], v[16:17] op_sel_hi:[1,0]
v_pk_mul_f32 v[110:111], v[110:111], v[16:17] op_sel_hi:[1,0]
v_pk_mul_f32 v[140:141], v[140:141], v[18:19] op_sel_hi:[1,0]
v_pk_mul_f32 v[142:143], v[142:143], v[18:19] op_sel_hi:[1,0]
v_perm_b32 v72, v198, v194, s49
v_perm_b32 v73, v206, v202, s49
v_perm_b32 v76, v198, v194, s50
v_perm_b32 v77, v206, v202, s50
s_waitcnt vmcnt(4)
s_bitcmp1_b32 s88, 0
s_cbranch_scc0 L_ng478
s_waitcnt vmcnt(3)
L_ng478:
buffer_load_dwordx4 v[168:171], v249, s[20:23], s45 offen offset:2048 nt
v_pk_mul_f32 v[112:113], v[112:113], v[16:17] op_sel_hi:[1,0]
v_pk_mul_f32 v[114:115], v[114:115], v[16:17] op_sel_hi:[1,0]
v_pk_mul_f32 v[144:145], v[144:145], v[18:19] op_sel_hi:[1,0]
v_pk_mul_f32 v[146:147], v[146:147], v[18:19] op_sel_hi:[1,0]
v_pk_mul_f32 v[116:117], v[116:117], v[16:17] op_sel_hi:[1,0]
v_pk_mul_f32 v[118:119], v[118:119], v[16:17] op_sel_hi:[1,0]
v_pk_mul_f32 v[148:149], v[148:149], v[18:19] op_sel_hi:[1,0]
v_pk_mul_f32 v[150:151], v[150:151], v[18:19] op_sel_hi:[1,0]
v_perm_b32 v80, v199, v195, s49
v_perm_b32 v81, v207, v203, s49
v_perm_b32 v84, v199, v195, s50
v_perm_b32 v85, v207, v203, s50
s_cbranch_vccnz L_sk479
s_waitcnt vmcnt(4)
L_sk479:
buffer_load_dwordx4 v[172:175], v249, s[20:23], s45 offen offset:3072 nt
v_and_b32 v241, 0xff, v10
v_lshrrev_b32 v10, 8, v10
v_cmp_le_u32 vcc, 29, v241
v_cmp_le_u32 s[90:91], 29, v10
s_nop 0
s_bcnt1_i32_b64 s88, vcc
s_bcnt1_i32_b64 s90, s[90:91]
s_add_u32 s90, s90, s88
s_add_u32 s90, s90, s43
s_cmp_ge_u32 s90, 18
s_cselect_b32 s88, 2, 0
s_cmp_le_u32 s90, 10
s_cselect_b32 s88, 1, s88
s_cmp_ge_u32 s90, 15
s_cselect_b64 vcc, -1, 0
v_perm_b32 v58, v212, v208, s49
v_perm_b32 v59, v220, v216, s49
v_perm_b32 v62, v212, v208, s50
v_perm_b32 v63, v220, v216, s50
v_mfma_f32_16x16x32_bf16 v[88:91], v[56:59], a[208:211], v[88:91]
v_mfma_f32_16x16x32_bf16 v[120:123], v[56:59], a[212:215], v[120:123]
v_mfma_f32_16x16x32_bf16 v[92:95], v[60:63], a[208:211], v[92:95]
v_mfma_f32_16x16x32_bf16 v[124:127], v[60:63], a[212:215], v[124:127]
s_add_u32 s45, s45, 32768
s_waitcnt vmcnt(4)
buffer_load_dwordx2 v[176:177], v242, s[20:23], s45 offen offset:0 nt
v_perm_b32 v66, v213, v209, s49
v_perm_b32 v67, v221, v217, s49
v_perm_b32 v70, v213, v209, s50
v_perm_b32 v71, v221, v217, s50
v_mfma_f32_16x16x32_bf16 v[96:99], v[64:67], a[208:211], v[96:99]
v_mfma_f32_16x16x32_bf16 v[128:131], v[64:67], a[212:215], v[128:131]
v_mfma_f32_16x16x32_bf16 v[100:103], v[68:71], a[208:211], v[100:103]
v_mfma_f32_16x16x32_bf16 v[132:135], v[68:71], a[212:215], v[132:135]
buffer_load_dwordx2 v[178:179], v242, s[20:23], s45 offen offset:1024 nt
v_perm_b32 v74, v214, v210, s49
v_perm_b32 v75, v222, v218, s49
v_perm_b32 v78, v214, v210, s50
v_perm_b32 v79, v222, v218, s50
v_mfma_f32_16x16x32_bf16 v[104:107], v[72:75], a[208:211], v[104:107]
v_mfma_f32_16x16x32_bf16 v[136:139], v[72:75], a[212:215], v[136:139]
v_mfma_f32_16x16x32_bf16 v[108:111], v[76:79], a[208:211], v[108:111]
v_mfma_f32_16x16x32_bf16 v[140:143], v[76:79], a[212:215], v[140:143]
s_waitcnt vmcnt(5)
buffer_load_dwordx2 v[180:181], v242, s[20:23], s45 offen offset:2048 nt
v_perm_b32 v82, v215, v211, s49
v_perm_b32 v83, v223, v219, s49
v_perm_b32 v86, v215, v211, s50
v_perm_b32 v87, v223, v219, s50
v_mfma_f32_16x16x32_bf16 v[112:115], v[80:83], a[208:211], v[112:115]
v_mfma_f32_16x16x32_bf16 v[144:147], v[80:83], a[212:215], v[144:147]
v_mfma_f32_16x16x32_bf16 v[116:119], v[84:87], a[208:211], v[116:119]
v_mfma_f32_16x16x32_bf16 v[148:151], v[84:87], a[212:215], v[148:151]
buffer_load_dwordx2 v[182:183], v242, s[20:23], s45 offen offset:3072 nt
v_mov_b32 v16, v51
v_mov_b32 v18, v51
s_nop 1
v_permlane32_swap_b32 v16, v18
v_pk_mul_f32 v[88:89], v[88:89], v[16:17] op_sel_hi:[1,0]
v_pk_mul_f32 v[90:91], v[90:91], v[16:17] op_sel_hi:[1,0]
v_pk_mul_f32 v[120:121], v[120:121], v[18:19] op_sel_hi:[1,0]
v_pk_mul_f32 v[122:123], v[122:123], v[18:19] op_sel_hi:[1,0]
v_pk_mul_f32 v[92:93], v[92:93], v[16:17] op_sel_hi:[1,0]
v_pk_mul_f32 v[94:95], v[94:95], v[16:17] op_sel_hi:[1,0]
v_pk_mul_f32 v[124:125], v[124:125], v[18:19] op_sel_hi:[1,0]
v_pk_mul_f32 v[126:127], v[126:127], v[18:19] op_sel_hi:[1,0]
v_perm_b32 v56, v228, v224, s49
v_perm_b32 v57, v236, v232, s49
v_perm_b32 v60, v228, v224, s50
v_perm_b32 v61, v236, v232, s50
s_add_u32 s45, s45, 32768
s_waitcnt vmcnt(6)
buffer_load_dwordx2 v[184:185], v242, s[20:23], s45 offen offset:0 nt
v_pk_mul_f32 v[96:97], v[96:97], v[16:17] op_sel_hi:[1,0]
v_pk_mul_f32 v[98:99], v[98:99], v[16:17] op_sel_hi:[1,0]
v_pk_mul_f32 v[128:129], v[128:129], v[18:19] op_sel_hi:[1,0]
v_pk_mul_f32 v[130:131], v[130:131], v[18:19] op_sel_hi:[1,0]
v_pk_mul_f32 v[100:101], v[100:101], v[16:17] op_sel_hi:[1,0]
v_pk_mul_f32 v[102:103], v[102:103], v[16:17] op_sel_hi:[1,0]
v_pk_mul_f32 v[132:133], v[132:133], v[18:19] op_sel_hi:[1,0]
v_pk_mul_f32 v[134:135], v[134:135], v[18:19] op_sel_hi:[1,0]
v_perm_b32 v64, v229, v225, s49
v_perm_b32 v65, v237, v233, s49
v_perm_b32 v68, v229, v225, s50
v_perm_b32 v69, v237, v233, s50
buffer_load_dwordx2 v[186:187], v242, s[20:23], s45 offen offset:1024 nt
v_pk_mul_f32 v[104:105], v[104:105], v[16:17] op_sel_hi:[1,0]
v_pk_mul_f32 v[106:107], v[106:107], v[16:17] op_sel_hi:[1,0]
v_pk_mul_f32 v[136:137], v[136:137], v[18:19] op_sel_hi:[1,0]
v_pk_mul_f32 v[138:139], v[138:139], v[18:19] op_sel_hi:[1,0]
v_pk_mul_f32 v[108:109], v[108:109], v[16:17] op_sel_hi:[1,0]
v_pk_mul_f32 v[110:111], v[110:111], v[16:17] op_sel_hi:[1,0]
v_pk_mul_f32 v[140:141], v[140:141], v[18:19] op_sel_hi:[1,0]
v_pk_mul_f32 v[142:143], v[142:143], v[18:19] op_sel_hi:[1,0]
v_perm_b32 v72, v230, v226, s49
v_perm_b32 v73, v238, v234, s49
v_perm_b32 v76, v230, v226, s50
v_perm_b32 v77, v238, v234, s50
s_bitcmp1_b32 s88, 1
s_cbranch_scc1 L_x486
s_waitcnt vmcnt(8)
s_cbranch_vccnz L_x486
s_waitcnt vmcnt(7)
s_bitcmp1_b32 s88, 0
s_cbranch_scc0 L_x486
s_waitcnt vmcnt(6)
L_x486:
buffer_load_dwordx2 v[188:189], v242, s[20:23], s45 offen offset:2048 nt
v_pk_mul_f32 v[112:113], v[112:113], v[16:17] op_sel_hi:[1,0]
v_pk_mul_f32 v[114:115], v[114:115], v[16:17] op_sel_hi:[1,0]
v_pk_mul_f32 v[144:145], v[144:145], v[18:19] op_sel_hi:[1,0]
v_pk_mul_f32 v[146:147], v[146:147], v[18:19] op_sel_hi:[1,0]
v_pk_mul_f32 v[116:117], v[116:117], v[16:17] op_sel_hi:[1,0]
v_pk_mul_f32 v[118:119], v[118:119], v[16:17] op_sel_hi:[1,0]
v_pk_mul_f32 v[148:149], v[148:149], v[18:19] op_sel_hi:[1,0]
v_pk_mul_f32 v[150:151], v[150:151], v[18:19] op_sel_hi:[1,0]
v_perm_b32 v80, v231, v227, s49
v_perm_b32 v81, v239, v235, s49
v_perm_b32 v84, v231, v227, s50
v_perm_b32 v85, v239, v235, s50
s_bitcmp1_b32 s88, 1
s_cbranch_scc1 L_x487
s_waitcnt vmcnt(9)
s_cbranch_vccnz L_x487
s_waitcnt vmcnt(8)
s_bitcmp1_b32 s88, 0
s_cbranch_scc0 L_x487
s_waitcnt vmcnt(7)
L_x487:
buffer_load_dwordx2 v[190:191], v242, s[20:23], s45 offen offset:3072 nt
s_add_u32 s45, s45, 32768
s_bitcmp1_b32 s88, 1
s_cbranch_scc1 L_x488
s_waitcnt vmcnt(9)
s_cbranch_vccnz L_x488
s_waitcnt vmcnt(8)
s_bitcmp1_b32 s88, 0
s_cbranch_scc0 L_x488
s_waitcnt vmcnt(7)
L_x488:
buffer_load_dwordx2 v[192:193], v242, s[20:23], s45 offen offset:0 nt
v_mov_b32 v241, 30
s_mov_b64 exec, 1
buffer_store_byte v241, v22, s[36:39], s42 offen
s_mov_b64 exec, -1
buffer_load_ushort v10, v240, s[36:39], 0 offen offset:128 nt
s_bitcmp1_b32 s88, 1
s_cbranch_scc1 L_x489
s_waitcnt vmcnt(12)
s_cbranch_vccnz L_x489
s_waitcnt vmcnt(11)
s_bitcmp1_b32 s88, 0
s_cbranch_scc0 L_x489
s_waitcnt vmcnt(10)
L_x489:
buffer_load_dwordx2 v[194:195], v242, s[20:23], s45 offen offset:1024 nt
s_waitcnt vmcnt(13)
s_bitcmp1_b32 s88, 1
s_cbranch_scc1 L_x490
s_waitcnt vmcnt(12)
s_cbranch_vccnz L_x490
s_waitcnt vmcnt(11)
s_bitcmp1_b32 s88, 0
s_cbranch_scc0 L_x490
s_waitcnt vmcnt(10)
L_x490:
buffer_load_dwordx2 v[196:197], v242, s[20:23], s45 offen offset:2048 nt
s_waitcnt vmcnt(13)
s_bitcmp1_b32 s88, 1
s_cbranch_scc1 L_x491
s_waitcnt vmcnt(12)
s_cbranch_vccnz L_x491
s_waitcnt vmcnt(11)
s_bitcmp1_b32 s88, 0
s_cbranch_scc0 L_x491
s_waitcnt vmcnt(10)
L_x491:
buffer_load_dwordx2 v[198:199], v242, s[20:23], s45 offen offset:3072 nt
v_perm_b32 v58, v164, v160, s49
v_perm_b32 v59, v172, v168, s49
v_perm_b32 v62, v164, v160, s50
v_perm_b32 v63, v172, v168, s50
v_mfma_f32_16x16x32_bf16 v[88:91], v[56:59], a[216:219], v[88:91]
v_mfma_f32_16x16x32_bf16 v[120:123], v[56:59], a[220:223], v[120:123]
v_mfma_f32_16x16x32_bf16 v[92:95], v[60:63], a[216:219], v[92:95]
v_mfma_f32_16x16x32_bf16 v[124:127], v[60:63], a[220:223], v[124:127]
s_add_u32 s45, s45, 32768
s_waitcnt vmcnt(13)
s_bitcmp1_b32 s88, 1
s_cbranch_scc1 L_x492
s_waitcnt vmcnt(12)
s_cbranch_vccnz L_x492
s_waitcnt vmcnt(11)
s_bitcmp1_b32 s88, 0
s_cbranch_scc0 L_x492
s_waitcnt vmcnt(10)
L_x492:
buffer_load_dwordx2 v[200:201], v242, s[20:23], s45 offen offset:0 nt
v_perm_b32 v66, v165, v161, s49
v_perm_b32 v67, v173, v169, s49
v_perm_b32 v70, v165, v161, s50
v_perm_b32 v71, v173, v169, s50
v_mfma_f32_16x16x32_bf16 v[96:99], v[64:67], a[216:219], v[96:99]
v_mfma_f32_16x16x32_bf16 v[128:131], v[64:67], a[220:223], v[128:131]
v_mfma_f32_16x16x32_bf16 v[100:103], v[68:71], a[216:219], v[100:103]
v_mfma_f32_16x16x32_bf16 v[132:135], v[68:71], a[220:223], v[132:135]
s_waitcnt vmcnt(13)
s_bitcmp1_b32 s88, 1
s_cbranch_scc1 L_x493
s_waitcnt vmcnt(12)
s_cbranch_vccnz L_x493
s_waitcnt vmcnt(11)
s_bitcmp1_b32 s88, 0
s_cbranch_scc0 L_x493
s_waitcnt vmcnt(10)
L_x493:
buffer_load_dwordx2 v[202:203], v242, s[20:23], s45 offen offset:1024 nt
v_perm_b32 v74, v166, v162, s49
v_perm_b32 v75, v174, v170, s49
v_perm_b32 v78, v166, v162, s50
v_perm_b32 v79, v174, v170, s50
v_mfma_f32_16x16x32_bf16 v[104:107], v[72:75], a[216:219], v[104:107]
v_mfma_f32_16x16x32_bf16 v[136:139], v[72:75], a[220:223], v[136:139]
v_mfma_f32_16x16x32_bf16 v[108:111], v[76:79], a[216:219], v[108:111]
v_mfma_f32_16x16x32_bf16 v[140:143], v[76:79], a[220:223], v[140:143]
s_waitcnt vmcnt(13)
s_bitcmp1_b32 s88, 1
s_cbranch_scc1 L_x494
s_waitcnt vmcnt(12)
s_cbranch_vccnz L_x494
s_waitcnt vmcnt(11)
s_bitcmp1_b32 s88, 0
s_cbranch_scc0 L_x494
s_waitcnt vmcnt(10)
L_x494:
buffer_load_dwordx2 v[204:205], v242, s[20:23], s45 offen offset:2048 nt
v_perm_b32 v82, v167, v163, s49
v_perm_b32 v83, v175, v171, s49
v_perm_b32 v86, v167, v163, s50
v_perm_b32 v87, v175, v171, s50
v_mfma_f32_16x16x32_bf16 v[112:115], v[80:83], a[216:219], v[112:115]
v_mfma_f32_16x16x32_bf16 v[144:147], v[80:83], a[220:223], v[144:147]
v_mfma_f32_16x16x32_bf16 v[116:119], v[84:87], a[216:219], v[116:119]
v_mfma_f32_16x16x32_bf16 v[148:151], v[84:87], a[220:223], v[148:151]
s_waitcnt vmcnt(13)
s_bitcmp1_b32 s88, 1
s_cbranch_scc1 L_x495
s_waitcnt vmcnt(12)
s_cbranch_vccnz L_x495
s_waitcnt vmcnt(11)
s_bitcmp1_b32 s88, 0
s_cbranch_scc0 L_x495
s_waitcnt vmcnt(10)
L_x495:
buffer_load_dwordx2 v[206:207], v242, s[20:23], s45 offen offset:3072 nt
v_mov_b32 v16, v52
v_mov_b32 v18, v52
s_nop 1
v_permlane32_swap_b32 v16, v18
v_permlane32_swap_b32 v88, v104
v_permlane32_swap_b32 v89, v105
v_permlane32_swap_b32 v90, v106
v_permlane32_swap_b32 v91, v107
v_permlane32_swap_b32 v120, v136
v_permlane32_swap_b32 v121, v137
v_permlane32_swap_b32 v122, v138
v_permlane32_swap_b32 v123, v139
v_pk_mul_f32 v[104:105], v[104:105], v[16:17] op_sel_hi:[1,0]
v_pk_mul_f32 v[106:107], v[106:107], v[16:17] op_sel_hi:[1,0]
v_pk_mul_f32 v[136:137], v[136:137], v[18:19] op_sel_hi:[1,0]
v_pk_mul_f32 v[138:139], v[138:139], v[18:19] op_sel_hi:[1,0]
v_perm_b32 v56, v178, v176, s49
v_perm_b32 v57, v182, v180, s49
s_add_u32 s45, s45, 32768
s_waitcnt vmcnt(13)
s_bitcmp1_b32 s88, 1
s_cbranch_scc1 L_x496
s_waitcnt vmcnt(12)
s_cbranch_vccnz L_x496
s_waitcnt vmcnt(11)
s_bitcmp1_b32 s88, 0
s_cbranch_scc0 L_x496
s_waitcnt vmcnt(10)
L_x496:
buffer_load_dwordx2 v[208:209], v242, s[20:23], s45 offen offset:0 nt
v_permlane32_swap_b32 v92, v108
v_permlane32_swap_b32 v93, v109
v_permlane32_swap_b32 v94, v110
v_permlane32_swap_b32 v95, v111
v_permlane32_swap_b32 v124, v140
v_permlane32_swap_b32 v125, v141
v_permlane32_swap_b32 v126, v142
v_permlane32_swap_b32 v127, v143
v_pk_mul_f32 v[108:109], v[108:109], v[16:17] op_sel_hi:[1,0]
v_pk_mul_f32 v[110:111], v[110:111], v[16:17] op_sel_hi:[1,0]
v_pk_mul_f32 v[140:141], v[140:141], v[18:19] op_sel_hi:[1,0]
v_pk_mul_f32 v[142:143], v[142:143], v[18:19] op_sel_hi:[1,0]
v_perm_b32 v60, v178, v176, s50
v_perm_b32 v61, v182, v180, s50
s_waitcnt vmcnt(13)
s_bitcmp1_b32 s88, 1
s_cbranch_scc1 L_x497
s_waitcnt vmcnt(12)
s_cbranch_vccnz L_x497
s_waitcnt vmcnt(11)
s_bitcmp1_b32 s88, 0
s_cbranch_scc0 L_x497
s_waitcnt vmcnt(10)
L_x497:
buffer_load_dwordx2 v[210:211], v242, s[20:23], s45 offen offset:1024 nt
v_permlane32_swap_b32 v96, v112
v_permlane32_swap_b32 v97, v113
v_permlane32_swap_b32 v98, v114
v_permlane32_swap_b32 v99, v115
v_permlane32_swap_b32 v128, v144
v_permlane32_swap_b32 v129, v145
v_permlane32_swap_b32 v130, v146
v_permlane32_swap_b32 v131, v147
v_pk_mul_f32 v[112:113], v[112:113], v[16:17] op_sel_hi:[1,0]
v_pk_mul_f32 v[114:115], v[114:115], v[16:17] op_sel_hi:[1,0]
v_pk_mul_f32 v[144:145], v[144:145], v[18:19] op_sel_hi:[1,0]
v_pk_mul_f32 v[146:147], v[146:147], v[18:19] op_sel_hi:[1,0]
v_perm_b32 v64, v179, v177, s49
v_perm_b32 v65, v183, v181, s49
s_waitcnt vmcnt(13)
s_bitcmp1_b32 s88, 1
s_cbranch_scc1 L_x498
s_waitcnt vmcnt(12)
s_cbranch_vccnz L_x498
s_waitcnt vmcnt(11)
s_bitcmp1_b32 s88, 0
s_cbranch_scc0 L_x498
s_waitcnt vmcnt(8)
L_x498:
buffer_load_dwordx2 v[212:213], v242, s[20:23], s45 offen offset:2048 nt
v_permlane32_swap_b32 v100, v116
v_permlane32_swap_b32 v101, v117
v_permlane32_swap_b32 v102, v118
v_permlane32_swap_b32 v103, v119
v_permlane32_swap_b32 v132, v148
v_permlane32_swap_b32 v133, v149
v_permlane32_swap_b32 v134, v150
v_permlane32_swap_b32 v135, v151
v_pk_mul_f32 v[116:117], v[116:117], v[16:17] op_sel_hi:[1,0]
v_pk_mul_f32 v[118:119], v[118:119], v[16:17] op_sel_hi:[1,0]
v_pk_mul_f32 v[148:149], v[148:149], v[18:19] op_sel_hi:[1,0]
v_pk_mul_f32 v[150:151], v[150:151], v[18:19] op_sel_hi:[1,0]
v_perm_b32 v68, v179, v177, s50
v_perm_b32 v69, v183, v181, s50
s_waitcnt vmcnt(13)
s_bitcmp1_b32 s88, 1
s_cbranch_scc1 L_x499
s_waitcnt vmcnt(12)
s_cbranch_vccnz L_x499
s_waitcnt vmcnt(9)
s_bitcmp1_b32 s88, 0
s_cbranch_scc0 L_x499
s_waitcnt vmcnt(8)
L_x499:
buffer_load_dwordx2 v[214:215], v242, s[20:23], s45 offen offset:3072 nt
v_perm_b32 v58, v186, v184, s49
v_perm_b32 v59, v190, v188, s49
s_nop 1
v_mfma_f32_16x16x32_bf16 v[104:107], v[56:59], a[224:227], v[104:107]
v_mfma_f32_16x16x32_bf16 v[136:139], v[56:59], a[228:231], v[136:139]
s_add_u32 s45, s45, 32768
s_waitcnt vmcnt(13)
s_bitcmp1_b32 s88, 1
s_cbranch_scc1 L_x500
s_waitcnt vmcnt(10)
s_cbranch_vccnz L_x500
s_waitcnt vmcnt(9)
s_bitcmp1_b32 s88, 0
s_cbranch_scc0 L_x500
s_waitcnt vmcnt(8)
L_x500:
buffer_load_dwordx2 v[216:217], v242, s[20:23], s45 offen offset:0 nt
v_perm_b32 v62, v186, v184, s50
v_perm_b32 v63, v190, v188, s50
s_nop 1
v_mfma_f32_16x16x32_bf16 v[108:111], v[60:63], a[224:227], v[108:111]
v_mfma_f32_16x16x32_bf16 v[140:143], v[60:63], a[228:231], v[140:143]
s_waitcnt vmcnt(11)
s_bitcmp1_b32 s88, 1
s_cbranch_scc1 L_x501
s_waitcnt vmcnt(10)
s_cbranch_vccnz L_x501
s_waitcnt vmcnt(9)
s_bitcmp1_b32 s88, 0
s_cbranch_scc0 L_x501
s_waitcnt vmcnt(8)
L_x501:
buffer_load_dwordx2 v[218:219], v242, s[20:23], s45 offen offset:1024 nt
v_and_b32 v241, 0xff, v10
v_lshrrev_b32 v10, 8, v10
v_cmp_le_u32 vcc, 30, v241
v_cmp_le_u32 s[90:91], 30, v10
s_nop 0
s_bcnt1_i32_b64 s88, vcc
s_bcnt1_i32_b64 s90, s[90:91]
s_add_u32 s90, s90, s88
s_add_u32 s90, s90, s43
s_cmp_ge_u32 s90, 18
s_cselect_b32 s88, 2, 0
s_cmp_le_u32 s90, 10
s_cselect_b32 s88, 1, s88
s_cmp_ge_u32 s90, 15
s_cselect_b64 vcc, -1, 0
v_perm_b32 v66, v187, v185, s49
v_perm_b32 v67, v191, v189, s49
s_nop 1
v_mfma_f32_16x16x32_bf16 v[112:115], v[64:67], a[224:227], v[112:115]
v_mfma_f32_16x16x32_bf16 v[144:147], v[64:67], a[228:231], v[144:147]
s_waitcnt vmcnt(11)
s_bitcmp1_b32 s88, 1
s_cbranch_scc1 L_x502
s_waitcnt vmcnt(10)
s_cbranch_vccnz L_x502
s_waitcnt vmcnt(9)
s_bitcmp1_b32 s88, 0
s_cbranch_scc0 L_x502
s_waitcnt vmcnt(8)
L_x502:
buffer_load_dwordx2 v[220:221], v242, s[20:23], s45 offen offset:2048 nt
v_perm_b32 v70, v187, v185, s50
v_perm_b32 v71, v191, v189, s50
s_nop 1
v_mfma_f32_16x16x32_bf16 v[116:119], v[68:71], a[224:227], v[116:119]
v_mfma_f32_16x16x32_bf16 v[148:151], v[68:71], a[228:231], v[148:151]
s_waitcnt vmcnt(11)
s_bitcmp1_b32 s88, 1
s_cbranch_scc1 L_x503
s_waitcnt vmcnt(10)
s_cbranch_vccnz L_x503
s_waitcnt vmcnt(9)
s_bitcmp1_b32 s88, 0
s_cbranch_scc0 L_x503
s_waitcnt vmcnt(8)
L_x503:
buffer_load_dwordx2 v[222:223], v242, s[20:23], s45 offen offset:3072 nt
v_mov_b32 v16, v53
v_mov_b32 v18, v53
s_nop 1
v_permlane32_swap_b32 v16, v18
v_pk_mul_f32 v[104:105], v[104:105], v[16:17] op_sel_hi:[1,0]
v_pk_mul_f32 v[106:107], v[106:107], v[16:17] op_sel_hi:[1,0]
v_pk_mul_f32 v[136:137], v[136:137], v[18:19] op_sel_hi:[1,0]
v_pk_mul_f32 v[138:139], v[138:139], v[18:19] op_sel_hi:[1,0]
v_perm_b32 v56, v194, v192, s49
v_perm_b32 v57, v198, v196, s49
s_add_u32 s45, s45, 32768
s_waitcnt vmcnt(11)
s_bitcmp1_b32 s88, 1
s_cbranch_scc1 L_x504
s_waitcnt vmcnt(10)
s_cbranch_vccnz L_x504
s_waitcnt vmcnt(9)
s_bitcmp1_b32 s88, 0
s_cbranch_scc0 L_x504
s_waitcnt vmcnt(8)
L_x504:
buffer_load_dwordx2 v[224:225], v242, s[20:23], s45 offen offset:0 nt
v_pk_mul_f32 v[108:109], v[108:109], v[16:17] op_sel_hi:[1,0]
v_pk_mul_f32 v[110:111], v[110:111], v[16:17] op_sel_hi:[1,0]
v_pk_mul_f32 v[140:141], v[140:141], v[18:19] op_sel_hi:[1,0]
v_pk_mul_f32 v[142:143], v[142:143], v[18:19] op_sel_hi:[1,0]
v_perm_b32 v60, v194, v192, s50
v_perm_b32 v61, v198, v196, s50
s_waitcnt vmcnt(11)
s_bitcmp1_b32 s88, 1
s_cbranch_scc1 L_x505
s_waitcnt vmcnt(10)
s_cbranch_vccnz L_x505
s_waitcnt vmcnt(9)
s_bitcmp1_b32 s88, 0
s_cbranch_scc0 L_x505
s_waitcnt vmcnt(8)
L_x505:
buffer_load_dwordx2 v[226:227], v242, s[20:23], s45 offen offset:1024 nt
v_pk_mul_f32 v[112:113], v[112:113], v[16:17] op_sel_hi:[1,0]
v_pk_mul_f32 v[114:115], v[114:115], v[16:17] op_sel_hi:[1,0]
v_pk_mul_f32 v[144:145], v[144:145], v[18:19] op_sel_hi:[1,0]
v_pk_mul_f32 v[146:147], v[146:147], v[18:19] op_sel_hi:[1,0]
v_perm_b32 v64, v195, v193, s49
v_perm_b32 v65, v199, v197, s49
s_waitcnt vmcnt(11)
s_bitcmp1_b32 s88, 1
s_cbranch_scc1 L_x506
s_waitcnt vmcnt(10)
s_cbranch_vccnz L_x506
s_waitcnt vmcnt(9)
s_bitcmp1_b32 s88, 0
s_cbranch_scc0 L_x506
s_waitcnt vmcnt(8)
L_x506:
buffer_load_dwordx2 v[228:229], v242, s[20:23], s45 offen offset:2048 nt
v_pk_mul_f32 v[116:117], v[116:117], v[16:17] op_sel_hi:[1,0]
v_pk_mul_f32 v[118:119], v[118:119], v[16:17] op_sel_hi:[1,0]
v_pk_mul_f32 v[148:149], v[148:149], v[18:19] op_sel_hi:[1,0]
v_pk_mul_f32 v[150:151], v[150:151], v[18:19] op_sel_hi:[1,0]
v_perm_b32 v68, v195, v193, s50
v_perm_b32 v69, v199, v197, s50
s_waitcnt vmcnt(11)
s_bitcmp1_b32 s88, 1
s_cbranch_scc1 L_x507
s_waitcnt vmcnt(10)
s_cbranch_vccnz L_x507
s_waitcnt vmcnt(9)
s_bitcmp1_b32 s88, 0
s_cbranch_scc0 L_x507
s_waitcnt vmcnt(8)
L_x507:
buffer_load_dwordx2 v[230:231], v242, s[20:23], s45 offen offset:3072 nt
v_perm_b32 v58, v202, v200, s49
v_perm_b32 v59, v206, v204, s49
s_nop 1
v_mfma_f32_16x16x32_bf16 v[104:107], v[56:59], a[232:235], v[104:107]
v_mfma_f32_16x16x32_bf16 v[136:139], v[56:59], a[236:239], v[136:139]
s_add_u32 s45, s45, 32768
s_waitcnt vmcnt(11)
s_bitcmp1_b32 s88, 1
s_cbranch_scc1 L_x508
s_waitcnt vmcnt(10)
s_cbranch_vccnz L_x508
s_waitcnt vmcnt(9)
s_bitcmp1_b32 s88, 0
s_cbranch_scc0 L_x508
s_waitcnt vmcnt(8)
L_x508:
buffer_load_dwordx2 v[232:233], v242, s[20:23], s45 offen offset:0 nt
v_perm_b32 v62, v202, v200, s50
v_perm_b32 v63, v206, v204, s50
s_nop 1
v_mfma_f32_16x16x32_bf16 v[108:111], v[60:63], a[232:235], v[108:111]
v_mfma_f32_16x16x32_bf16 v[140:143], v[60:63], a[236:239], v[140:143]
s_waitcnt vmcnt(11)
s_bitcmp1_b32 s88, 1
s_cbranch_scc1 L_x509
s_waitcnt vmcnt(10)
s_cbranch_vccnz L_x509
s_waitcnt vmcnt(9)
s_bitcmp1_b32 s88, 0
s_cbranch_scc0 L_x509
s_waitcnt vmcnt(8)
L_x509:
buffer_load_dwordx2 v[234:235], v242, s[20:23], s45 offen offset:1024 nt
v_perm_b32 v66, v203, v201, s49
v_perm_b32 v67, v207, v205, s49
s_nop 1
v_mfma_f32_16x16x32_bf16 v[112:115], v[64:67], a[232:235], v[112:115]
v_mfma_f32_16x16x32_bf16 v[144:147], v[64:67], a[236:239], v[144:147]
s_waitcnt vmcnt(11)
s_bitcmp1_b32 s88, 1
s_cbranch_scc1 L_x510
s_waitcnt vmcnt(10)
s_cbranch_vccnz L_x510
s_waitcnt vmcnt(9)
s_bitcmp1_b32 s88, 0
s_cbranch_scc0 L_x510
s_waitcnt vmcnt(8)
L_x510:
buffer_load_dwordx2 v[236:237], v242, s[20:23], s45 offen offset:2048 nt
v_perm_b32 v70, v203, v201, s50
v_perm_b32 v71, v207, v205, s50
s_nop 1
v_mfma_f32_16x16x32_bf16 v[116:119], v[68:71], a[232:235], v[116:119]
v_mfma_f32_16x16x32_bf16 v[148:151], v[68:71], a[236:239], v[148:151]
s_waitcnt vmcnt(11)
s_bitcmp1_b32 s88, 1
s_cbranch_scc1 L_x511
s_waitcnt vmcnt(10)
s_cbranch_vccnz L_x511
s_waitcnt vmcnt(9)
s_bitcmp1_b32 s88, 0
s_cbranch_scc0 L_x511
s_waitcnt vmcnt(8)
L_x511:
buffer_load_dwordx2 v[238:239], v242, s[20:23], s45 offen offset:3072 nt
v_mov_b32 v16, v54
v_mov_b32 v18, v54
s_nop 1
v_permlane32_swap_b32 v16, v18
v_pk_mul_f32 v[104:105], v[104:105], v[16:17] op_sel_hi:[1,0]
v_pk_mul_f32 v[106:107], v[106:107], v[16:17] op_sel_hi:[1,0]
v_pk_mul_f32 v[136:137], v[136:137], v[18:19] op_sel_hi:[1,0]
v_pk_mul_f32 v[138:139], v[138:139], v[18:19] op_sel_hi:[1,0]
v_perm_b32 v56, v210, v208, s49
v_perm_b32 v57, v214, v212, s49
s_sub_u32 s45, s45, 229376
s_waitcnt vmcnt(10)
buffer_load_dwordx2 v[160:161], v243, s[20:23], s45 offen offset:0 nt
v_pk_mul_f32 v[108:109], v[108:109], v[16:17] op_sel_hi:[1,0]
v_pk_mul_f32 v[110:111], v[110:111], v[16:17] op_sel_hi:[1,0]
v_pk_mul_f32 v[140:141], v[140:141], v[18:19] op_sel_hi:[1,0]
v_pk_mul_f32 v[142:143], v[142:143], v[18:19] op_sel_hi:[1,0]
v_perm_b32 v60, v210, v208, s50
v_perm_b32 v61, v214, v212, s50
buffer_load_dwordx2 v[162:163], v243, s[20:23], s45 offen offset:1024 nt
v_pk_mul_f32 v[112:113], v[112:113], v[16:17] op_sel_hi:[1,0]
v_pk_mul_f32 v[114:115], v[114:115], v[16:17] op_sel_hi:[1,0]
v_pk_mul_f32 v[144:145], v[144:145], v[18:19] op_sel_hi:[1,0]
v_pk_mul_f32 v[146:147], v[146:147], v[18:19] op_sel_hi:[1,0]
v_perm_b32 v64, v211, v209, s49
v_perm_b32 v65, v215, v213, s49
s_waitcnt vmcnt(11)
buffer_load_dwordx2 v[164:165], v243, s[20:23], s45 offen offset:2048 nt
v_pk_mul_f32 v[116:117], v[116:117], v[16:17] op_sel_hi:[1,0]
v_pk_mul_f32 v[118:119], v[118:119], v[16:17] op_sel_hi:[1,0]
v_pk_mul_f32 v[148:149], v[148:149], v[18:19] op_sel_hi:[1,0]
v_pk_mul_f32 v[150:151], v[150:151], v[18:19] op_sel_hi:[1,0]
v_perm_b32 v68, v211, v209, s50
v_perm_b32 v69, v215, v213, s50
s_waitcnt vmcnt(11)
buffer_load_dwordx2 v[166:167], v243, s[20:23], s45 offen offset:3072 nt
v_perm_b32 v58, v218, v216, s49
v_perm_b32 v59, v222, v220, s49
s_nop 1
v_mfma_f32_16x16x32_bf16 v[104:107], v[56:59], a[240:243], v[104:107]
v_mfma_f32_16x16x32_bf16 v[136:139], v[56:59], a[244:247], v[136:139]
s_add_u32 s45, s45, 32768
s_waitcnt vmcnt(11)
buffer_load_dwordx2 v[168:169], v243, s[20:23], s45 offen offset:0 nt
v_perm_b32 v62, v218, v216, s50
v_perm_b32 v63, v222, v220, s50
s_nop 1
v_mfma_f32_16x16x32_bf16 v[108:111], v[60:63], a[240:243], v[108:111]
v_mfma_f32_16x16x32_bf16 v[140:143], v[60:63], a[244:247], v[140:143]
s_waitcnt vmcnt(11)
buffer_load_dwordx2 v[170:171], v243, s[20:23], s45 offen offset:1024 nt
v_perm_b32 v66, v219, v217, s49
v_perm_b32 v67, v223, v221, s49
s_nop 1
v_mfma_f32_16x16x32_bf16 v[112:115], v[64:67], a[240:243], v[112:115]
v_mfma_f32_16x16x32_bf16 v[144:147], v[64:67], a[244:247], v[144:147]
s_waitcnt vmcnt(11)
buffer_load_dwordx2 v[172:173], v243, s[20:23], s45 offen offset:2048 nt
v_perm_b32 v70, v219, v217, s50
v_perm_b32 v71, v223, v221, s50
s_nop 1
v_mfma_f32_16x16x32_bf16 v[116:119], v[68:71], a[240:243], v[116:119]
v_mfma_f32_16x16x32_bf16 v[148:151], v[68:71], a[244:247], v[148:151]
s_waitcnt vmcnt(11)
buffer_load_dwordx2 v[174:175], v243, s[20:23], s45 offen offset:3072 nt
v_mov_b32 v16, v55
v_mov_b32 v18, v55
s_nop 1
v_permlane32_swap_b32 v16, v18
v_pk_mul_f32 v[104:105], v[104:105], v[16:17] op_sel_hi:[1,0]
v_pk_mul_f32 v[106:107], v[106:107], v[16:17] op_sel_hi:[1,0]
v_pk_mul_f32 v[136:137], v[136:137], v[18:19] op_sel_hi:[1,0]
v_pk_mul_f32 v[138:139], v[138:139], v[18:19] op_sel_hi:[1,0]
v_perm_b32 v56, v226, v224, s49
v_perm_b32 v57, v230, v228, s49
s_add_u32 s45, s45, 32768
s_waitcnt vmcnt(11)
buffer_load_dwordx2 v[176:177], v243, s[20:23], s45 offen offset:0 nt
v_pk_mul_f32 v[108:109], v[108:109], v[16:17] op_sel_hi:[1,0]
v_pk_mul_f32 v[110:111], v[110:111], v[16:17] op_sel_hi:[1,0]
v_pk_mul_f32 v[140:141], v[140:141], v[18:19] op_sel_hi:[1,0]
v_pk_mul_f32 v[142:143], v[142:143], v[18:19] op_sel_hi:[1,0]
v_perm_b32 v60, v226, v224, s50
v_perm_b32 v61, v230, v228, s50
s_waitcnt vmcnt(11)
buffer_load_dwordx2 v[178:179], v243, s[20:23], s45 offen offset:1024 nt
v_pk_mul_f32 v[112:113], v[112:113], v[16:17] op_sel_hi:[1,0]
v_pk_mul_f32 v[114:115], v[114:115], v[16:17] op_sel_hi:[1,0]
v_pk_mul_f32 v[144:145], v[144:145], v[18:19] op_sel_hi:[1,0]
v_pk_mul_f32 v[146:147], v[146:147], v[18:19] op_sel_hi:[1,0]
v_perm_b32 v64, v227, v225, s49
v_perm_b32 v65, v231, v229, s49
s_waitcnt vmcnt(11)
buffer_load_dwordx2 v[180:181], v243, s[20:23], s45 offen offset:2048 nt
v_pk_mul_f32 v[116:117], v[116:117], v[16:17] op_sel_hi:[1,0]
v_pk_mul_f32 v[118:119], v[118:119], v[16:17] op_sel_hi:[1,0]
v_pk_mul_f32 v[148:149], v[148:149], v[18:19] op_sel_hi:[1,0]
v_pk_mul_f32 v[150:151], v[150:151], v[18:19] op_sel_hi:[1,0]
v_perm_b32 v68, v227, v225, s50
v_perm_b32 v69, v231, v229, s50
s_waitcnt vmcnt(11)
buffer_load_dwordx2 v[182:183], v243, s[20:23], s45 offen offset:3072 nt
v_perm_b32 v58, v234, v232, s49
v_perm_b32 v59, v238, v236, s49
s_nop 1
v_mfma_f32_16x16x32_bf16 v[104:107], v[56:59], a[248:251], v[104:107]
v_mfma_f32_16x16x32_bf16 v[136:139], v[56:59], a[252:255], v[136:139]
s_add_u32 s45, s45, 32768
s_waitcnt vmcnt(11)
buffer_load_dwordx2 v[184:185], v243, s[20:23], s45 offen offset:0 nt
v_perm_b32 v62, v234, v232, s50
v_perm_b32 v63, v238, v236, s50
s_nop 1
v_mfma_f32_16x16x32_bf16 v[108:111], v[60:63], a[248:251], v[108:111]
v_mfma_f32_16x16x32_bf16 v[140:143], v[60:63], a[252:255], v[140:143]
ds_write_b128 v1, v[104:107] offset:0
ds_write_b128 v1, v[136:139] offset:4096
s_waitcnt vmcnt(11)
buffer_load_dwordx2 v[186:187], v243, s[20:23], s45 offen offset:1024 nt
v_perm_b32 v66, v235, v233, s49
v_perm_b32 v67, v239, v237, s49
s_nop 1
v_mfma_f32_16x16x32_bf16 v[112:115], v[64:67], a[248:251], v[112:115]
v_mfma_f32_16x16x32_bf16 v[144:147], v[64:67], a[252:255], v[144:147]
ds_write_b128 v1, v[108:111] offset:512
ds_write_b128 v1, v[140:143] offset:4608
s_waitcnt vmcnt(11)
buffer_load_dwordx2 v[188:189], v243, s[20:23], s45 offen offset:2048 nt
v_perm_b32 v70, v235, v233, s50
v_perm_b32 v71, v239, v237, s50
s_nop 1
v_mfma_f32_16x16x32_bf16 v[116:119], v[68:71], a[248:251], v[116:119]
v_mfma_f32_16x16x32_bf16 v[148:151], v[68:71], a[252:255], v[148:151]
ds_write_b128 v2, v[112:115] offset:1024
ds_write_b128 v2, v[144:147] offset:5120
s_waitcnt vmcnt(11)
buffer_load_dwordx2 v[190:191], v243, s[20:23], s45 offen offset:3072 nt
v_mov_b32 v16, v52
v_mov_b32 v18, v52
s_nop 1
v_permlane32_swap_b32 v16, v18
v_pk_mul_f32 v[88:89], v[88:89], v[16:17] op_sel_hi:[1,0]
v_pk_mul_f32 v[90:91], v[90:91], v[16:17] op_sel_hi:[1,0]
v_pk_mul_f32 v[120:121], v[120:121], v[18:19] op_sel_hi:[1,0]
v_pk_mul_f32 v[122:123], v[122:123], v[18:19] op_sel_hi:[1,0]
v_perm_b32 v56, v162, v160, s49
v_perm_b32 v57, v166, v164, s49
ds_write_b128 v2, v[116:119] offset:1536
ds_write_b128 v2, v[148:151] offset:5632
s_add_u32 s45, s45, 32768
s_waitcnt vmcnt(11)
buffer_load_dwordx2 v[192:193], v243, s[20:23], s45 offen offset:0 nt
v_pk_mul_f32 v[92:93], v[92:93], v[16:17] op_sel_hi:[1,0]
v_pk_mul_f32 v[94:95], v[94:95], v[16:17] op_sel_hi:[1,0]
v_pk_mul_f32 v[124:125], v[124:125], v[18:19] op_sel_hi:[1,0]
v_pk_mul_f32 v[126:127], v[126:127], v[18:19] op_sel_hi:[1,0]
v_perm_b32 v60, v162, v160, s50
v_perm_b32 v61, v166, v164, s50
s_waitcnt lgkmcnt(0)
s_barrier
ds_read_b64 v[24:25], v3 offset:0
ds_read_b64 v[26:27], v3 offset:512
ds_read_b64 v[28:29], v3 offset:1024
ds_read_b64 v[30:31], v3 offset:1536
ds_read_b128 v[32:35], v4 offset:0
ds_read_b128 v[36:39], v4 offset:512
s_waitcnt vmcnt(11)
buffer_load_dwordx2 v[194:195], v243, s[20:23], s45 offen offset:1024 nt
v_pk_mul_f32 v[96:97], v[96:97], v[16:17] op_sel_hi:[1,0]
v_pk_mul_f32 v[98:99], v[98:99], v[16:17] op_sel_hi:[1,0]
v_pk_mul_f32 v[128:129], v[128:129], v[18:19] op_sel_hi:[1,0]
v_pk_mul_f32 v[130:131], v[130:131], v[18:19] op_sel_hi:[1,0]
v_perm_b32 v64, v163, v161, s49
v_perm_b32 v65, v167, v165, s49
s_waitcnt lgkmcnt(2)
v_max3_f32 v20, v24, v26, v28
v_max_f32 v20, v20, v30
v_sub_f32 v248, v24, v20
v_sub_f32 v250, v26, v20
v_sub_f32 v252, v28, v20
v_sub_f32 v254, v30, v20
v_exp_f32 v248, v248
v_exp_f32 v250, v250
v_exp_f32 v252, v252
v_exp_f32 v254, v254
v_mul_f32 v21, v248, v25
v_fmac_f32 v21, v250, v27
v_fmac_f32 v21, v252, v29
v_fmac_f32 v21, v254, v31
ds_read_b128 v[24:27], v4 offset:16384
ds_read_b128 v[28:31], v4 offset:16896
s_waitcnt lgkmcnt(2)
v_pk_mul_f32 v[152:153], v[32:33], v[248:249] op_sel_hi:[1,0]
v_pk_mul_f32 v[154:155], v[34:35], v[248:249] op_sel_hi:[1,0]
v_pk_mul_f32 v[156:157], v[36:37], v[248:249] op_sel_hi:[1,0]
v_pk_mul_f32 v[158:159], v[38:39], v[248:249] op_sel_hi:[1,0]
ds_read_b128 v[32:35], v4 offset:32768
ds_read_b128 v[36:39], v4 offset:33280
s_waitcnt vmcnt(11)
buffer_load_dwordx2 v[196:197], v243, s[20:23], s45 offen offset:2048 nt
v_pk_mul_f32 v[100:101], v[100:101], v[16:17] op_sel_hi:[1,0]
v_pk_mul_f32 v[102:103], v[102:103], v[16:17] op_sel_hi:[1,0]
v_pk_mul_f32 v[132:133], v[132:133], v[18:19] op_sel_hi:[1,0]
v_pk_mul_f32 v[134:135], v[134:135], v[18:19] op_sel_hi:[1,0]
v_perm_b32 v68, v163, v161, s50
v_perm_b32 v69, v167, v165, s50
s_waitcnt lgkmcnt(2)
v_pk_fma_f32 v[152:153], v[24:25], v[250:251], v[152:153] op_sel_hi:[1,0,1]
v_pk_fma_f32 v[154:155], v[26:27], v[250:251], v[154:155] op_sel_hi:[1,0,1]
v_pk_fma_f32 v[156:157], v[28:29], v[250:251], v[156:157] op_sel_hi:[1,0,1]
v_pk_fma_f32 v[158:159], v[30:31], v[250:251], v[158:159] op_sel_hi:[1,0,1]
ds_read_b128 v[24:27], v4 offset:49152
ds_read_b128 v[28:31], v4 offset:49664
s_waitcnt lgkmcnt(2)
v_pk_fma_f32 v[152:153], v[32:33], v[252:253], v[152:153] op_sel_hi:[1,0,1]
v_pk_fma_f32 v[154:155], v[34:35], v[252:253], v[154:155] op_sel_hi:[1,0,1]
v_pk_fma_f32 v[156:157], v[36:37], v[252:253], v[156:157] op_sel_hi:[1,0,1]
v_pk_fma_f32 v[158:159], v[38:39], v[252:253], v[158:159] op_sel_hi:[1,0,1]
s_waitcnt vmcnt(11)
buffer_load_dwordx2 v[198:199], v243, s[20:23], s45 offen offset:3072 nt
v_perm_b32 v58, v170, v168, s49
v_perm_b32 v59, v174, v172, s49
s_nop 1
v_mfma_f32_16x16x32_bf16 v[88:91], v[56:59], a[224:227], v[88:91]
v_mfma_f32_16x16x32_bf16 v[120:123], v[56:59], a[228:231], v[120:123]
s_waitcnt lgkmcnt(0)
v_pk_fma_f32 v[152:153], v[24:25], v[254:255], v[152:153] op_sel_hi:[1,0,1]
v_pk_fma_f32 v[154:155], v[26:27], v[254:255], v[154:155] op_sel_hi:[1,0,1]
v_pk_fma_f32 v[156:157], v[28:29], v[254:255], v[156:157] op_sel_hi:[1,0,1]
v_pk_fma_f32 v[158:159], v[30:31], v[254:255], v[158:159] op_sel_hi:[1,0,1]
v_max3_f32 v24, |v152|, |v153|, |v154|
v_max3_f32 v25, |v155|, |v156|, |v157|
v_max3_f32 v24, v24, |v158|, |v159|
v_max_f32 v24, v24, v25
s_nop 1
v_max_f32_dpp v24, v24, v24 row_ror:8 row_mask:0xf bank_mask:0xf
v_mov_b32 v25, v24
s_nop 1
v_permlane16_swap_b32 v24, v25
v_max_f32 v24, v24, v25
v_mov_b32 v25, v24
s_nop 1
v_permlane32_swap_b32 v24, v25
v_max_f32 v24, v24, v25
v_frexp_exp_i32_f32 v24, v24
v_max_i32 v24, 0xffffffb0, v24
v_sub_u32 v25, 14, v24
v_add_u32 v24, -14, v24
v_ldexp_f32 v26, 1.0, v25
v_ldexp_f32 v38, 1.0, v24
v_mov_b32 v36, v20
v_mov_b32 v37, v21
v_pk_mul_f32 v[28:29], v[152:153], v[26:27] op_sel_hi:[1,0]
v_pk_mul_f32 v[30:31], v[154:155], v[26:27] op_sel_hi:[1,0]
v_pk_mul_f32 v[32:33], v[156:157], v[26:27] op_sel_hi:[1,0]
v_pk_mul_f32 v[34:35], v[158:159], v[26:27] op_sel_hi:[1,0]
v_cvt_pk_f16_f32 v152, v28, v32
v_cvt_pk_f16_f32 v153, v29, v33
v_cvt_pk_f16_f32 v154, v30, v34
v_cvt_pk_f16_f32 v155, v31, v35
v_mov_b32 v156, v38
buffer_store_dwordx4 v[152:155], v9, s[32:35], s63 offen sc1
s_mov_b64 exec, 0xff
buffer_store_dwordx4 v[36:39], v23, s[32:35], s89 offen sc1
s_mov_b64 exec, -1
s_add_u32 s45, s45, 32768
s_waitcnt vmcnt(13)
buffer_load_dwordx2 v[200:201], v243, s[20:23], s45 offen offset:0 nt
v_perm_b32 v62, v170, v168, s50
v_perm_b32 v63, v174, v172, s50
s_nop 1
v_mfma_f32_16x16x32_bf16 v[92:95], v[60:63], a[224:227], v[92:95]
v_mfma_f32_16x16x32_bf16 v[124:127], v[60:63], a[228:231], v[124:127]
s_waitcnt vmcnt(13)
buffer_load_dwordx2 v[202:203], v243, s[20:23], s45 offen offset:1024 nt
v_perm_b32 v66, v171, v169, s49
v_perm_b32 v67, v175, v173, s49
s_nop 1
v_mfma_f32_16x16x32_bf16 v[96:99], v[64:67], a[224:227], v[96:99]
v_mfma_f32_16x16x32_bf16 v[128:131], v[64:67], a[228:231], v[128:131]
s_waitcnt vmcnt(13)
buffer_load_dwordx2 v[204:205], v243, s[20:23], s45 offen offset:2048 nt
v_perm_b32 v70, v171, v169, s50
v_perm_b32 v71, v175, v173, s50
s_nop 1
v_mfma_f32_16x16x32_bf16 v[100:103], v[68:71], a[224:227], v[100:103]
v_mfma_f32_16x16x32_bf16 v[132:135], v[68:71], a[228:231], v[132:135]
s_waitcnt vmcnt(13)
buffer_load_dwordx2 v[206:207], v243, s[20:23], s45 offen offset:3072 nt
v_mov_b32 v16, v53
v_mov_b32 v18, v53
s_nop 1
v_permlane32_swap_b32 v16, v18
v_pk_mul_f32 v[88:89], v[88:89], v[16:17] op_sel_hi:[1,0]
v_pk_mul_f32 v[90:91], v[90:91], v[16:17] op_sel_hi:[1,0]
v_pk_mul_f32 v[120:121], v[120:121], v[18:19] op_sel_hi:[1,0]
v_pk_mul_f32 v[122:123], v[122:123], v[18:19] op_sel_hi:[1,0]
v_perm_b32 v56, v178, v176, s49
v_perm_b32 v57, v182, v180, s49
s_add_u32 s45, s45, 32768
s_waitcnt vmcnt(13)
buffer_load_dwordx2 v[208:209], v243, s[20:23], s45 offen offset:0 nt
v_pk_mul_f32 v[92:93], v[92:93], v[16:17] op_sel_hi:[1,0]
v_pk_mul_f32 v[94:95], v[94:95], v[16:17] op_sel_hi:[1,0]
v_pk_mul_f32 v[124:125], v[124:125], v[18:19] op_sel_hi:[1,0]
v_pk_mul_f32 v[126:127], v[126:127], v[18:19] op_sel_hi:[1,0]
v_perm_b32 v60, v178, v176, s50
v_perm_b32 v61, v182, v180, s50
s_waitcnt vmcnt(13)
buffer_load_dwordx2 v[210:211], v243, s[20:23], s45 offen offset:1024 nt
v_pk_mul_f32 v[96:97], v[96:97], v[16:17] op_sel_hi:[1,0]
v_pk_mul_f32 v[98:99], v[98:99], v[16:17] op_sel_hi:[1,0]
v_pk_mul_f32 v[128:129], v[128:129], v[18:19] op_sel_hi:[1,0]
v_pk_mul_f32 v[130:131], v[130:131], v[18:19] op_sel_hi:[1,0]
v_perm_b32 v64, v179, v177, s49
v_perm_b32 v65, v183, v181, s49
s_waitcnt vmcnt(13)
buffer_load_dwordx2 v[212:213], v243, s[20:23], s45 offen offset:2048 nt
v_pk_mul_f32 v[100:101], v[100:101], v[16:17] op_sel_hi:[1,0]
v_pk_mul_f32 v[102:103], v[102:103], v[16:17] op_sel_hi:[1,0]
v_pk_mul_f32 v[132:133], v[132:133], v[18:19] op_sel_hi:[1,0]
v_pk_mul_f32 v[134:135], v[134:135], v[18:19] op_sel_hi:[1,0]
v_perm_b32 v68, v179, v177, s50
v_perm_b32 v69, v183, v181, s50
s_waitcnt vmcnt(13)
buffer_load_dwordx2 v[214:215], v243, s[20:23], s45 offen offset:3072 nt
v_perm_b32 v58, v186, v184, s49
v_perm_b32 v59, v190, v188, s49
s_nop 1
v_mfma_f32_16x16x32_bf16 v[88:91], v[56:59], a[232:235], v[88:91]
v_mfma_f32_16x16x32_bf16 v[120:123], v[56:59], a[236:239], v[120:123]
s_add_u32 s45, s45, 32768
s_waitcnt vmcnt(13)
buffer_load_dwordx2 v[216:217], v243, s[20:23], s45 offen offset:0 nt
v_perm_b32 v62, v186, v184, s50
v_perm_b32 v63, v190, v188, s50
s_nop 1
v_mfma_f32_16x16x32_bf16 v[92:95], v[60:63], a[232:235], v[92:95]
v_mfma_f32_16x16x32_bf16 v[124:127], v[60:63], a[236:239], v[124:127]
buffer_load_dwordx2 v[218:219], v243, s[20:23], s45 offen offset:1024 nt
v_perm_b32 v66, v187, v185, s49
v_perm_b32 v67, v191, v189, s49
s_nop 1
v_mfma_f32_16x16x32_bf16 v[96:99], v[64:67], a[232:235], v[96:99]
v_mfma_f32_16x16x32_bf16 v[128:131], v[64:67], a[236:239], v[128:131]
s_waitcnt vmcnt(10)
v_mov_b32 v24, s95
v_mov_b32 v25, s94
s_mov_b64 exec, 1
buffer_store_dwordx2 v[24:25], v22, s[32:35], s93 offen sc1
s_mov_b64 exec, -1
buffer_load_dwordx2 v[220:221], v243, s[20:23], s45 offen offset:2048 nt
v_perm_b32 v70, v187, v185, s50
v_perm_b32 v71, v191, v189, s50
s_nop 1
v_mfma_f32_16x16x32_bf16 v[100:103], v[68:71], a[232:235], v[100:103]
v_mfma_f32_16x16x32_bf16 v[132:135], v[68:71], a[236:239], v[132:135]
buffer_load_dwordx2 v[222:223], v243, s[20:23], s45 offen offset:3072 nt
v_mov_b32 v16, v54
v_mov_b32 v18, v54
s_nop 1
v_permlane32_swap_b32 v16, v18
v_pk_mul_f32 v[88:89], v[88:89], v[16:17] op_sel_hi:[1,0]
v_pk_mul_f32 v[90:91], v[90:91], v[16:17] op_sel_hi:[1,0]
v_pk_mul_f32 v[120:121], v[120:121], v[18:19] op_sel_hi:[1,0]
v_pk_mul_f32 v[122:123], v[122:123], v[18:19] op_sel_hi:[1,0]
v_perm_b32 v56, v194, v192, s49
v_perm_b32 v57, v198, v196, s49
s_load_dword s90, s[14:15], s92 glc
v_pk_mul_f32 v[92:93], v[92:93], v[16:17] op_sel_hi:[1,0]
v_pk_mul_f32 v[94:95], v[94:95], v[16:17] op_sel_hi:[1,0]
v_pk_mul_f32 v[124:125], v[124:125], v[18:19] op_sel_hi:[1,0]
v_pk_mul_f32 v[126:127], v[126:127], v[18:19] op_sel_hi:[1,0]
v_perm_b32 v60, v194, v192, s50
v_perm_b32 v61, v198, v196, s50
v_pk_mul_f32 v[96:97], v[96:97], v[16:17] op_sel_hi:[1,0]
v_pk_mul_f32 v[98:99], v[98:99], v[16:17] op_sel_hi:[1,0]
v_pk_mul_f32 v[128:129], v[128:129], v[18:19] op_sel_hi:[1,0]
v_pk_mul_f32 v[130:131], v[130:131], v[18:19] op_sel_hi:[1,0]
v_perm_b32 v64, v195, v193, s49
v_perm_b32 v65, v199, v197, s49
v_pk_mul_f32 v[100:101], v[100:101], v[16:17] op_sel_hi:[1,0]
v_pk_mul_f32 v[102:103], v[102:103], v[16:17] op_sel_hi:[1,0]
v_pk_mul_f32 v[132:133], v[132:133], v[18:19] op_sel_hi:[1,0]
v_pk_mul_f32 v[134:135], v[134:135], v[18:19] op_sel_hi:[1,0]
v_perm_b32 v68, v195, v193, s50
v_perm_b32 v69, v199, v197, s50
s_waitcnt vmcnt(11)
v_perm_b32 v58, v202, v200, s49
s_waitcnt vmcnt(9)
v_perm_b32 v59, v206, v204, s49
s_nop 1
v_mfma_f32_16x16x32_bf16 v[88:91], v[56:59], a[240:243], v[88:91]
v_mfma_f32_16x16x32_bf16 v[120:123], v[56:59], a[244:247], v[120:123]
v_perm_b32 v62, v202, v200, s50
v_perm_b32 v63, v206, v204, s50
s_nop 1
v_mfma_f32_16x16x32_bf16 v[92:95], v[60:63], a[240:243], v[92:95]
v_mfma_f32_16x16x32_bf16 v[124:127], v[60:63], a[244:247], v[124:127]
v_perm_b32 v66, v203, v201, s49
v_perm_b32 v67, v207, v205, s49
s_nop 1
v_mfma_f32_16x16x32_bf16 v[96:99], v[64:67], a[240:243], v[96:99]
v_mfma_f32_16x16x32_bf16 v[128:131], v[64:67], a[244:247], v[128:131]
s_waitcnt lgkmcnt(0)
s_cmp_eq_u32 s90, s96
s_cselect_b32 s90, 1, 0
s_cselect_b32 s66, s57, s65
s_cselect_b32 s67, s58, s65
s_waitcnt vmcnt(2)
buffer_load_dwordx4 v[244:247], v22, s[32:35], s92 offen sc1
buffer_load_dwordx3 v[32:34], v23, s[32:35], s67 offen sc1
buffer_load_dwordx4 v[24:27], v9, s[32:35], s66 offen sc1
v_perm_b32 v70, v203, v201, s50
v_perm_b32 v71, v207, v205, s50
s_nop 1
v_mfma_f32_16x16x32_bf16 v[100:103], v[68:71], a[240:243], v[100:103]
v_mfma_f32_16x16x32_bf16 v[132:135], v[68:71], a[244:247], v[132:135]
v_mov_b32 v16, v55
v_mov_b32 v18, v55
s_nop 1
v_permlane32_swap_b32 v16, v18
v_pk_mul_f32 v[88:89], v[88:89], v[16:17] op_sel_hi:[1,0]
v_pk_mul_f32 v[90:91], v[90:91], v[16:17] op_sel_hi:[1,0]
v_pk_mul_f32 v[120:121], v[120:121], v[18:19] op_sel_hi:[1,0]
v_pk_mul_f32 v[122:123], v[122:123], v[18:19] op_sel_hi:[1,0]
v_perm_b32 v56, v210, v208, s49
v_perm_b32 v57, v214, v212, s49
v_pk_mul_f32 v[92:93], v[92:93], v[16:17] op_sel_hi:[1,0]
v_pk_mul_f32 v[94:95], v[94:95], v[16:17] op_sel_hi:[1,0]
v_pk_mul_f32 v[124:125], v[124:125], v[18:19] op_sel_hi:[1,0]
v_pk_mul_f32 v[126:127], v[126:127], v[18:19] op_sel_hi:[1,0]
v_perm_b32 v60, v210, v208, s50
v_perm_b32 v61, v214, v212, s50
v_pk_mul_f32 v[96:97], v[96:97], v[16:17] op_sel_hi:[1,0]
v_pk_mul_f32 v[98:99], v[98:99], v[16:17] op_sel_hi:[1,0]
v_pk_mul_f32 v[128:129], v[128:129], v[18:19] op_sel_hi:[1,0]
v_pk_mul_f32 v[130:131], v[130:131], v[18:19] op_sel_hi:[1,0]
v_perm_b32 v64, v211, v209, s49
v_perm_b32 v65, v215, v213, s49
v_pk_mul_f32 v[100:101], v[100:101], v[16:17] op_sel_hi:[1,0]
v_pk_mul_f32 v[102:103], v[102:103], v[16:17] op_sel_hi:[1,0]
v_pk_mul_f32 v[132:133], v[132:133], v[18:19] op_sel_hi:[1,0]
v_pk_mul_f32 v[134:135], v[134:135], v[18:19] op_sel_hi:[1,0]
v_perm_b32 v68, v211, v209, s50
v_perm_b32 v69, v215, v213, s50
v_perm_b32 v58, v218, v216, s49
v_perm_b32 v62, v218, v216, s50
v_perm_b32 v66, v219, v217, s49
v_perm_b32 v70, v219, v217, s50
s_waitcnt vmcnt(3)
v_perm_b32 v59, v222, v220, s49
v_perm_b32 v63, v222, v220, s50
v_perm_b32 v67, v223, v221, s49
v_perm_b32 v71, v223, v221, s50
v_mfma_f32_16x16x32_bf16 v[88:91], v[56:59], a[248:251], v[88:91]
v_mfma_f32_16x16x32_bf16 v[120:123], v[56:59], a[252:255], v[120:123]
v_mfma_f32_16x16x32_bf16 v[92:95], v[60:63], a[248:251], v[92:95]
v_mfma_f32_16x16x32_bf16 v[124:127], v[60:63], a[252:255], v[124:127]
v_mfma_f32_16x16x32_bf16 v[96:99], v[64:67], a[248:251], v[96:99]
v_mfma_f32_16x16x32_bf16 v[128:131], v[64:67], a[252:255], v[128:131]
s_nop 2
ds_write_b128 v1, v[88:91] offset:8192
ds_write_b128 v1, v[120:123] offset:12288
v_mfma_f32_16x16x32_bf16 v[100:103], v[68:71], a[248:251], v[100:103]
v_mfma_f32_16x16x32_bf16 v[132:135], v[68:71], a[252:255], v[132:135]
ds_write_b128 v1, v[92:95] offset:8704
ds_write_b128 v1, v[124:127] offset:12800
ds_write_b128 v2, v[96:99] offset:9216
ds_write_b128 v2, v[128:131] offset:13312
s_nop 2
ds_write_b128 v2, v[100:103] offset:9728
ds_write_b128 v2, v[132:135] offset:13824
s_waitcnt lgkmcnt(0)
s_barrier
ds_read_b128 v[160:163], v4 offset:8192
ds_read_b128 v[164:167], v4 offset:8704
ds_read_b128 v[168:171], v4 offset:24576
ds_read_b128 v[172:175], v4 offset:25088
ds_read_b128 v[176:179], v4 offset:40960
ds_read_b128 v[180:183], v4 offset:41472
ds_read_b128 v[184:187], v4 offset:57344
ds_read_b128 v[188:191], v4 offset:57856
s_cmp_lg_u32 s90, 0
s_cbranch_scc0 L_na
s_waitcnt vmcnt(0)
v_max_f32 v12, v20, v32
v_sub_f32 v16, v20, v12
v_sub_f32 v18, v32, v12
v_exp_f32 v16, v16
v_exp_f32 v18, v18
v_mul_f32 v12, v16, v21
v_mul_f32 v13, v18, v33
v_add_f32 v12, v12, v13
v_rcp_f32 v12, v12
s_nop 0
v_mul_f32 v16, v16, v12
v_mul_f32 v18, v18, v12
s_branch L_nob
L_na:
s_waitcnt vmcnt(0)
v_readfirstlane_b32 s90, v244
s_nop 1
s_cmp_eq_u32 s90, s96
s_cselect_b32 s90, 1, 0
s_cbranch_scc0 L_nob
buffer_load_dwordx3 v[32:34], v23, s[32:35], s58 offen sc1
buffer_load_dwordx4 v[24:27], v9, s[32:35], s57 offen sc1
s_mov_b32 s90, 2
L_nob:
s_waitcnt lgkmcnt(6)
v_pk_mul_f32 v[56:57], v[160:161], v[248:249] op_sel_hi:[1,0]
v_pk_mul_f32 v[58:59], v[162:163], v[248:249] op_sel_hi:[1,0]
v_pk_mul_f32 v[60:61], v[164:165], v[248:249] op_sel_hi:[1,0]
v_pk_mul_f32 v[62:63], v[166:167], v[248:249] op_sel_hi:[1,0]
s_waitcnt lgkmcnt(4)
v_pk_fma_f32 v[56:57], v[168:169], v[250:251], v[56:57] op_sel_hi:[1,0,1]
v_pk_fma_f32 v[58:59], v[170:171], v[250:251], v[58:59] op_sel_hi:[1,0,1]
v_pk_fma_f32 v[60:61], v[172:173], v[250:251], v[60:61] op_sel_hi:[1,0,1]
v_pk_fma_f32 v[62:63], v[174:175], v[250:251], v[62:63] op_sel_hi:[1,0,1]
s_waitcnt lgkmcnt(2)
v_pk_fma_f32 v[56:57], v[176:177], v[252:253], v[56:57] op_sel_hi:[1,0,1]
v_pk_fma_f32 v[58:59], v[178:179], v[252:253], v[58:59] op_sel_hi:[1,0,1]
v_pk_fma_f32 v[60:61], v[180:181], v[252:253], v[60:61] op_sel_hi:[1,0,1]
v_pk_fma_f32 v[62:63], v[182:183], v[252:253], v[62:63] op_sel_hi:[1,0,1]
s_waitcnt lgkmcnt(0)
v_pk_fma_f32 v[56:57], v[184:185], v[254:255], v[56:57] op_sel_hi:[1,0,1]
v_pk_fma_f32 v[58:59], v[186:187], v[254:255], v[58:59] op_sel_hi:[1,0,1]
v_pk_fma_f32 v[60:61], v[188:189], v[254:255], v[60:61] op_sel_hi:[1,0,1]
v_pk_fma_f32 v[62:63], v[190:191], v[254:255], v[62:63] op_sel_hi:[1,0,1]
s_mov_b32 s60, 0
s_cmp_eq_u32 s90, 1
s_cbranch_scc1 L_have3
s_cmp_lg_u32 s90, 0
s_cbranch_scc0 L_fb
L_have:
s_waitcnt vmcnt(0)
L_have2:
v_max_f32 v12, v20, v32
v_sub_f32 v16, v20, v12
v_sub_f32 v18, v32, v12
v_exp_f32 v16, v16
v_exp_f32 v18, v18
v_mul_f32 v12, v16, v21
v_mul_f32 v13, v18, v33
v_add_f32 v12, v12, v13
v_rcp_f32 v12, v12
s_nop 0
v_mul_f32 v16, v16, v12
v_mul_f32 v18, v18, v12
L_have3:
s_nop 0
v_mul_f32 v13, v18, v34
v_pk_mul_f32 v[64:65], v[56:57], v[16:17] op_sel_hi:[1,0]
v_pk_mul_f32 v[66:67], v[58:59], v[16:17] op_sel_hi:[1,0]
v_pk_mul_f32 v[68:69], v[60:61], v[16:17] op_sel_hi:[1,0]
v_pk_mul_f32 v[70:71], v[62:63], v[16:17] op_sel_hi:[1,0]
v_fma_mix_f32 v64, v24, v13, v64 op_sel_hi:[1,0,0]
v_fma_mix_f32 v68, v24, v13, v68 op_sel:[1,0,0] op_sel_hi:[1,0,0]
v_fma_mix_f32 v65, v25, v13, v65 op_sel_hi:[1,0,0]
v_fma_mix_f32 v69, v25, v13, v69 op_sel:[1,0,0] op_sel_hi:[1,0,0]
v_fma_mix_f32 v66, v26, v13, v66 op_sel_hi:[1,0,0]
v_fma_mix_f32 v70, v26, v13, v70 op_sel:[1,0,0] op_sel_hi:[1,0,0]
v_fma_mix_f32 v67, v27, v13, v67 op_sel_hi:[1,0,0]
v_fma_mix_f32 v71, v27, v13, v71 op_sel:[1,0,0] op_sel_hi:[1,0,0]
v_cvt_pk_bf16_f32 v72, v64, v68
ds_write_b32 v5, v72 offset:0
v_cvt_pk_bf16_f32 v73, v65, v69
ds_write_b32 v5, v73 offset:16
v_cvt_pk_bf16_f32 v74, v66, v70
ds_write_b32 v5, v74 offset:32
v_cvt_pk_bf16_f32 v75, v67, v71
ds_write_b32 v5, v75 offset:48
s_waitcnt lgkmcnt(0)
ds_read_b128 v[76:79], v6
s_waitcnt lgkmcnt(0)
buffer_store_dwordx4 v[76:79], v15, s[28:31], s69 offen sc1
v_readfirstlane_b32 s90, v246
v_readfirstlane_b32 s91, v245
s_nop 0
s_cmp_eq_u32 s90, s98
s_cbranch_scc1 L_second
s_cmp_lg_u32 s91, s95
s_cbranch_scc1 L_fin
s_cmp_lg_u32 s60, 0
s_cbranch_scc1 L_arb
s_mov_b32 s60, 2
L_fb:
buffer_store_dwordx4 v[56:59], v9, s[32:35], s63 offen offset:2048 sc1
buffer_store_dwordx4 v[60:63], v9, s[32:35], s63 offen offset:3072 sc1
s_cmp_lg_u32 s60, 0
s_cbranch_scc1 L_fb2
buffer_load_dwordx4 v[244:247], v22, s[32:35], s92 offen sc1
s_waitcnt vmcnt(0)
v_readfirstlane_b32 s90, v244
s_nop 1
s_cmp_eq_u32 s90, s96
s_cselect_b32 s90, 1, 0
s_cbranch_scc0 L_fb2
buffer_load_dwordx3 v[32:34], v23, s[32:35], s58 offen sc1
buffer_load_dwordx4 v[24:27], v9, s[32:35], s57 offen sc1
s_branch L_have
L_fb2:
s_waitcnt vmcnt(0)
v_mov_b32 v80, s99
s_mov_b64 exec, 1
buffer_store_dword v80, v22, s[32:35], s93 offen offset:8 sc1
s_mov_b64 exec, -1
s_waitcnt vmcnt(0)
s_cmp_lg_u32 s60, 0
s_cbranch_scc1 L_arb
s_mov_b32 s60, 1
buffer_load_dwordx4 v[244:247], v22, s[32:35], s92 offen sc1
s_waitcnt vmcnt(0)
v_readfirstlane_b32 s90, v244
s_nop 1
s_cmp_eq_u32 s90, s96
s_cselect_b32 s90, 1, 0
s_cbranch_scc0 L_arb
buffer_load_dwordx3 v[32:34], v23, s[32:35], s58 offen sc1
buffer_load_dwordx4 v[24:27], v9, s[32:35], s57 offen sc1
s_branch L_have
L_arb:
s_lshl_b32 s91, 2, s40
s_nop 0
v_mov_b32 v80, s91
ds_write_b32 v7, v80
s_waitcnt lgkmcnt(0)
s_barrier
ds_read_b128 v[80:83], v8
s_waitcnt lgkmcnt(0)
v_or3_b32 v80, v80, v81, v82
v_or_b32 v80, v80, v83
s_nop 0
v_readfirstlane_b32 s90, v80
s_nop 1
s_ff1_i32_b32 s46, s90
s_sub_u32 s46, s46, 1
s_cmp_lg_u32 s46, s40
s_cbranch_scc1 L_noatomic
s_or_b32 s90, s90, 1
s_lshl_b32 s90, s90, s59
v_mov_b32 v80, s90
s_mov_b64 exec, 1
buffer_atomic_add v80, v22, s[36:39], s61 offen sc0
s_waitcnt vmcnt(0)
ds_write_b32 v8, v80 offset:32
s_waitcnt lgkmcnt(0)
s_mov_b64 exec, -1
L_noatomic:
s_barrier
ds_read_b32 v80, v8 offset:32
s_waitcnt lgkmcnt(0)
v_readfirstlane_b32 s90, v80
s_nop 1
s_lshr_b32 s90, s90, s59
s_and_b32 s90, s90, s91
s_cbranch_scc0 L_fin
buffer_load_dwordx3 v[32:34], v23, s[32:35], s58 offen sc1
buffer_load_dwordx4 v[24:27], v9, s[32:35], s57 offen sc1
s_waitcnt vmcnt(0)
v_max_f32 v12, v20, v32
v_sub_f32 v16, v20, v12
v_sub_f32 v18, v32, v12
v_exp_f32 v16, v16
v_exp_f32 v18, v18
v_mul_f32 v12, v16, v21
v_mul_f32 v13, v18, v33
v_add_f32 v12, v12, v13
v_rcp_f32 v12, v12
s_nop 0
v_mul_f32 v16, v16, v12
v_mul_f32 v18, v18, v12
v_mul_f32 v13, v18, v34
v_pk_mul_f32 v[64:65], v[56:57], v[16:17] op_sel_hi:[1,0]
v_pk_mul_f32 v[66:67], v[58:59], v[16:17] op_sel_hi:[1,0]
v_pk_mul_f32 v[68:69], v[60:61], v[16:17] op_sel_hi:[1,0]
v_pk_mul_f32 v[70:71], v[62:63], v[16:17] op_sel_hi:[1,0]
v_fma_mix_f32 v64, v24, v13, v64 op_sel_hi:[1,0,0]
v_fma_mix_f32 v68, v24, v13, v68 op_sel:[1,0,0] op_sel_hi:[1,0,0]
v_fma_mix_f32 v65, v25, v13, v65 op_sel_hi:[1,0,0]
v_fma_mix_f32 v69, v25, v13, v69 op_sel:[1,0,0] op_sel_hi:[1,0,0]
v_fma_mix_f32 v66, v26, v13, v66 op_sel_hi:[1,0,0]
v_fma_mix_f32 v70, v26, v13, v70 op_sel:[1,0,0] op_sel_hi:[1,0,0]
v_fma_mix_f32 v67, v27, v13, v67 op_sel_hi:[1,0,0]
v_fma_mix_f32 v71, v27, v13, v71 op_sel:[1,0,0] op_sel_hi:[1,0,0]
v_cvt_pk_bf16_f32 v72, v64, v68
ds_write_b32 v5, v72 offset:0
v_cvt_pk_bf16_f32 v73, v65, v69
ds_write_b32 v5, v73 offset:16
v_cvt_pk_bf16_f32 v74, v66, v70
ds_write_b32 v5, v74 offset:32
v_cvt_pk_bf16_f32 v75, v67, v71
ds_write_b32 v5, v75 offset:48
s_waitcnt lgkmcnt(0)
ds_read_b128 v[76:79], v6
s_waitcnt lgkmcnt(0)
buffer_store_dwordx4 v[76:79], v15, s[28:31], s69 offen sc1
L_second:
buffer_load_dwordx4 v[24:27], v9, s[32:35], s57 offen offset:2048 sc1
buffer_load_dwordx4 v[28:31], v9, s[32:35], s57 offen offset:3072 sc1
s_waitcnt vmcnt(0)
v_mul_f32 v13, v16, v156
v_pk_mul_f32 v[64:65], v[24:25], v[18:19] op_sel_hi:[1,0]
v_pk_mul_f32 v[66:67], v[26:27], v[18:19] op_sel_hi:[1,0]
v_pk_mul_f32 v[68:69], v[28:29], v[18:19] op_sel_hi:[1,0]
v_pk_mul_f32 v[70:71], v[30:31], v[18:19] op_sel_hi:[1,0]
v_fma_mix_f32 v64, v152, v13, v64 op_sel_hi:[1,0,0]
v_fma_mix_f32 v68, v152, v13, v68 op_sel:[1,0,0] op_sel_hi:[1,0,0]
v_fma_mix_f32 v65, v153, v13, v65 op_sel_hi:[1,0,0]
v_fma_mix_f32 v69, v153, v13, v69 op_sel:[1,0,0] op_sel_hi:[1,0,0]
v_fma_mix_f32 v66, v154, v13, v66 op_sel_hi:[1,0,0]
v_fma_mix_f32 v70, v154, v13, v70 op_sel:[1,0,0] op_sel_hi:[1,0,0]
v_fma_mix_f32 v67, v155, v13, v67 op_sel_hi:[1,0,0]
v_fma_mix_f32 v71, v155, v13, v71 op_sel:[1,0,0] op_sel_hi:[1,0,0]
v_cvt_pk_bf16_f32 v72, v64, v68
ds_write_b32 v5, v72 offset:0
v_cvt_pk_bf16_f32 v73, v65, v69
ds_write_b32 v5, v73 offset:16
v_cvt_pk_bf16_f32 v74, v66, v70
ds_write_b32 v5, v74 offset:32
v_cvt_pk_bf16_f32 v75, v67, v71
ds_write_b32 v5, v75 offset:48
s_waitcnt lgkmcnt(0)
ds_read_b128 v[76:79], v6
s_waitcnt lgkmcnt(0)
buffer_store_dwordx4 v[76:79], v15, s[28:31], s68 offen sc1
L_fin:
s_cmp_lt_u32 s2, 8
s_cselect_b32 s42, s42, 0x1000
s_mov_b64 exec, 1
buffer_store_byte v22, v22, s[36:39], s42 offen sc1
L_end:
s_endpgm
.section .rodata,"a"
.p2align 6
.amdhsa_kernel standalone__gqa_softmax__sampling_kernel
  .amdhsa_next_free_vgpr 512
  .amdhsa_next_free_sgpr 102
  .amdhsa_accum_offset 256
  .amdhsa_group_segment_fixed_size 0
  .amdhsa_kernarg_size 48
  .amdhsa_user_sgpr_count 2
  .amdhsa_user_sgpr_kernarg_segment_ptr 1
  .amdhsa_system_sgpr_workgroup_id_x 1
.end_amdhsa_kernel
```
